```python
import torch

def _softmax(x, axis=-1):
    return torch.softmax(x, dim=axis)
def _gelu(x):
    return torch.nn.functional.gelu(x, approximate="tanh")
def _silu(x):
    return torch.nn.functional.silu(x)
def _sigmoid(x):
    return torch.sigmoid(x)
def _layernorm(x, axis=-1, eps=1e-5):
    m = x.mean(dim=axis, keepdim=True)
    v = x.var(dim=axis, keepdim=True, unbiased=False)
    return (x - m) / torch.sqrt(v + eps)
def _scatter_add(tgt, idx, src, axis=0):
    return tgt.clone().index_add_(axis, idx, src)
def _segment_sum(src, seg, n):
    out = torch.zeros((n,) + src.shape[1:], dtype=src.dtype)
    return out.index_add_(0, seg, src)
def _pad(x, pw):
    flat = tuple(v for pair in reversed(pw) for v in pair)
    return torch.nn.functional.pad(x, flat)

kernel_name = 'parallel_sum__ssm_conv_s5__dense_activation_squared_relu__prompt'

def setup_inputs():

    _w = (lambda a: (lambda t: t.to(torch.bfloat16) if t.is_floating_point() else t)(torch.as_tensor(a)))
    def _A_setup():
        B, S, D = 1, 2048, 640
        P = D
        Lambda_re = -0.5 * (lambda _x: torch.exp(torch.as_tensor(_x)))((lambda *s: torch.randn(*s, dtype=torch.bfloat16) * 0.8)(P))
        Lambda_im = (lambda *s: torch.randn(*s, dtype=torch.bfloat16) * 0.8)(P) * 1.0
        B_re = (lambda *s: torch.randn(*s, dtype=torch.bfloat16) * 1.6)(P, D) * (D ** -0.5)
        B_im = (lambda *s: torch.randn(*s, dtype=torch.bfloat16) * 1.6)(P, D) * (D ** -0.5)
        C_re = (lambda *s: torch.randn(*s, dtype=torch.bfloat16) * 1.6)(D, P) * (P ** -0.5)
        C_im = (lambda *s: torch.randn(*s, dtype=torch.bfloat16) * 1.6)(D, P) * (P ** -0.5)
        log_dt = (lambda *s: torch.randn(*s, dtype=torch.bfloat16) * 0.8)(P) * 0.3 - 2.0
        Dskip = (lambda *s: torch.randn(*s, dtype=torch.bfloat16) * 0.8)(D)
        return {
            "x": _w((lambda *s: torch.randn(*s, dtype=torch.bfloat16) * 0.05)(B, S, D)),
            "Lambda_re": _w(Lambda_re),
            "Lambda_im": _w(Lambda_im),
            "B_re": _w(B_re),
            "B_im": _w(B_im),
            "C_re": _w(C_re),
            "C_im": _w(C_im),
            "log_dt": _w(log_dt),
            "Dskip": _w(Dskip),
        }
    _A_in = _A_setup()

    def _B_setup():
        B, S, D, F = 1, 2048, 640, 1728
        return {
            "x": _w((lambda *s: torch.randn(*s, dtype=torch.bfloat16) * 0.05)(B, S, D)),
            "w1": _w((lambda *s: torch.randn(*s, dtype=torch.bfloat16) * 0.05)(D, F)),
            "b1": _w((lambda *s: torch.randn(*s, dtype=torch.bfloat16) * 0.4)(F)),
            "w2": _w((lambda *s: torch.randn(*s, dtype=torch.bfloat16) * 0.05)(F, D)),
            "b2": _w((lambda *s: torch.randn(*s, dtype=torch.bfloat16) * 1.6)(D)),
        }
    _B_in = _B_setup()

    return {
        "A_x": _A_in["x"],
        "A_Lambda_re": _A_in["Lambda_re"],
        "A_Lambda_im": _A_in["Lambda_im"],
        "A_B_re": _A_in["B_re"],
        "A_B_im": _A_in["B_im"],
        "A_C_re": _A_in["C_re"],
        "A_C_im": _A_in["C_im"],
        "A_log_dt": _A_in["log_dt"],
        "A_Dskip": _A_in["Dskip"],
        "B_x": _B_in["x"],
        "B_w1": _B_in["w1"],
        "B_b1": _B_in["b1"],
        "B_w2": _B_in["w2"],
        "B_b2": _B_in["b2"],
    }

def reference(A_x, A_Lambda_re, A_Lambda_im, A_B_re, A_B_im, A_C_re, A_C_im, A_log_dt, A_Dskip, B_x, B_w1, B_b1, B_w2, B_b2):
    def _A_ref(x, Lambda_re, Lambda_im, B_re, B_im, C_re, C_im, log_dt, Dskip):
        Bsz, L, H = x.shape
        Lam = Lambda_re + 1j * Lambda_im
        Bmat = B_re + 1j * B_im
        Cmat = C_re + 1j * C_im
        dt = torch.exp(log_dt)
        Lam_bar = torch.exp(dt * Lam)
        B_bar = ((Lam_bar - 1.0) / Lam)[:, None] * Bmat
        Bu = torch.einsum("bld,pd->blp", x + 0j, B_bar)
        h = torch.zeros_like(Bu[:, 0, :])
        hs = []
        for t in range(L):
            h = Lam_bar[None, :] * h + Bu[:, t, :]
            hs.append(h)
        hseq = torch.stack(hs, 1)
        y = 2.0 * torch.einsum("blp,dp->bld", hseq, Cmat).real + x * Dskip[None, None, :]
        return y

    def _B_ref(x, w1, b1, w2, b2):
        h = torch.einsum("bsd,df->bsf", x, w1) + b1
        zero = torch.zeros_like(h)
        r = torch.where(h > zero, h, zero)
        h = r * r
        out = torch.einsum("bsf,fd->bsd", h, w2) + b2
        return out

    x = A_x
    xn = _layernorm(x, axis=-1)
    return x + _A_ref(xn, A_Lambda_re, A_Lambda_im, A_B_re, A_B_im, A_C_re, A_C_im, A_log_dt, A_Dskip) + _B_ref(xn, B_w1, B_b1, B_w2, B_b2)
```

```asm
; @launch grid=(256,1,1) block=(256,1,1) lds=163840
.amdgcn_target "amdgcn-amd-amdhsa--gfx950"
.text
.globl parallel_sum__ssm_conv_s5__dense_activation_squared_relu__prompt_kernel
.p2align 8
.type parallel_sum__ssm_conv_s5__dense_activation_squared_relu__prompt_kernel,@function
parallel_sum__ssm_conv_s5__dense_activation_squared_relu__prompt_kernel:
    s_cmp_ge_u32 s2, 256
    s_cbranch_scc1 L_end
    s_load_dwordx16 s[4:19], s[0:1], 0
    s_load_dwordx16 s[20:35], s[0:1], 64
    s_load_dwordx2 s[36:37], s[0:1], 128
    s_getpc_b64 s[60:61]
    s_lshr_b32 s3, s2, 3
    s_mul_i32 s38, s3, 12
    v_add_lshl_u32 v34, s38, v0, 7
    v_cmp_gt_u32 vcc, 12, v0
    v_lshrrev_b32 v35, 6, v0
    v_and_b32_e64 v0, 63, v0
    s_and_saveexec_b64 s[62:63], vcc
    s_cbranch_execz L_nopf
    global_load_dword a2, v34, s[60:61]
L_nopf:
    s_mov_b64 exec, -1
    v_readfirstlane_b32 s64, v35
    s_lshr_b32 s65, s2, 5
    s_add_u32 s68, s65, s3
    s_bitcmp1_b32 s68, 0
    s_mov_b32 s68, 408065584
    s_cselect_b32 s68, 1661419909, s68
    s_lshl_b32 s38, s2, 2
    s_lshr_b32 s68, s68, s38
    s_and_b32 s68, s68, 15
    s_and_b32 s38, s2, 4
    s_lshl1_add_u32 s65, s38, s65
    v_lshrrev_b32 v32, 3, v0
    v_and_b32 v33, 7, v0
    v_lshrrev_b32_e64 v2, 4, v0
    s_lshl_b32 s38, s65, 6
    s_add_u32 s38, s38, s64
    s_mul_i32 s38, s38, 2560
    v_xor_b32 v34, v2, v33
    v_lshlrev_b32 v34, 4, v34
    v_mul_u32_u24 v35, 10240, v32
    v_add3_u32 v3, v35, v34, s38
    s_mul_i32 s73, s64, 40960
    s_lshl_b32 s69, s68, 7
    s_mov_b32 s42, 2621440
    s_mov_b32 s43, 0x20000
    s_add_u32 m0, s73, 0
    s_waitcnt lgkmcnt(0)
    s_mov_b64 s[40:41], s[4:5]
    buffer_load_dwordx4 v3, s[40:43], s69 offen offset:0 lds
    s_add_u32 m0, s73, 768
    v_xor_b32_e64 v4, 64, v3
    buffer_load_dwordx4 v3, s[40:43], s69 offen offset:1280 lds
    s_add_u32 m0, s73, 1024
    v_add_u32 v4, 81920, v4
    buffer_load_dwordx4 v4, s[40:43], s69 offen offset:0 lds
    s_add_u32 m0, s73, 1792
    s_and_b32 s38, s2, 3
    buffer_load_dwordx4 v4, s[40:43], s69 offen offset:1280 lds
    s_and_b32 s3, s3, 3
    s_lshl2_add_u32 s66, s38, s3
    s_lshl1_add_u32 s67, s38, s3
    s_mov_b32 s47, 0x20000
    s_mov_b32 s51, 0x20000
    s_lshr_b32 s39, s3, 1
    s_cmp_eq_u32 s66, 14
    s_cselect_b32 s39, 0, s39
    s_cmp_eq_u32 s39, 0
    s_cbranch_scc1 L_p0F
    s_sub_u32 s67, s67, 2
    s_min_u32 s67, s67, 6
    s_lshl2_add_u32 s38, s67, s64
    s_mul_i32 s3, s38, 48
    s_mul_i32 s38, s38, 30720
    v_min_u32 v34, 23, v0
    v_lshl_add_u32 v34, v34, 1, s3
    v_min_u32 v40, 1278, v34
    global_load_ushort v132, v40, s[18:19]
    global_load_ushort v133, v40, s[6:7]
    global_load_ushort v134, v40, s[8:9]
    v_and_b32 v34, 6, v32
    v_xor_b32 v34, v34, v33
    v_lshlrev_b32_e64 v34, 4, v34
    v_mul_u32_u24 v35, 1280, v32
    v_add3_u32 v5, v35, v34, s38
    v_xor_b32_e64 v6, 16, v5
    s_mov_b32 s46, 819200
    s_mov_b32 s70, s69
    s_add_u32 s71, s69, 10240
    s_add_u32 s72, s69, 20480
    s_mov_b64 s[44:45], s[10:11]
    s_mov_b64 s[48:49], s[12:13]
    s_branch L_p0j
L_p0F:
    s_mul_i32 s3, s64, 55296
    s_mul_i32 s38, s67, 384
    s_add_u32 s38, s3, s38
    v_and_b32 v34, 2, v32
    v_xor_b32 v34, v34, v33
    v_lshlrev_b32 v34, 4, v34
    v_mul_u32_u24 v35, 3456, v32
    v_add3_u32 v5, v35, v34, s38
    v_xor_b32_e64 v6, 64, v5
    v_add_u32 v6, 27648, v6
    s_mov_b32 s46, 2211840
    s_mul_i32 s70, s68, 221184
    s_add_u32 s71, s70, 128
    s_add_u32 s72, s70, 256
    s_mov_b64 s[44:45], s[24:25]
    s_mov_b64 s[48:49], s[24:25]
L_p0j:
    s_add_u32 m0, s73, 4096
    s_mov_b32 s50, s46
    buffer_load_dwordx4 v5, s[44:47], s70 offen lds
    s_add_u32 m0, s73, 5120
    s_mov_b32 s3, 18448384
    buffer_load_dwordx4 v6, s[48:51], s70 offen lds
    s_add_u32 m0, s73, 6144
    s_load_dword s34, s[36:37], s3
    buffer_load_dwordx4 v5, s[44:47], s71 offen lds
    s_add_u32 m0, s73, 7168
    s_lshl4_add_u32 s3, s65, s66
    buffer_load_dwordx4 v6, s[48:51], s71 offen lds
    s_add_u32 m0, s73, 8192
    s_lshl2_add_u32 s3, s3, s64
    buffer_load_dwordx4 v5, s[44:47], s72 offen lds
    s_add_u32 m0, s73, 9216
    s_lshl_b32 s3, s3, 1
    buffer_load_dwordx4 v6, s[48:51], s72 offen lds
    v_lshrrev_b32 v34, 5, v0
    v_add_u32 v30, s3, v34
    v_and_b32_e64 v39, 31, v0
    v_mul_u32_u24 v36, 1280, v30
    v_lshl_add_u32 v37, v39, 3, v36
    v_lshl_add_u32 v36, v39, 4, v36
    s_mov_b64 s[52:53], s[36:37]
    s_mov_b32 s54, 22151168
    s_mov_b32 s55, 0x20000
    v_and_b32 v1, 15, v0
    v_lshrrev_b32 v34, 1, v1
    v_xor_b32 v34, v34, v2
    v_lshlrev_b32_e64 v34, 4, v34
    v_lshl_add_u32 v7, v1, 7, v34
    v_xor_b32_e64 v9, 64, v7
    v_add_u32 v8, 81920, v7
    v_add_u32 v10, 81920, v9
    v_lshlrev_b32_e64 v21, 4, v0
    s_mov_b32 s3, 0x3f803f80
    v_accvgpr_write_b32 a248, s3
    v_accvgpr_write_b32 a249, s3
    v_accvgpr_write_b32 a250, s3
    v_accvgpr_write_b32 a251, s3
    v_cmp_eq_u32 vcc, 0, v39
    v_lshlrev_b32 v34, 3, v30
    v_add_u32 v34, 17825792, v34
    v_mov_b32 v38, 134217728
    v_cndmask_b32 v30, v38, v34, vcc
    s_and_b32 s35, s2, 1
    s_cmp_eq_u32 s35, 0
    s_cselect_b64 s[56:57], s[14:15], s[16:17]
    s_mov_b32 s58, 819200
    s_mov_b32 s59, 0x20000
    s_mov_b64 s[60:61], s[28:29]
    s_mov_b32 s62, 2211840
    s_mov_b32 s63, 0x20000
    s_and_b32 s0, s2, 6
    s_lshr_b32 s74, s2, 6
    s_lshl1_add_u32 s74, s0, s74
    s_bfe_u32 s75, s2, 0x30003
    v_add_u32 v19, s73, v7
    v_add_u32 v20, s73, v9
    s_mul_i32 s0, s75, 102400
    s_mul_i32 s1, s64, 320
    s_add_u32 s1, s1, 64
    s_and_b32 s1, s1, 0xff80
    s_add_u32 s0, s0, s1
    v_and_b32 v34, 7, v0
    v_xor_b32 v34, v34, v2
    v_lshlrev_b32 v34, 4, v34
    v_lshrrev_b32 v35, 3, v0
    v_mul_u32_u24 v35, 1280, v35
    v_add3_u32 v17, v35, v34, s0
    v_xor_b32_e64 v18, 64, v17
    v_add_u32 v18, 10240, v18
    s_mov_b32 s76, 0
    s_mov_b32 s77, 20480
    s_mov_b32 s78, 40960
    s_mov_b32 s79, 61440
    s_mov_b32 s80, 81920
    s_lshl1_add_u32 s85, s75, s35
    s_mul_i32 s85, s85, 27
    s_mul_i32 s0, s64, 7
    s_add_u32 s85, s85, s0
    s_mul_i32 s85, s85, 5120
    s_add_u32 s85, s85, 19922944
    s_and_b32 s22, s64, 2
    s_mul_i32 s22, s22, 40960
    s_add_u32 s22, s22, 30720
    s_cmp_eq_u32 s39, 0
    s_cbranch_scc0 L_ssm
    v_lshrrev_b32 v40, 2, v1
    v_and_b32 v41, 3, v1
    v_and_b32 v34, 1, v2
    v_lshrrev_b32 v35, 1, v2
    v_lshrrev_b32_e64 v42, 1, v40
    v_lshl_add_u32 v42, v34, 1, v42
    v_mul_u32_u24 v43, 40960, v35
    v_lshl_add_u32 v43, v34, 10, v43
    v_lshl_add_u32 v43, v40, 7, v43
    v_lshl_add_u32 v43, v41, 3, v43
    s_mul_i32 s0, s64, 3
    s_add_u32 s3, s0, 8
    s_and_b32 s38, s3, 3
    s_lshr_b32 s3, s3, 2
    s_lshl_b32 s3, s3, 11
    v_xor_b32 v40, s38, v42
    v_lshlrev_b32_e64 v40, 5, v40
    v_add3_u32 v11, v43, v40, s3
    v_add_u32 v14, 81920, v11
    s_add_u32 s3, s0, 9
    s_and_b32 s38, s3, 3
    s_lshr_b32 s3, s3, 2
    s_lshl_b32 s3, s3, 11
    v_xor_b32 v40, s38, v42
    v_lshlrev_b32 v40, 5, v40
    v_add3_u32 v12, v43, v40, s3
    v_add_u32 v15, 81920, v12
    s_add_u32 s3, s0, 10
    s_and_b32 s38, s3, 3
    s_lshr_b32 s3, s3, 2
    s_lshl_b32 s3, s3, 11
    v_xor_b32 v40, s38, v42
    v_lshlrev_b32 v40, 5, v40
    v_add3_u32 v13, v43, v40, s3
    v_add_u32 v16, 81920, v13
    s_lshl2_add_u32 s0, s67, s64
    s_mul_i32 s3, s65, 770048
    s_mul_i32 s38, s0, 1536
    s_add_u32 s3, s3, s38
    v_mul_u32_u24 v43, 96256, v34
    v_lshl_add_u32 v43, v35, 8, v43
    v_lshl_add_u32 v43, v1, 4, v43
    v_add_u32 v23, s3, v43
    s_and_b32 s81, s65, 3
    s_mul_i32 s82, s65, 9
    s_add_u32 s82, s82, s67
    s_add_u32 s3, s64, 0
    s_mul_i32 s38, s3, 52
    s_lshr_b32 s38, s38, 8
    s_mul_i32 s1, s38, 5
    s_sub_u32 s3, s3, s1
    s_lshl_b32 s3, s3, 6
    s_mul_i32 s1, s82, 3
    s_add_u32 s38, s38, s1
    s_and_b32 s1, s38, 7
    s_lshr_b32 s38, s38, 3
    v_add_u32_e64 v34, s3, v0
    v_mul_u32_u24 v35, 6554, v34
    v_lshrrev_b32_e64 v35, 16, v35
    s_mul_i32 s23, s1, 54
    s_add_u32 s23, s23, s38
    s_mul_i32 s23, s23, 5120
    s_add_u32 s23, s23, 19922944
    v_lshl_add_u32 v68, v34, 4, s23
    v_bfe_u32 v40, v35, 2, 1
    v_bfe_u32 v41, v35, 3, 1
    v_sub_u32_e64 v40, v40, v41
    v_mul_i32_i24 v40, 5120, v40
    s_mul_i32 s38, s38, 40960
    s_mul_i32 s1, s1, 160
    s_add_u32 s38, s38, s1
    v_mul_u32_u24 v35, 1120, v35
    v_lshl_add_u32 v34, v34, 4, v35
    v_add3_u32 v64, v34, v40, s38
    s_add_u32 s3, s64, 4
    s_mul_i32 s38, s3, 52
    s_lshr_b32 s38, s38, 8
    s_mul_i32 s1, s38, 5
    s_sub_u32 s3, s3, s1
    s_lshl_b32 s3, s3, 6
    s_mul_i32 s1, s82, 3
    s_add_u32 s38, s38, s1
    s_and_b32 s1, s38, 7
    s_lshr_b32 s38, s38, 3
    v_add_u32 v34, s3, v0
    v_mul_u32_u24 v35, 6554, v34
    v_lshrrev_b32_e64 v35, 16, v35
    s_mul_i32 s23, s1, 54
    s_add_u32 s23, s23, s38
    s_mul_i32 s23, s23, 5120
    s_add_u32 s23, s23, 19922944
    v_lshl_add_u32 v69, v34, 4, s23
    v_bfe_u32 v40, v35, 2, 1
    v_bfe_u32 v41, v35, 3, 1
    v_sub_u32_e64 v40, v40, v41
    v_mul_i32_i24 v40, 5120, v40
    s_mul_i32 s38, s38, 40960
    s_mul_i32 s1, s1, 160
    s_add_u32 s38, s38, s1
    v_mul_u32_u24 v35, 1120, v35
    v_lshl_add_u32 v34, v34, 4, v35
    v_add3_u32 v65, v34, v40, s38
    s_add_u32 s3, s64, 8
    s_mul_i32 s38, s3, 52
    s_lshr_b32 s38, s38, 8
    s_mul_i32 s1, s38, 5
    s_sub_u32 s3, s3, s1
    s_lshl_b32 s3, s3, 6
    s_mul_i32 s1, s82, 3
    s_add_u32 s38, s38, s1
    s_and_b32 s1, s38, 7
    s_lshr_b32 s38, s38, 3
    v_add_u32 v34, s3, v0
    v_mul_u32_u24 v35, 6554, v34
    v_lshrrev_b32_e64 v35, 16, v35
    s_mul_i32 s23, s1, 54
    s_add_u32 s23, s23, s38
    s_mul_i32 s23, s23, 5120
    s_add_u32 s23, s23, 19922944
    v_lshl_add_u32 v70, v34, 4, s23
    v_bfe_u32 v40, v35, 2, 1
    v_bfe_u32 v41, v35, 3, 1
    v_sub_u32_e64 v40, v40, v41
    v_mul_i32_i24 v40, 5120, v40
    s_mul_i32 s38, s38, 40960
    s_mul_i32 s1, s1, 160
    s_add_u32 s38, s38, s1
    v_mul_u32_u24 v35, 1120, v35
    v_lshl_add_u32 v34, v34, 4, v35
    v_add3_u32 v66, v34, v40, s38
    s_add_u32 s3, s64, 12
    s_mul_i32 s38, s3, 52
    s_lshr_b32 s38, s38, 8
    s_mul_i32 s1, s38, 5
    s_sub_u32 s3, s3, s1
    s_lshl_b32 s3, s3, 6
    s_mul_i32 s1, s82, 3
    s_add_u32 s38, s38, s1
    s_and_b32 s1, s38, 7
    s_lshr_b32 s38, s38, 3
    v_add_u32 v34, s3, v0
    v_mul_u32_u24 v35, 6554, v34
    v_lshrrev_b32_e64 v35, 16, v35
    s_mul_i32 s23, s1, 54
    s_add_u32 s23, s23, s38
    s_mul_i32 s23, s23, 5120
    s_add_u32 s23, s23, 19922944
    v_lshl_add_u32 v71, v34, 4, s23
    v_bfe_u32 v40, v35, 2, 1
    v_bfe_u32 v41, v35, 3, 1
    v_sub_u32_e64 v40, v40, v41
    v_mul_i32_i24 v40, 5120, v40
    s_mul_i32 s38, s38, 40960
    s_mul_i32 s1, s1, 160
    s_add_u32 s38, s38, s1
    v_mul_u32_u24 v35, 1120, v35
    v_lshl_add_u32 v34, v34, 4, v35
    v_add3_u32 v67, v34, v40, s38
    s_cmp_eq_u32 s64, 3
    s_cselect_b32 s3, 134217728, 0
    v_add_u32 v67, s3, v67
    v_add_u32 v71, s3, v71
    s_bitcmp1_b32 s64, 0
    s_cselect_b64 s[8:9], s[16:17], s[14:15]
    s_lshr_b32 s3, s64, 1
    s_lshl1_add_u32 s3, s82, s3
    s_mul_i32 s3, s3, 23
    v_min_u32 v34, 22, v0
    v_add_u32_e64 v34, s3, v34
    v_min_u32 v34, 6399, v34
    v_lshlrev_b32_e64 v72, 7, v34
    s_mul_i32 s0, s0, 96
    v_lshl_add_u32 v34, v2, 3, s0
    s_lshl3_add_u32 s3, s74, s75
    s_lshl1_add_u32 s3, s3, s35
    s_lshl2_add_u32 s3, s3, s64
    s_xor_b32 s3, s3, 4
    s_lshl_b32 s3, s3, 7
    s_add_u32 s3, s3, 18612224
    v_add_u32 v40, s3, v21
    s_lshl4_add_u32 s3, s65, s67
    s_lshl_b32 s3, s3, 7
    s_add_u32 s3, s3, 18087808
    s_cmp_eq_u32 s64, 0
    s_cselect_b32 s3, s3, 134217728
    s_lshl_b32 s38, s82, 7
    s_add_u32 s38, s38, 18481024
    s_cmp_eq_u32 s64, 1
    s_cselect_b32 s3, s38, s3
    v_cmp_gt_u32 vcc, 8, v0
    v_add_u32_e64 v41, s3, v21
    s_nop 0
    v_cndmask_b32 v40, v41, v40, vcc
    s_waitcnt lgkmcnt(0)
    s_mul_i32 s34, s34, 0x9e3779b1
    s_add_u32 s34, s34, 0x7f4a7c15
    s_or_b32 s34, s34, 1
    v_accvgpr_write_b32 a252, s34
    v_accvgpr_write_b32 a253, s34
    v_accvgpr_write_b32 a254, s34
    v_accvgpr_write_b32 a255, s34
    s_mul_i32 s3, s35, 27
    s_mul_i32 s0, s64, 7
    s_add_u32 s3, s3, s0
    s_lshl_b32 s3, s3, 10
    v_add_u32 v202, s3, v21
    buffer_load_dwordx4 v[44:47], v36, s[40:43], 0 offen
    v_accvgpr_write_b32 a108, v202
    s_lshl2_add_u32 s0, s35, s64
    s_mul_i32 s0, s0, 5120
    s_add_u32 s0, s0, 55296
    s_bitcmp1_b32 s64, 0
    s_cselect_b32 s3, 1024, 0
    s_cselect_b32 s1, 0, 4096
    s_add_u32 s3, s3, s0
    v_add_u32 v202, s3, v21
    buffer_load_dwordx4 v[142:145], v36, s[40:43], 0 offen offset:512
    v_accvgpr_write_b32 a109, v202
    s_add_u32 s1, s1, s0
    v_add_u32 v202, s1, v21
    v_accvgpr_write_b32 a110, v202
    v_lshrrev_b32_e64 v200, 1, v2
    buffer_load_dwordx2 v[146:147], v37, s[40:43], 0 offen offset:1024
    v_lshlrev_b32 v200, 4, v200
    v_and_b32 v201, 1, v2
    v_lshl_add_u32 v200, v201, 2, v200
    v_lshrrev_b32_e64 v201, 2, v1
    s_mov_b64 exec, 0xffff
    buffer_store_dwordx4 a[248:251], v40, s[52:55], 0 offen sc1
    s_mov_b64 exec, -1
    v_add_u32 v200, v200, v201
    v_mul_u32_u24 v200, 160, v200
    v_and_b32_e64 v201, 3, v1
    v_lshl_add_u32 v200, v201, 3, v200
    global_load_dwordx2 v[96:97], v34, s[26:27] offset:0
    v_add_u32_e64 v202, s73, v200
    v_accvgpr_write_b32 a111, v202
    s_lshl1_add_u32 s0, s74, s35
    s_mul_i32 s24, s0, 385024
    s_xor_b32 s0, s0, 1
    s_mul_i32 s10, s0, 385024
    s_add_u32 s11, s10, 96256
    global_load_dwordx2 v[98:99], v34, s[26:27] offset:32
    s_add_u32 s12, s10, 192512
    s_add_u32 s13, s10, 288768
    s_add_u32 s25, s24, 96256
    global_load_dwordx2 v[100:101], v34, s[26:27] offset:64
    s_add_u32 s28, s24, 192512
    s_add_u32 s29, s24, 288768
    s_lshl2_add_u32 s0, s35, s64
    s_lshl_b32 s1, s74, 7
    s_add_u32 s0, s0, s1
    s_mul_i32 s1, s75, 160
    s_add_u32 s68, s68, 1
    s_cmp_ge_u32 s68, 10
    s_cselect_b32 s68, 0, s68
    s_mul_i32 s5, s0, 1280
    s_add_u32 s5, s5, s1
    v_add_u32 v200, 0, v0
    v_mul_u32_u24 v201, 6554, v200
    s_lshl_b32 s69, s68, 7
    v_lshrrev_b32 v201, 16, v201
    v_mul_u32_u24 v201, 10080, v201
    v_lshl_add_u32 v202, v200, 4, v201
    v_accvgpr_write_b32 a112, v202
    s_mul_i32 s70, s68, 221184
    v_add_u32_e64 v200, 64, v0
    v_mul_u32_u24 v201, 6554, v200
    v_lshrrev_b32_e64 v201, 16, v201
    s_add_u32 m0, s73, 10240
    v_mul_u32_u24 v201, 10080, v201
    buffer_load_dwordx4 v3, s[40:43], s69 offen offset:0 lds
    v_lshl_add_u32 v202, v200, 4, v201
    v_accvgpr_write_b32 a113, v202
    s_add_u32 m0, s73, 11264
    v_add_u32 v200, 128, v0
    buffer_load_dwordx4 v4, s[40:43], s69 offen offset:0 lds
    v_min_u32 v200, 159, v200
    v_mul_u32_u24 v201, 6554, v200
    v_lshrrev_b32_e64 v201, 16, v201
    s_add_u32 m0, s73, 11008
    v_mul_u32_u24 v201, 10080, v201
    buffer_load_dwordx4 v3, s[40:43], s69 offen offset:1280 lds
    v_lshl_add_u32 v202, v200, 4, v201
    v_accvgpr_write_b32 a114, v202
    v_min_u32_e64 v200, 9, v0
    s_add_u32 m0, s73, 12032
    v_lshl_add_u32 v202, v200, 4, s1
    buffer_load_dwordx4 v4, s[40:43], s69 offen offset:1280 lds
    v_accvgpr_write_b32 a115, v202
    v_and_b32 v201, 12, v0
    v_add_u32 v202, v201, v2
    s_add_u32 m0, s73, 14336
    v_lshl_add_u32 v200, v202, 3, s0
    buffer_load_dwordx4 v5, s[44:47], s70 offen offset:0 lds
    v_accvgpr_write_b32 a116, v202
    v_lshlrev_b32_e64 v200, 3, v200
    v_add_u32 v202, 17825792, v200
    s_add_u32 m0, s73, 15360
    v_accvgpr_write_b32 a117, v202
    buffer_load_dwordx4 v6, s[44:47], s70 offen offset:0 lds
    s_mul_i32 s3, s35, 27
    s_mul_i32 s0, s64, 7
    s_add_u32 s3, s3, s0
    s_mul_i32 s3, s3, 43
    s_lshr_b32 s3, s3, 8
    s_min_u32 s3, s3, 7
    s_lshl4_add_u32 s3, s74, s3
    s_lshl_b32 s3, s3, 7
    s_add_u32 s3, s3, 18087936
    s_add_u32 s14, s36, s3
    s_addc_u32 s15, s37, 0
    v_min_u32 v110, 11, v0
    v_and_b32 v110, 3, v110
    v_lshl_add_u32 v110, s64, 2, v110
    s_add_u32 m0, s73, 16256
    s_mov_b32 s3, 0
    v_min_u32 v111, s3, v110
    v_lshl_add_u32 v111, v111, 4, s66
    buffer_load_dwordx4 v5, s[44:47], s70 offen offset:128 lds
    v_cmp_gt_u32 vcc, 8, v0
    s_lshl_b32 s3, s74, 4
    v_add_u32 v29, s3, v110
    v_cndmask_b32 v111, v29, v111, vcc
    v_cmp_gt_u32 vcc, 4, v0
    s_lshl_b32 s3, s65, 4
    v_add_u32 v110, s3, v110
    v_cndmask_b32 v110, v111, v110, vcc
    v_lshlrev_b32_e64 v110, 7, v110
    v_add_u32 v29, 18415616, v110
    s_add_u32 m0, s73, 17280
    s_and_b32 s3, s64, 1
    s_mul_i32 s23, s3, 5120
    s_add_u32 s23, s23, s22
    buffer_load_dwordx4 v6, s[44:47], s70 offen offset:128 lds
    s_bitcmp1_b32 s64, 0
    s_cselect_b64 vcc, -1, 0
    s_movk_i32 s3, 0x100
    s_cselect_b32 s3, 40832, s3
    v_cndmask_b32 v204, v17, v18, vcc
    v_cndmask_b32 v205, v18, v17, vcc
    v_cndmask_b32 v206, v7, v9, vcc
    v_add_u32_e64 v204, s3, v204
    s_bitcmp1_b32 s64, 0
    s_movk_i32 s3, 0x100
    s_cselect_b32 s3, 61312, s3
    v_add_u32 v205, s3, v205
    v_add_u32 v206, s22, v206
    s_add_u32 m0, s73, 18176
    v_accvgpr_write_b32 a124, v204
    buffer_load_dwordx4 v5, s[44:47], s70 offen offset:256 lds
    v_accvgpr_write_b32 a125, v205
    v_accvgpr_write_b32 a126, v206
    v_add_u32 v22, 4096, v21
    s_add_u32 m0, s73, 19200
    s_mul_i32 s3, s64, 7
    v_min_u32 v31, 6, v0
    v_add_u32 v31, s3, v31
    v_min_u32 v31, 26, v31
    buffer_load_dwordx4 v6, s[44:47], s70 offen offset:256 lds
    s_mul_i32 s3, s35, 216
    s_add_u32 s3, s3, s75
    v_lshl_add_u32 v31, v31, 3, s3
    v_mul_u32_u24 v31, 21846, v31
    v_lshrrev_b32 v31, 16, v31
    v_lshlrev_b32_e64 v31, 7, v31
    v_add_u32 v31, 18481152, v31
    s_lshl_b32 s18, s65, 10
    s_add_u32 s18, s18, 17825792
    s_waitcnt vmcnt(17)
    s_barrier
    ds_read_b64_tr_b16 a[224:225], v11 offset:0
    ds_read_b64_tr_b16 a[226:227], v11 offset:512
    ds_read_b64_tr_b16 a[236:237], v14 offset:0
    ds_read_b64_tr_b16 a[238:239], v14 offset:512
    ds_read_b64_tr_b16 a[228:229], v12 offset:0
    ds_read_b64_tr_b16 a[230:231], v12 offset:512
    ds_read_b64_tr_b16 a[240:241], v15 offset:0
    ds_read_b64_tr_b16 a[242:243], v15 offset:512
    ds_read_b64_tr_b16 a[232:233], v13 offset:0
    ds_read_b64_tr_b16 a[234:235], v13 offset:512
    ds_read_b64_tr_b16 a[244:245], v16 offset:0
    ds_read_b64_tr_b16 a[246:247], v16 offset:512
    ds_read_b128 a[160:163], v7 offset:0
    ds_read_b128 a[164:167], v9 offset:0
    ds_read_b128 a[168:171], v7 offset:2048
    ds_read_b128 a[172:175], v9 offset:2048
    ds_read_b128 a[176:179], v7 offset:40960
    ds_read_b128 a[180:183], v9 offset:40960
    ds_read_b128 a[184:187], v7 offset:43008
    ds_read_b128 a[188:191], v9 offset:43008
    s_waitcnt lgkmcnt(0)
    v_mfma_f32_16x16x32_bf16 v[160:163], a[224:227], a[160:163], 0
    ds_read_b128 a[192:195], v8 offset:0
    v_mfma_f32_16x16x32_bf16 v[160:163], a[236:239], a[164:167], v[160:163]
    s_add_u32 s68, s68, 1
    s_cmp_ge_u32 s68, 10
    s_cselect_b32 s68, 0, s68
    v_mfma_f32_16x16x32_bf16 v[164:167], a[240:243], a[164:167], 0
    ds_read_b128 a[196:199], v10 offset:0
    v_mfma_f32_16x16x32_bf16 v[164:167], a[228:231], a[160:163], v[164:167]
    ds_read_b128 a[200:203], v8 offset:2048
    v_mfma_f32_16x16x32_bf16 v[168:171], a[232:235], a[160:163], 0
    v_mfma_f32_16x16x32_bf16 v[168:171], a[244:247], a[164:167], v[168:171]
    s_lshl_b32 s69, s68, 7
    ds_read_b128 a[204:207], v10 offset:2048
    v_mfma_f32_16x16x32_bf16 v[180:183], a[244:247], a[172:175], 0
    v_mfma_f32_16x16x32_bf16 v[180:183], a[232:235], a[168:171], v[180:183]
    ds_read_b128 a[208:211], v8 offset:40960
    v_mfma_f32_16x16x32_bf16 v[176:179], a[228:231], a[168:171], 0
    s_mul_i32 s70, s68, 221184
    v_mfma_f32_16x16x32_bf16 v[176:179], a[240:243], a[172:175], v[176:179]
    ds_read_b128 a[212:215], v10 offset:40960
    v_mfma_f32_16x16x32_bf16 v[172:175], a[236:239], a[172:175], 0
    ds_read_b128 a[216:219], v8 offset:43008
    v_mfma_f32_16x16x32_bf16 v[172:175], a[224:227], a[168:171], v[172:175]
    s_add_u32 m0, s73, 20480
    v_mfma_f32_16x16x32_bf16 v[184:187], a[224:227], a[176:179], 0
    buffer_load_dwordx4 v3, s[40:43], s69 offen offset:0 lds
    v_mfma_f32_16x16x32_bf16 v[184:187], a[236:239], a[180:183], v[184:187]
    ds_read_b128 a[220:223], v10 offset:43008
    v_mfma_f32_16x16x32_bf16 v[188:191], a[240:243], a[180:183], 0
    v_mfma_f32_16x16x32_bf16 v[188:191], a[228:231], a[176:179], v[188:191]
    s_add_u32 m0, s73, 21504
    v_mfma_f32_16x16x32_bf16 v[192:195], a[232:235], a[176:179], 0
    buffer_load_dwordx4 v4, s[40:43], s69 offen offset:0 lds
    v_mfma_f32_16x16x32_bf16 v[192:195], a[244:247], a[180:183], v[192:195]
    v_mfma_f32_16x16x32_bf16 v[204:207], a[244:247], a[188:191], 0
    v_mfma_f32_16x16x32_bf16 v[204:207], a[232:235], a[184:187], v[204:207]
    s_add_u32 m0, s73, 21248
    v_mfma_f32_16x16x32_bf16 v[200:203], a[228:231], a[184:187], 0
    buffer_load_dwordx4 v3, s[40:43], s69 offen offset:1280 lds
    v_mfma_f32_16x16x32_bf16 v[200:203], a[240:243], a[188:191], v[200:203]
    v_mfma_f32_16x16x32_bf16 v[196:199], a[236:239], a[188:191], 0
    v_mfma_f32_16x16x32_bf16 v[196:199], a[224:227], a[184:187], v[196:199]
    s_add_u32 m0, s73, 22272
    s_waitcnt vmcnt(17)
    buffer_load_dwordx4 v4, s[40:43], s69 offen offset:1280 lds
    v_lshlrev_b32 v32, 16, v44
    v_and_b32 v33, 0xffff0000, v44
    v_lshlrev_b32_e64 v34, 16, v45
    v_and_b32 v35, 0xffff0000, v45
    v_lshlrev_b32_e64 v36, 16, v46
    v_and_b32 v37, 0xffff0000, v46
    v_lshlrev_b32_e64 v38, 16, v47
    v_and_b32 v39, 0xffff0000, v47
    v_lshlrev_b32_e64 v40, 16, v142
    v_and_b32 v41, 0xffff0000, v142
    s_add_u32 m0, s73, 24576
    v_lshlrev_b32_e64 v42, 16, v143
    buffer_load_dwordx4 v5, s[44:47], s70 offen offset:0 lds
    v_and_b32 v43, 0xffff0000, v143
    v_lshlrev_b32_e64 v132, 16, v144
    v_and_b32 v133, 0xffff0000, v144
    v_lshlrev_b32_e64 v134, 16, v145
    v_and_b32 v135, 0xffff0000, v145
    v_lshlrev_b32_e64 v136, 16, v146
    v_and_b32 v137, 0xffff0000, v146
    v_lshlrev_b32_e64 v138, 16, v147
    v_and_b32 v139, 0xffff0000, v147
    v_pk_add_f32 v[140:141], v[32:33], v[34:35]
    v_pk_add_f32 v[140:141], v[140:141], v[36:37]
    s_add_u32 m0, s73, 25600
    v_pk_add_f32 v[140:141], v[140:141], v[38:39]
    buffer_load_dwordx4 v6, s[44:47], s70 offen offset:0 lds
    v_pk_add_f32 v[140:141], v[140:141], v[40:41]
    v_pk_add_f32 v[140:141], v[140:141], v[42:43]
    v_pk_add_f32 v[140:141], v[140:141], v[132:133]
    v_pk_add_f32 v[140:141], v[140:141], v[134:135]
    v_pk_add_f32 v[140:141], v[140:141], v[136:137]
    v_pk_add_f32 v[140:141], v[140:141], v[138:139]
    v_add_f32 v140, v140, v141
    s_nop 1
    v_add_f32_dpp v140, v140, v140 row_ror:8 row_mask:0xf bank_mask:0xf
    s_nop 1
    v_add_f32_dpp v140, v140, v140 row_ror:4 row_mask:0xf bank_mask:0xf
    s_nop 1
    v_add_f32_dpp v140, v140, v140 row_ror:2 row_mask:0xf bank_mask:0xf
    s_add_u32 m0, s73, 26496
    s_nop 0
    v_add_f32_dpp v140, v140, v140 row_ror:1 row_mask:0xf bank_mask:0xf
    buffer_load_dwordx4 v5, s[44:47], s70 offen offset:128 lds
    v_mov_b32 v141, v140
    s_nop 1
    v_permlane16_swap_b32 v140, v141
    v_add_f32_e64 v140, v140, v141
    v_mul_f32 v140, 0x3acccccd, v140
    v_cvt_pk_bf16_f32 v44, v140, v140
    v_lshlrev_b32_e64 v44, 16, v44
    v_pk_add_f32 v[32:33], v[32:33], v[140:141] op_sel_hi:[1,0] neg_lo:[0,1] neg_hi:[0,1]
    v_pk_add_f32 v[34:35], v[34:35], v[140:141] op_sel_hi:[1,0] neg_lo:[0,1] neg_hi:[0,1]
    v_pk_add_f32 v[36:37], v[36:37], v[140:141] op_sel_hi:[1,0] neg_lo:[0,1] neg_hi:[0,1]
    v_pk_add_f32 v[38:39], v[38:39], v[140:141] op_sel_hi:[1,0] neg_lo:[0,1] neg_hi:[0,1]
    v_pk_add_f32 v[40:41], v[40:41], v[140:141] op_sel_hi:[1,0] neg_lo:[0,1] neg_hi:[0,1]
    s_add_u32 m0, s73, 27520
    v_pk_add_f32 v[42:43], v[42:43], v[140:141] op_sel_hi:[1,0] neg_lo:[0,1] neg_hi:[0,1]
    buffer_load_dwordx4 v6, s[44:47], s70 offen offset:128 lds
    v_pk_add_f32 v[132:133], v[132:133], v[140:141] op_sel_hi:[1,0] neg_lo:[0,1] neg_hi:[0,1]
    v_pk_add_f32 v[134:135], v[134:135], v[140:141] op_sel_hi:[1,0] neg_lo:[0,1] neg_hi:[0,1]
    v_pk_add_f32 v[136:137], v[136:137], v[140:141] op_sel_hi:[1,0] neg_lo:[0,1] neg_hi:[0,1]
    v_pk_add_f32 v[138:139], v[138:139], v[140:141] op_sel_hi:[1,0] neg_lo:[0,1] neg_hi:[0,1]
    v_pk_mul_f32 v[140:141], v[32:33], v[32:33]
    v_pk_fma_f32 v[140:141], v[34:35], v[34:35], v[140:141]
    v_pk_fma_f32 v[140:141], v[36:37], v[36:37], v[140:141]
    v_pk_fma_f32 v[140:141], v[38:39], v[38:39], v[140:141]
    v_pk_fma_f32 v[140:141], v[40:41], v[40:41], v[140:141]
    v_pk_fma_f32 v[140:141], v[42:43], v[42:43], v[140:141]
    s_add_u32 m0, s73, 28416
    v_pk_fma_f32 v[140:141], v[132:133], v[132:133], v[140:141]
    buffer_load_dwordx4 v5, s[44:47], s70 offen offset:256 lds
    v_pk_fma_f32 v[140:141], v[134:135], v[134:135], v[140:141]
    v_pk_fma_f32 v[140:141], v[136:137], v[136:137], v[140:141]
    v_pk_fma_f32 v[140:141], v[138:139], v[138:139], v[140:141]
    v_add_f32 v140, v140, v141
    s_nop 1
    v_add_f32_dpp v140, v140, v140 row_ror:8 row_mask:0xf bank_mask:0xf
    s_nop 1
    v_add_f32_dpp v140, v140, v140 row_ror:4 row_mask:0xf bank_mask:0xf
    s_nop 1
    v_add_f32_dpp v140, v140, v140 row_ror:2 row_mask:0xf bank_mask:0xf
    s_nop 1
    v_add_f32_dpp v140, v140, v140 row_ror:1 row_mask:0xf bank_mask:0xf
    v_mov_b32 v141, v140
    s_nop 1
    v_permlane16_swap_b32 v140, v141
    v_add_f32_e64 v140, v140, v141
    s_add_u32 m0, s73, 29440
    v_mul_f32 v140, 0x3acccccd, v140
    buffer_load_dwordx4 v6, s[44:47], s70 offen offset:256 lds
    v_cvt_pk_bf16_f32 v140, v140, v140
    v_lshlrev_b32_e64 v140, 16, v140
    v_add_f32 v140, 0x3727c5ac, v140
    v_cvt_pk_bf16_f32 v140, v140, v140
    v_lshlrev_b32 v140, 16, v140
    v_sqrt_f32_e64 v140, v140
    s_nop 0
    v_cvt_pk_bf16_f32 v140, v140, v140
    v_lshlrev_b32 v140, 16, v140
    v_rcp_f32_e64 v45, v140
    s_nop 0
    buffer_store_dwordx2 v[44:45], v30, s[52:55], 0 offen sc1
    s_waitcnt vmcnt(11) lgkmcnt(0)
    s_barrier
    v_mfma_f32_16x16x32_bf16 v[156:159], a[232:235], a[248:251], 0
    ds_read_b64_tr_b16 a[136:137], v11 offset:10240
    v_mfma_f32_16x16x32_bf16 v[156:159], a[244:247], a[248:251], v[156:159]
    s_add_u32 s68, s68, 1
    s_cmp_ge_u32 s68, 10
    s_cselect_b32 s68, 0, s68
    v_mfma_f32_16x16x32_bf16 v[152:155], a[240:243], a[248:251], 0
    ds_read_b64_tr_b16 a[138:139], v11 offset:10752
    ds_read_b64_tr_b16 a[148:149], v14 offset:10240
    v_mfma_f32_16x16x32_bf16 v[152:155], a[228:231], a[248:251], v[152:155]
    ds_read_b64_tr_b16 a[150:151], v14 offset:10752
    v_mfma_f32_16x16x32_bf16 v[148:151], a[224:227], a[248:251], 0
    ds_read_b64_tr_b16 a[140:141], v12 offset:10240
    v_mfma_f32_16x16x32_bf16 v[148:151], a[236:239], a[248:251], v[148:151]
    s_lshl_b32 s69, s68, 7
    ds_read_b64_tr_b16 a[142:143], v12 offset:10752
    v_mfma_f32_16x16x32_bf16 v[208:211], a[236:239], a[196:199], 0
    ds_read_b64_tr_b16 a[152:153], v15 offset:10240
    v_mfma_f32_16x16x32_bf16 v[208:211], a[224:227], a[192:195], v[208:211]
    ds_read_b64_tr_b16 a[154:155], v15 offset:10752
    v_mfma_f32_16x16x32_bf16 v[212:215], a[228:231], a[192:195], 0
    s_mul_i32 s70, s68, 221184
    v_mfma_f32_16x16x32_bf16 v[212:215], a[240:243], a[196:199], v[212:215]
    ds_read_b64_tr_b16 a[144:145], v13 offset:10240
    v_mfma_f32_16x16x32_bf16 v[216:219], a[244:247], a[196:199], 0
    ds_read_b64_tr_b16 a[146:147], v13 offset:10752
    v_mfma_f32_16x16x32_bf16 v[216:219], a[232:235], a[192:195], v[216:219]
    ds_read_b64_tr_b16 a[156:157], v16 offset:10240
    s_add_u32 m0, s73, 0
    v_mfma_f32_16x16x32_bf16 v[228:231], a[232:235], a[200:203], 0
    buffer_load_dwordx4 v3, s[40:43], s69 offen offset:0 lds
    v_mfma_f32_16x16x32_bf16 v[228:231], a[244:247], a[204:207], v[228:231]
    ds_read_b64_tr_b16 a[158:159], v16 offset:10752
    ds_read_b128 a[160:163], v7 offset:10240
    v_mfma_f32_16x16x32_bf16 v[224:227], a[240:243], a[204:207], 0
    ds_read_b128 a[164:167], v9 offset:10240
    s_add_u32 m0, s73, 1024
    v_mfma_f32_16x16x32_bf16 v[224:227], a[228:231], a[200:203], v[224:227]
    buffer_load_dwordx4 v4, s[40:43], s69 offen offset:0 lds
    v_mfma_f32_16x16x32_bf16 v[220:223], a[224:227], a[200:203], 0
    ds_read_b128 a[168:171], v7 offset:12288
    ds_read_b128 a[172:175], v9 offset:12288
    v_mfma_f32_16x16x32_bf16 v[220:223], a[236:239], a[204:207], v[220:223]
    v_mfma_f32_16x16x32_bf16 v[232:235], a[236:239], a[212:215], 0
    ds_read_b128 a[176:179], v7 offset:51200
    s_add_u32 m0, s73, 768
    v_mfma_f32_16x16x32_bf16 v[232:235], a[224:227], a[208:211], v[232:235]
    buffer_load_dwordx4 v3, s[40:43], s69 offen offset:1280 lds
    v_mfma_f32_16x16x32_bf16 v[236:239], a[228:231], a[208:211], 0
    ds_read_b128 a[180:183], v9 offset:51200
    ds_read_b128 a[184:187], v7 offset:53248
    v_mfma_f32_16x16x32_bf16 v[236:239], a[240:243], a[212:215], v[236:239]
    ds_read_b128 a[188:191], v9 offset:53248
    s_add_u32 m0, s73, 1792
    v_mfma_f32_16x16x32_bf16 v[240:243], a[244:247], a[212:215], 0
    buffer_load_dwordx4 v4, s[40:43], s69 offen offset:1280 lds
    v_mfma_f32_16x16x32_bf16 v[240:243], a[232:235], a[208:211], v[240:243]
    v_mfma_f32_16x16x32_bf16 v[252:255], a[232:235], a[216:219], 0
    v_mfma_f32_16x16x32_bf16 v[252:255], a[244:247], a[220:223], v[252:255]
    s_add_u32 m0, s73, 4096
    v_mfma_f32_16x16x32_bf16 v[248:251], a[240:243], a[220:223], 0
    buffer_load_dwordx4 v5, s[44:47], s70 offen offset:0 lds
    v_mfma_f32_16x16x32_bf16 v[248:251], a[228:231], a[216:219], v[248:251]
    v_mfma_f32_16x16x32_bf16 v[244:247], a[224:227], a[216:219], 0
    v_mfma_f32_16x16x32_bf16 v[244:247], a[236:239], a[220:223], v[244:247]
    s_waitcnt lgkmcnt(0)
    v_mfma_f32_16x16x32_bf16 v[160:163], a[136:139], a[160:163], v[160:163]
    ds_read_b128 a[192:195], v8 offset:10240
    s_add_u32 m0, s73, 5120
    v_mfma_f32_16x16x32_bf16 v[160:163], a[148:151], a[164:167], v[160:163]
    buffer_load_dwordx4 v6, s[44:47], s70 offen offset:0 lds
    v_mfma_f32_16x16x32_bf16 v[164:167], a[152:155], a[164:167], v[164:167]
    ds_read_b128 a[196:199], v10 offset:10240
    v_lshlrev_b32_e64 v84, 16, v96
    v_mfma_f32_16x16x32_bf16 v[164:167], a[140:143], a[160:163], v[164:167]
    ds_read_b128 a[200:203], v8 offset:12288
    v_and_b32 v85, 0xffff0000, v96
    v_mfma_f32_16x16x32_bf16 v[168:171], a[144:147], a[160:163], v[168:171]
    v_lshlrev_b32_e64 v86, 16, v97
    s_add_u32 m0, s73, 6016
    v_mfma_f32_16x16x32_bf16 v[168:171], a[156:159], a[164:167], v[168:171]
    buffer_load_dwordx4 v5, s[44:47], s70 offen offset:128 lds
    v_mfma_f32_16x16x32_bf16 v[180:183], a[156:159], a[172:175], v[180:183]
    ds_read_b128 a[204:207], v10 offset:12288
    v_and_b32 v87, 0xffff0000, v97
    v_mfma_f32_16x16x32_bf16 v[180:183], a[144:147], a[168:171], v[180:183]
    ds_read_b128 a[208:211], v8 offset:51200
    v_lshlrev_b32_e64 v88, 16, v98
    v_mfma_f32_16x16x32_bf16 v[176:179], a[140:143], a[168:171], v[176:179]
    v_mfma_f32_16x16x32_bf16 v[176:179], a[152:155], a[172:175], v[176:179]
    ds_read_b128 a[212:215], v10 offset:51200
    s_add_u32 m0, s73, 7040
    v_mfma_f32_16x16x32_bf16 v[172:175], a[148:151], a[172:175], v[172:175]
    buffer_load_dwordx4 v6, s[44:47], s70 offen offset:128 lds
    v_mfma_f32_16x16x32_bf16 v[172:175], a[136:139], a[168:171], v[172:175]
    ds_read_b128 a[216:219], v8 offset:53248
    v_and_b32 v89, 0xffff0000, v98
    v_mfma_f32_16x16x32_bf16 v[184:187], a[136:139], a[176:179], v[184:187]
    ds_read_b128 a[220:223], v10 offset:53248
    v_lshlrev_b32_e64 v90, 16, v99
    v_mfma_f32_16x16x32_bf16 v[184:187], a[148:151], a[180:183], v[184:187]
    v_and_b32 v91, 0xffff0000, v99
    s_add_u32 m0, s73, 7936
    v_mfma_f32_16x16x32_bf16 v[188:191], a[152:155], a[180:183], v[188:191]
    buffer_load_dwordx4 v5, s[44:47], s70 offen offset:256 lds
    v_mfma_f32_16x16x32_bf16 v[188:191], a[140:143], a[176:179], v[188:191]
    v_lshlrev_b32_e64 v92, 16, v100
    v_mfma_f32_16x16x32_bf16 v[192:195], a[144:147], a[176:179], v[192:195]
    v_and_b32 v93, 0xffff0000, v100
    v_mfma_f32_16x16x32_bf16 v[192:195], a[156:159], a[180:183], v[192:195]
    v_mfma_f32_16x16x32_bf16 v[204:207], a[156:159], a[188:191], v[204:207]
    v_lshlrev_b32_e64 v94, 16, v101
    s_add_u32 m0, s73, 8960
    v_mfma_f32_16x16x32_bf16 v[204:207], a[144:147], a[184:187], v[204:207]
    buffer_load_dwordx4 v6, s[44:47], s70 offen offset:256 lds
    v_mfma_f32_16x16x32_bf16 v[200:203], a[140:143], a[184:187], v[200:203]
    v_and_b32 v95, 0xffff0000, v101
    v_mfma_f32_16x16x32_bf16 v[200:203], a[152:155], a[188:191], v[200:203]
    v_mfma_f32_16x16x32_bf16 v[196:199], a[148:151], a[188:191], v[196:199]
    s_cmp_lg_u32 s81, 0
    s_cbranch_scc1 L_rl0
    global_load_dword a106, v72, s[8:9]
    buffer_load_dwordx4 a[0:3], v64, s[60:63], 0 offen
    buffer_load_dwordx4 a[4:7], v65, s[60:63], 0 offen
    buffer_load_dwordx4 a[8:11], v66, s[60:63], 0 offen
    buffer_load_dwordx4 a[12:15], v67, s[60:63], 0 offen
L_rl0:
    v_mfma_f32_16x16x32_bf16 v[196:199], a[136:139], a[184:187], v[196:199]
    s_waitcnt vmcnt(11) lgkmcnt(0)
    s_barrier
    v_mfma_f32_16x16x32_bf16 v[156:159], a[144:147], a[248:251], v[156:159]
    ds_read_b64_tr_b16 a[224:225], v11 offset:20480
    s_cmp_lg_u32 s81, 1
    s_cbranch_scc1 L_rl1
    global_load_dword a106, v72, s[8:9]
    buffer_load_dwordx4 a[0:3], v64, s[60:63], 0 offen
    buffer_load_dwordx4 a[4:7], v65, s[60:63], 0 offen
    buffer_load_dwordx4 a[8:11], v66, s[60:63], 0 offen
    buffer_load_dwordx4 a[12:15], v67, s[60:63], 0 offen
L_rl1:
    v_mfma_f32_16x16x32_bf16 v[156:159], a[156:159], a[248:251], v[156:159]
    s_add_u32 s68, s68, 1
    s_cmp_ge_u32 s68, 10
    s_cselect_b32 s68, 0, s68
    v_mfma_f32_16x16x32_bf16 v[152:155], a[152:155], a[248:251], v[152:155]
    ds_read_b64_tr_b16 a[226:227], v11 offset:20992
    ds_read_b64_tr_b16 a[236:237], v14 offset:20480
    v_mfma_f32_16x16x32_bf16 v[152:155], a[140:143], a[248:251], v[152:155]
    ds_read_b64_tr_b16 a[238:239], v14 offset:20992
    v_mfma_f32_16x16x32_bf16 v[148:151], a[136:139], a[248:251], v[148:151]
    ds_read_b64_tr_b16 a[228:229], v12 offset:20480
    v_mfma_f32_16x16x32_bf16 v[148:151], a[148:151], a[248:251], v[148:151]
    s_lshl_b32 s69, s68, 7
    ds_read_b64_tr_b16 a[230:231], v12 offset:20992
    v_mfma_f32_16x16x32_bf16 v[208:211], a[148:151], a[196:199], v[208:211]
    ds_read_b64_tr_b16 a[240:241], v15 offset:20480
    v_mfma_f32_16x16x32_bf16 v[208:211], a[136:139], a[192:195], v[208:211]
    ds_read_b64_tr_b16 a[242:243], v15 offset:20992
    v_mfma_f32_16x16x32_bf16 v[212:215], a[140:143], a[192:195], v[212:215]
    s_mul_i32 s70, s68, 221184
    v_mfma_f32_16x16x32_bf16 v[212:215], a[152:155], a[196:199], v[212:215]
    ds_read_b64_tr_b16 a[232:233], v13 offset:20480
    v_mfma_f32_16x16x32_bf16 v[216:219], a[156:159], a[196:199], v[216:219]
    ds_read_b64_tr_b16 a[234:235], v13 offset:20992
    v_mfma_f32_16x16x32_bf16 v[216:219], a[144:147], a[192:195], v[216:219]
    ds_read_b64_tr_b16 a[244:245], v16 offset:20480
    s_add_u32 m0, s73, 10240
    v_mfma_f32_16x16x32_bf16 v[228:231], a[144:147], a[200:203], v[228:231]
    buffer_load_dwordx4 v3, s[40:43], s69 offen offset:0 lds
    v_mfma_f32_16x16x32_bf16 v[228:231], a[156:159], a[204:207], v[228:231]
    ds_read_b64_tr_b16 a[246:247], v16 offset:20992
    ds_read_b128 a[160:163], v7 offset:20480
    v_mfma_f32_16x16x32_bf16 v[224:227], a[152:155], a[204:207], v[224:227]
    ds_read_b128 a[164:167], v9 offset:20480
    s_add_u32 m0, s73, 11264
    v_mfma_f32_16x16x32_bf16 v[224:227], a[140:143], a[200:203], v[224:227]
    buffer_load_dwordx4 v4, s[40:43], s69 offen offset:0 lds
    v_mfma_f32_16x16x32_bf16 v[220:223], a[136:139], a[200:203], v[220:223]
    ds_read_b128 a[168:171], v7 offset:22528
    ds_read_b128 a[172:175], v9 offset:22528
    v_mfma_f32_16x16x32_bf16 v[220:223], a[148:151], a[204:207], v[220:223]
    v_mfma_f32_16x16x32_bf16 v[232:235], a[148:151], a[212:215], v[232:235]
    ds_read_b128 a[176:179], v7 offset:61440
    s_add_u32 m0, s73, 11008
    v_mfma_f32_16x16x32_bf16 v[232:235], a[136:139], a[208:211], v[232:235]
    buffer_load_dwordx4 v3, s[40:43], s69 offen offset:1280 lds
    v_mfma_f32_16x16x32_bf16 v[236:239], a[140:143], a[208:211], v[236:239]
    ds_read_b128 a[180:183], v9 offset:61440
    ds_read_b128 a[184:187], v7 offset:63488
    v_mfma_f32_16x16x32_bf16 v[236:239], a[152:155], a[212:215], v[236:239]
    ds_read_b128 a[188:191], v9 offset:63488
    s_add_u32 m0, s73, 12032
    v_mfma_f32_16x16x32_bf16 v[240:243], a[156:159], a[212:215], v[240:243]
    buffer_load_dwordx4 v4, s[40:43], s69 offen offset:1280 lds
    v_mfma_f32_16x16x32_bf16 v[240:243], a[144:147], a[208:211], v[240:243]
    v_mfma_f32_16x16x32_bf16 v[252:255], a[144:147], a[216:219], v[252:255]
    v_mfma_f32_16x16x32_bf16 v[252:255], a[156:159], a[220:223], v[252:255]
    s_add_u32 m0, s73, 14336
    v_mfma_f32_16x16x32_bf16 v[248:251], a[152:155], a[220:223], v[248:251]
    buffer_load_dwordx4 v5, s[44:47], s70 offen offset:0 lds
    v_mfma_f32_16x16x32_bf16 v[248:251], a[140:143], a[216:219], v[248:251]
    v_mfma_f32_16x16x32_bf16 v[244:247], a[136:139], a[216:219], v[244:247]
    v_mfma_f32_16x16x32_bf16 v[244:247], a[148:151], a[220:223], v[244:247]
    s_waitcnt lgkmcnt(0)
    v_mfma_f32_16x16x32_bf16 v[160:163], a[224:227], a[160:163], v[160:163]
    ds_read_b128 a[192:195], v8 offset:20480
    s_cmp_lg_u32 s81, 2
    s_cbranch_scc1 L_rl2
    global_load_dword a106, v72, s[8:9]
    buffer_load_dwordx4 a[0:3], v64, s[60:63], 0 offen
    buffer_load_dwordx4 a[4:7], v65, s[60:63], 0 offen
    buffer_load_dwordx4 a[8:11], v66, s[60:63], 0 offen
    buffer_load_dwordx4 a[12:15], v67, s[60:63], 0 offen
L_rl2:
    s_add_u32 m0, s73, 15360
    v_mfma_f32_16x16x32_bf16 v[160:163], a[236:239], a[164:167], v[160:163]
    buffer_load_dwordx4 v6, s[44:47], s70 offen offset:0 lds
    v_mfma_f32_16x16x32_bf16 v[164:167], a[240:243], a[164:167], v[164:167]
    ds_read_b128 a[196:199], v10 offset:20480
    v_mfma_f32_16x16x32_bf16 v[164:167], a[228:231], a[160:163], v[164:167]
    ds_read_b128 a[200:203], v8 offset:22528
    v_mfma_f32_16x16x32_bf16 v[168:171], a[232:235], a[160:163], v[168:171]
    s_add_u32 m0, s73, 16256
    v_mfma_f32_16x16x32_bf16 v[168:171], a[244:247], a[164:167], v[168:171]
    buffer_load_dwordx4 v5, s[44:47], s70 offen offset:128 lds
    v_mfma_f32_16x16x32_bf16 v[180:183], a[244:247], a[172:175], v[180:183]
    ds_read_b128 a[204:207], v10 offset:22528
    v_mfma_f32_16x16x32_bf16 v[180:183], a[232:235], a[168:171], v[180:183]
    ds_read_b128 a[208:211], v8 offset:61440
    v_mfma_f32_16x16x32_bf16 v[176:179], a[228:231], a[168:171], v[176:179]
    v_mfma_f32_16x16x32_bf16 v[176:179], a[240:243], a[172:175], v[176:179]
    ds_read_b128 a[212:215], v10 offset:61440
    s_add_u32 m0, s73, 17280
    v_mfma_f32_16x16x32_bf16 v[172:175], a[236:239], a[172:175], v[172:175]
    buffer_load_dwordx4 v6, s[44:47], s70 offen offset:128 lds
    v_mfma_f32_16x16x32_bf16 v[172:175], a[224:227], a[168:171], v[172:175]
    ds_read_b128 a[216:219], v8 offset:63488
    v_mfma_f32_16x16x32_bf16 v[184:187], a[224:227], a[176:179], v[184:187]
    ds_read_b128 a[220:223], v10 offset:63488
    v_mfma_f32_16x16x32_bf16 v[184:187], a[236:239], a[180:183], v[184:187]
    s_add_u32 m0, s73, 18176
    v_mfma_f32_16x16x32_bf16 v[188:191], a[240:243], a[180:183], v[188:191]
    buffer_load_dwordx4 v5, s[44:47], s70 offen offset:256 lds
    v_mfma_f32_16x16x32_bf16 v[188:191], a[228:231], a[176:179], v[188:191]
    v_mfma_f32_16x16x32_bf16 v[192:195], a[232:235], a[176:179], v[192:195]
    v_mfma_f32_16x16x32_bf16 v[192:195], a[244:247], a[180:183], v[192:195]
    v_mfma_f32_16x16x32_bf16 v[204:207], a[244:247], a[188:191], v[204:207]
    s_add_u32 m0, s73, 19200
    v_mfma_f32_16x16x32_bf16 v[204:207], a[232:235], a[184:187], v[204:207]
    buffer_load_dwordx4 v6, s[44:47], s70 offen offset:256 lds
    v_mfma_f32_16x16x32_bf16 v[200:203], a[228:231], a[184:187], v[200:203]
    v_mfma_f32_16x16x32_bf16 v[200:203], a[240:243], a[188:191], v[200:203]
    v_mfma_f32_16x16x32_bf16 v[196:199], a[236:239], a[188:191], v[196:199]
    v_mfma_f32_16x16x32_bf16 v[196:199], a[224:227], a[184:187], v[196:199]
    s_waitcnt vmcnt(10) lgkmcnt(0)
    s_barrier
    v_mfma_f32_16x16x32_bf16 v[156:159], a[232:235], a[248:251], v[156:159]
    ds_read_b64_tr_b16 a[136:137], v11 offset:0
    s_cmp_lg_u32 s81, 3
    s_cbranch_scc1 L_rl3
    global_load_dword a106, v72, s[8:9]
    buffer_load_dwordx4 a[0:3], v64, s[60:63], 0 offen
    buffer_load_dwordx4 a[4:7], v65, s[60:63], 0 offen
    buffer_load_dwordx4 a[8:11], v66, s[60:63], 0 offen
    buffer_load_dwordx4 a[12:15], v67, s[60:63], 0 offen
L_rl3:
    v_mfma_f32_16x16x32_bf16 v[156:159], a[244:247], a[248:251], v[156:159]
    s_add_u32 s68, s68, 1
    s_cmp_ge_u32 s68, 10
    s_cselect_b32 s68, 0, s68
    v_mfma_f32_16x16x32_bf16 v[152:155], a[240:243], a[248:251], v[152:155]
    ds_read_b64_tr_b16 a[138:139], v11 offset:512
    ds_read_b64_tr_b16 a[148:149], v14 offset:0
    v_mfma_f32_16x16x32_bf16 v[152:155], a[228:231], a[248:251], v[152:155]
    ds_read_b64_tr_b16 a[150:151], v14 offset:512
    v_mfma_f32_16x16x32_bf16 v[148:151], a[224:227], a[248:251], v[148:151]
    ds_read_b64_tr_b16 a[140:141], v12 offset:0
    v_mfma_f32_16x16x32_bf16 v[148:151], a[236:239], a[248:251], v[148:151]
    s_lshl_b32 s69, s68, 7
    ds_read_b64_tr_b16 a[142:143], v12 offset:512
    v_mfma_f32_16x16x32_bf16 v[208:211], a[236:239], a[196:199], v[208:211]
    ds_read_b64_tr_b16 a[152:153], v15 offset:0
    v_mfma_f32_16x16x32_bf16 v[208:211], a[224:227], a[192:195], v[208:211]
    ds_read_b64_tr_b16 a[154:155], v15 offset:512
    v_mfma_f32_16x16x32_bf16 v[212:215], a[228:231], a[192:195], v[212:215]
    s_mul_i32 s70, s68, 221184
    v_mfma_f32_16x16x32_bf16 v[212:215], a[240:243], a[196:199], v[212:215]
    ds_read_b64_tr_b16 a[144:145], v13 offset:0
    v_mfma_f32_16x16x32_bf16 v[216:219], a[244:247], a[196:199], v[216:219]
    ds_read_b64_tr_b16 a[146:147], v13 offset:512
    v_mfma_f32_16x16x32_bf16 v[216:219], a[232:235], a[192:195], v[216:219]
    ds_read_b64_tr_b16 a[156:157], v16 offset:0
    s_add_u32 m0, s73, 20480
    v_mfma_f32_16x16x32_bf16 v[228:231], a[232:235], a[200:203], v[228:231]
    buffer_load_dwordx4 v3, s[40:43], s69 offen offset:0 lds
    v_mfma_f32_16x16x32_bf16 v[228:231], a[244:247], a[204:207], v[228:231]
    ds_read_b64_tr_b16 a[158:159], v16 offset:512
    ds_read_b128 a[160:163], v7 offset:0
    v_mfma_f32_16x16x32_bf16 v[224:227], a[240:243], a[204:207], v[224:227]
    ds_read_b128 a[164:167], v9 offset:0
    s_add_u32 m0, s73, 21504
    v_mfma_f32_16x16x32_bf16 v[224:227], a[228:231], a[200:203], v[224:227]
    buffer_load_dwordx4 v4, s[40:43], s69 offen offset:0 lds
    v_mfma_f32_16x16x32_bf16 v[220:223], a[224:227], a[200:203], v[220:223]
    ds_read_b128 a[168:171], v7 offset:2048
    ds_read_b128 a[172:175], v9 offset:2048
    v_mfma_f32_16x16x32_bf16 v[220:223], a[236:239], a[204:207], v[220:223]
    v_mfma_f32_16x16x32_bf16 v[232:235], a[236:239], a[212:215], v[232:235]
    ds_read_b128 a[176:179], v7 offset:40960
    s_add_u32 m0, s73, 21248
    v_mfma_f32_16x16x32_bf16 v[232:235], a[224:227], a[208:211], v[232:235]
    buffer_load_dwordx4 v3, s[40:43], s69 offen offset:1280 lds
    v_mfma_f32_16x16x32_bf16 v[236:239], a[228:231], a[208:211], v[236:239]
    ds_read_b128 a[180:183], v9 offset:40960
    ds_read_b128 a[184:187], v7 offset:43008
    v_mfma_f32_16x16x32_bf16 v[236:239], a[240:243], a[212:215], v[236:239]
    ds_read_b128 a[188:191], v9 offset:43008
    s_add_u32 m0, s73, 22272
    v_mfma_f32_16x16x32_bf16 v[240:243], a[244:247], a[212:215], v[240:243]
    buffer_load_dwordx4 v4, s[40:43], s69 offen offset:1280 lds
    v_mfma_f32_16x16x32_bf16 v[240:243], a[232:235], a[208:211], v[240:243]
    v_mfma_f32_16x16x32_bf16 v[252:255], a[232:235], a[216:219], v[252:255]
    v_mfma_f32_16x16x32_bf16 v[252:255], a[244:247], a[220:223], v[252:255]
    s_add_u32 m0, s73, 24576
    v_mfma_f32_16x16x32_bf16 v[248:251], a[240:243], a[220:223], v[248:251]
    buffer_load_dwordx4 v5, s[44:47], s70 offen offset:0 lds
    v_mfma_f32_16x16x32_bf16 v[248:251], a[228:231], a[216:219], v[248:251]
    v_mfma_f32_16x16x32_bf16 v[244:247], a[224:227], a[216:219], v[244:247]
    v_mfma_f32_16x16x32_bf16 v[244:247], a[236:239], a[220:223], v[244:247]
    s_waitcnt lgkmcnt(0)
    v_mfma_f32_16x16x32_bf16 v[160:163], a[136:139], a[160:163], v[160:163]
    ds_read_b128 a[192:195], v8 offset:0
    s_add_u32 m0, s73, 25600
    v_mfma_f32_16x16x32_bf16 v[160:163], a[148:151], a[164:167], v[160:163]
    buffer_load_dwordx4 v6, s[44:47], s70 offen offset:0 lds
    v_mfma_f32_16x16x32_bf16 v[164:167], a[152:155], a[164:167], v[164:167]
    ds_read_b128 a[196:199], v10 offset:0
    v_mfma_f32_16x16x32_bf16 v[164:167], a[140:143], a[160:163], v[164:167]
    ds_read_b128 a[200:203], v8 offset:2048
    v_mfma_f32_16x16x32_bf16 v[168:171], a[144:147], a[160:163], v[168:171]
    s_add_u32 m0, s73, 26496
    v_mfma_f32_16x16x32_bf16 v[168:171], a[156:159], a[164:167], v[168:171]
    buffer_load_dwordx4 v5, s[44:47], s70 offen offset:128 lds
    v_mfma_f32_16x16x32_bf16 v[180:183], a[156:159], a[172:175], v[180:183]
    ds_read_b128 a[204:207], v10 offset:2048
    v_mfma_f32_16x16x32_bf16 v[180:183], a[144:147], a[168:171], v[180:183]
    ds_read_b128 a[208:211], v8 offset:40960
    v_mfma_f32_16x16x32_bf16 v[176:179], a[140:143], a[168:171], v[176:179]
    v_mfma_f32_16x16x32_bf16 v[176:179], a[152:155], a[172:175], v[176:179]
    ds_read_b128 a[212:215], v10 offset:40960
    s_add_u32 m0, s73, 27520
    v_mfma_f32_16x16x32_bf16 v[172:175], a[148:151], a[172:175], v[172:175]
    buffer_load_dwordx4 v6, s[44:47], s70 offen offset:128 lds
    v_mfma_f32_16x16x32_bf16 v[172:175], a[136:139], a[168:171], v[172:175]
    ds_read_b128 a[216:219], v8 offset:43008
    v_mfma_f32_16x16x32_bf16 v[184:187], a[136:139], a[176:179], v[184:187]
    ds_read_b128 a[220:223], v10 offset:43008
    v_mfma_f32_16x16x32_bf16 v[184:187], a[148:151], a[180:183], v[184:187]
    s_add_u32 m0, s73, 28416
    v_mfma_f32_16x16x32_bf16 v[188:191], a[152:155], a[180:183], v[188:191]
    buffer_load_dwordx4 v5, s[44:47], s70 offen offset:256 lds
    v_mfma_f32_16x16x32_bf16 v[188:191], a[140:143], a[176:179], v[188:191]
    v_mfma_f32_16x16x32_bf16 v[192:195], a[144:147], a[176:179], v[192:195]
    v_mfma_f32_16x16x32_bf16 v[192:195], a[156:159], a[180:183], v[192:195]
    v_mfma_f32_16x16x32_bf16 v[204:207], a[156:159], a[188:191], v[204:207]
    s_add_u32 m0, s73, 29440
    v_mfma_f32_16x16x32_bf16 v[204:207], a[144:147], a[184:187], v[204:207]
    buffer_load_dwordx4 v6, s[44:47], s70 offen offset:256 lds
    v_mfma_f32_16x16x32_bf16 v[200:203], a[140:143], a[184:187], v[200:203]
    v_mfma_f32_16x16x32_bf16 v[200:203], a[152:155], a[188:191], v[200:203]
    v_mfma_f32_16x16x32_bf16 v[196:199], a[148:151], a[188:191], v[196:199]
    v_mfma_f32_16x16x32_bf16 v[196:199], a[136:139], a[184:187], v[196:199]
    s_waitcnt vmcnt(10) lgkmcnt(0)
    s_barrier
    v_mfma_f32_16x16x32_bf16 v[156:159], a[144:147], a[248:251], v[156:159]
    ds_read_b64_tr_b16 a[224:225], v11 offset:10240
    s_cmp_lg_u32 s64, 0
    s_cbranch_scc1 L_arrF
    s_lshl4_add_u32 s3, s65, s66
    s_lshl_b32 s3, s3, 7
    s_add_u32 s3, s3, 18415616
    s_mov_b64 exec, 0xff
    buffer_store_dwordx4 a[252:255], v21, s[52:55], s3 offen sc1
    s_mov_b64 exec, -1
L_arrF:
    buffer_store_dwordx4 a[0:3], v68, s[52:55], 0 offen sc1
    v_mfma_f32_16x16x32_bf16 v[156:159], a[156:159], a[248:251], v[156:159]
    s_add_u32 s68, s68, 1
    s_cmp_ge_u32 s68, 10
    s_cselect_b32 s68, 0, s68
    v_mfma_f32_16x16x32_bf16 v[152:155], a[152:155], a[248:251], v[152:155]
    ds_read_b64_tr_b16 a[226:227], v11 offset:10752
    ds_read_b64_tr_b16 a[236:237], v14 offset:10240
    v_mfma_f32_16x16x32_bf16 v[152:155], a[140:143], a[248:251], v[152:155]
    ds_read_b64_tr_b16 a[238:239], v14 offset:10752
    v_mfma_f32_16x16x32_bf16 v[148:151], a[136:139], a[248:251], v[148:151]
    ds_read_b64_tr_b16 a[228:229], v12 offset:10240
    v_mfma_f32_16x16x32_bf16 v[148:151], a[148:151], a[248:251], v[148:151]
    s_lshl_b32 s69, s68, 7
    ds_read_b64_tr_b16 a[230:231], v12 offset:10752
    v_mfma_f32_16x16x32_bf16 v[208:211], a[148:151], a[196:199], v[208:211]
    ds_read_b64_tr_b16 a[240:241], v15 offset:10240
    v_mfma_f32_16x16x32_bf16 v[208:211], a[136:139], a[192:195], v[208:211]
    ds_read_b64_tr_b16 a[242:243], v15 offset:10752
    v_mfma_f32_16x16x32_bf16 v[212:215], a[140:143], a[192:195], v[212:215]
    s_mul_i32 s70, s68, 221184
    v_mfma_f32_16x16x32_bf16 v[212:215], a[152:155], a[196:199], v[212:215]
    ds_read_b64_tr_b16 a[232:233], v13 offset:10240
    v_mfma_f32_16x16x32_bf16 v[216:219], a[156:159], a[196:199], v[216:219]
    ds_read_b64_tr_b16 a[234:235], v13 offset:10752
    v_mfma_f32_16x16x32_bf16 v[216:219], a[144:147], a[192:195], v[216:219]
    ds_read_b64_tr_b16 a[244:245], v16 offset:10240
    s_add_u32 m0, s73, 0
    v_mfma_f32_16x16x32_bf16 v[228:231], a[144:147], a[200:203], v[228:231]
    buffer_load_dwordx4 v3, s[40:43], s69 offen offset:0 lds
    v_mfma_f32_16x16x32_bf16 v[228:231], a[156:159], a[204:207], v[228:231]
    ds_read_b64_tr_b16 a[246:247], v16 offset:10752
    ds_read_b128 a[160:163], v7 offset:10240
    v_mfma_f32_16x16x32_bf16 v[224:227], a[152:155], a[204:207], v[224:227]
    ds_read_b128 a[164:167], v9 offset:10240
    s_add_u32 m0, s73, 1024
    v_mfma_f32_16x16x32_bf16 v[224:227], a[140:143], a[200:203], v[224:227]
    buffer_load_dwordx4 v4, s[40:43], s69 offen offset:0 lds
    v_mfma_f32_16x16x32_bf16 v[220:223], a[136:139], a[200:203], v[220:223]
    ds_read_b128 a[168:171], v7 offset:12288
    ds_read_b128 a[172:175], v9 offset:12288
    v_mfma_f32_16x16x32_bf16 v[220:223], a[148:151], a[204:207], v[220:223]
    buffer_store_dwordx4 a[4:7], v69, s[52:55], 0 offen sc1
    v_mfma_f32_16x16x32_bf16 v[232:235], a[148:151], a[212:215], v[232:235]
    ds_read_b128 a[176:179], v7 offset:51200
    s_add_u32 m0, s73, 768
    v_mfma_f32_16x16x32_bf16 v[232:235], a[136:139], a[208:211], v[232:235]
    buffer_load_dwordx4 v3, s[40:43], s69 offen offset:1280 lds
    v_mfma_f32_16x16x32_bf16 v[236:239], a[140:143], a[208:211], v[236:239]
    ds_read_b128 a[180:183], v9 offset:51200
    ds_read_b128 a[184:187], v7 offset:53248
    v_mfma_f32_16x16x32_bf16 v[236:239], a[152:155], a[212:215], v[236:239]
    ds_read_b128 a[188:191], v9 offset:53248
    s_add_u32 m0, s73, 1792
    v_mfma_f32_16x16x32_bf16 v[240:243], a[156:159], a[212:215], v[240:243]
    buffer_load_dwordx4 v4, s[40:43], s69 offen offset:1280 lds
    v_mfma_f32_16x16x32_bf16 v[240:243], a[144:147], a[208:211], v[240:243]
    v_mfma_f32_16x16x32_bf16 v[252:255], a[144:147], a[216:219], v[252:255]
    v_mfma_f32_16x16x32_bf16 v[252:255], a[156:159], a[220:223], v[252:255]
    s_add_u32 m0, s73, 4096
    v_mfma_f32_16x16x32_bf16 v[248:251], a[152:155], a[220:223], v[248:251]
    buffer_load_dwordx4 v5, s[44:47], s70 offen offset:0 lds
    v_mfma_f32_16x16x32_bf16 v[248:251], a[140:143], a[216:219], v[248:251]
    v_mfma_f32_16x16x32_bf16 v[244:247], a[136:139], a[216:219], v[244:247]
    v_mfma_f32_16x16x32_bf16 v[244:247], a[148:151], a[220:223], v[244:247]
    s_waitcnt lgkmcnt(0)
    v_mfma_f32_16x16x32_bf16 v[160:163], a[224:227], a[160:163], v[160:163]
    ds_read_b128 a[192:195], v8 offset:10240
    buffer_store_dwordx4 a[8:11], v70, s[52:55], 0 offen sc1
    s_add_u32 m0, s73, 5120
    v_mfma_f32_16x16x32_bf16 v[160:163], a[236:239], a[164:167], v[160:163]
    buffer_load_dwordx4 v6, s[44:47], s70 offen offset:0 lds
    v_mfma_f32_16x16x32_bf16 v[164:167], a[240:243], a[164:167], v[164:167]
    ds_read_b128 a[196:199], v10 offset:10240
    v_mfma_f32_16x16x32_bf16 v[164:167], a[228:231], a[160:163], v[164:167]
    ds_read_b128 a[200:203], v8 offset:12288
    v_mfma_f32_16x16x32_bf16 v[168:171], a[232:235], a[160:163], v[168:171]
    s_add_u32 m0, s73, 6016
    v_mfma_f32_16x16x32_bf16 v[168:171], a[244:247], a[164:167], v[168:171]
    buffer_load_dwordx4 v5, s[44:47], s70 offen offset:128 lds
    v_mfma_f32_16x16x32_bf16 v[180:183], a[244:247], a[172:175], v[180:183]
    ds_read_b128 a[204:207], v10 offset:12288
    v_mfma_f32_16x16x32_bf16 v[180:183], a[232:235], a[168:171], v[180:183]
    ds_read_b128 a[208:211], v8 offset:51200
    v_mfma_f32_16x16x32_bf16 v[176:179], a[228:231], a[168:171], v[176:179]
    v_mfma_f32_16x16x32_bf16 v[176:179], a[240:243], a[172:175], v[176:179]
    ds_read_b128 a[212:215], v10 offset:51200
    s_add_u32 m0, s73, 7040
    v_mfma_f32_16x16x32_bf16 v[172:175], a[236:239], a[172:175], v[172:175]
    buffer_load_dwordx4 v6, s[44:47], s70 offen offset:128 lds
    v_mfma_f32_16x16x32_bf16 v[172:175], a[224:227], a[168:171], v[172:175]
    ds_read_b128 a[216:219], v8 offset:53248
    v_mfma_f32_16x16x32_bf16 v[184:187], a[224:227], a[176:179], v[184:187]
    ds_read_b128 a[220:223], v10 offset:53248
    v_mfma_f32_16x16x32_bf16 v[184:187], a[236:239], a[180:183], v[184:187]
    s_add_u32 m0, s73, 7936
    v_mfma_f32_16x16x32_bf16 v[188:191], a[240:243], a[180:183], v[188:191]
    buffer_load_dwordx4 v5, s[44:47], s70 offen offset:256 lds
    v_mfma_f32_16x16x32_bf16 v[188:191], a[228:231], a[176:179], v[188:191]
    buffer_store_dwordx4 a[12:15], v71, s[52:55], 0 offen sc1
    v_mfma_f32_16x16x32_bf16 v[192:195], a[232:235], a[176:179], v[192:195]
    v_mfma_f32_16x16x32_bf16 v[192:195], a[244:247], a[180:183], v[192:195]
    v_mfma_f32_16x16x32_bf16 v[204:207], a[244:247], a[188:191], v[204:207]
    s_add_u32 m0, s73, 8960
    v_mfma_f32_16x16x32_bf16 v[204:207], a[232:235], a[184:187], v[204:207]
    buffer_load_dwordx4 v6, s[44:47], s70 offen offset:256 lds
    v_mfma_f32_16x16x32_bf16 v[200:203], a[228:231], a[184:187], v[200:203]
    v_mfma_f32_16x16x32_bf16 v[200:203], a[240:243], a[188:191], v[200:203]
    v_mfma_f32_16x16x32_bf16 v[196:199], a[236:239], a[188:191], v[196:199]
    v_mfma_f32_16x16x32_bf16 v[196:199], a[224:227], a[184:187], v[196:199]
    s_waitcnt vmcnt(14) lgkmcnt(0)
    s_barrier
    v_mfma_f32_16x16x32_bf16 v[156:159], a[232:235], a[248:251], v[156:159]
    ds_read_b64_tr_b16 a[136:137], v11 offset:20480
    v_mfma_f32_16x16x32_bf16 v[156:159], a[244:247], a[248:251], v[156:159]
    s_add_u32 s68, s68, 1
    s_cmp_ge_u32 s68, 10
    s_cselect_b32 s68, 0, s68
    v_mfma_f32_16x16x32_bf16 v[152:155], a[240:243], a[248:251], v[152:155]
    ds_read_b64_tr_b16 a[138:139], v11 offset:20992
    ds_read_b64_tr_b16 a[148:149], v14 offset:20480
    v_mfma_f32_16x16x32_bf16 v[152:155], a[228:231], a[248:251], v[152:155]
    ds_read_b64_tr_b16 a[150:151], v14 offset:20992
    v_mfma_f32_16x16x32_bf16 v[148:151], a[224:227], a[248:251], v[148:151]
    ds_read_b64_tr_b16 a[140:141], v12 offset:20480
    v_mfma_f32_16x16x32_bf16 v[148:151], a[236:239], a[248:251], v[148:151]
    s_lshl_b32 s69, s68, 7
    ds_read_b64_tr_b16 a[142:143], v12 offset:20992
    v_mfma_f32_16x16x32_bf16 v[208:211], a[236:239], a[196:199], v[208:211]
    ds_read_b64_tr_b16 a[152:153], v15 offset:20480
    v_mfma_f32_16x16x32_bf16 v[208:211], a[224:227], a[192:195], v[208:211]
    ds_read_b64_tr_b16 a[154:155], v15 offset:20992
    v_mfma_f32_16x16x32_bf16 v[212:215], a[228:231], a[192:195], v[212:215]
    s_mul_i32 s70, s68, 221184
    v_mfma_f32_16x16x32_bf16 v[212:215], a[240:243], a[196:199], v[212:215]
    ds_read_b64_tr_b16 a[144:145], v13 offset:20480
    v_mfma_f32_16x16x32_bf16 v[216:219], a[244:247], a[196:199], v[216:219]
    ds_read_b64_tr_b16 a[146:147], v13 offset:20992
    v_mfma_f32_16x16x32_bf16 v[216:219], a[232:235], a[192:195], v[216:219]
    ds_read_b64_tr_b16 a[156:157], v16 offset:20480
    s_add_u32 m0, s73, 10240
    v_mfma_f32_16x16x32_bf16 v[228:231], a[232:235], a[200:203], v[228:231]
    buffer_load_dwordx4 v3, s[40:43], s69 offen offset:0 lds
    v_mfma_f32_16x16x32_bf16 v[228:231], a[244:247], a[204:207], v[228:231]
    ds_read_b64_tr_b16 a[158:159], v16 offset:20992
    ds_read_b128 a[160:163], v7 offset:20480
    v_mfma_f32_16x16x32_bf16 v[224:227], a[240:243], a[204:207], v[224:227]
    ds_read_b128 a[164:167], v9 offset:20480
    s_add_u32 m0, s73, 11264
    v_mfma_f32_16x16x32_bf16 v[224:227], a[228:231], a[200:203], v[224:227]
    buffer_load_dwordx4 v4, s[40:43], s69 offen offset:0 lds
    v_mfma_f32_16x16x32_bf16 v[220:223], a[224:227], a[200:203], v[220:223]
    ds_read_b128 a[168:171], v7 offset:22528
    ds_read_b128 a[172:175], v9 offset:22528
    v_mfma_f32_16x16x32_bf16 v[220:223], a[236:239], a[204:207], v[220:223]
    v_accvgpr_read_b32 v42, a124
    v_mfma_f32_16x16x32_bf16 v[232:235], a[236:239], a[212:215], v[232:235]
    ds_read_b128 a[176:179], v7 offset:61440
    s_add_u32 m0, s73, 11008
    v_mfma_f32_16x16x32_bf16 v[232:235], a[224:227], a[208:211], v[232:235]
    buffer_load_dwordx4 v3, s[40:43], s69 offen offset:1280 lds
    v_mfma_f32_16x16x32_bf16 v[236:239], a[228:231], a[208:211], v[236:239]
    ds_read_b128 a[180:183], v9 offset:61440
    ds_read_b128 a[184:187], v7 offset:63488
    v_mfma_f32_16x16x32_bf16 v[236:239], a[240:243], a[212:215], v[236:239]
    ds_read_b128 a[188:191], v9 offset:63488
    s_add_u32 m0, s73, 12032
    v_mfma_f32_16x16x32_bf16 v[240:243], a[244:247], a[212:215], v[240:243]
    buffer_load_dwordx4 v4, s[40:43], s69 offen offset:1280 lds
    v_mfma_f32_16x16x32_bf16 v[240:243], a[232:235], a[208:211], v[240:243]
    v_accvgpr_read_b32 v43, a125
    v_mfma_f32_16x16x32_bf16 v[252:255], a[232:235], a[216:219], v[252:255]
    v_accvgpr_read_b32 v30, a126
    v_mfma_f32_16x16x32_bf16 v[252:255], a[244:247], a[220:223], v[252:255]
    s_add_u32 m0, s73, 14336
    v_mfma_f32_16x16x32_bf16 v[248:251], a[240:243], a[220:223], v[248:251]
    buffer_load_dwordx4 v5, s[44:47], s70 offen offset:0 lds
    v_mfma_f32_16x16x32_bf16 v[248:251], a[228:231], a[216:219], v[248:251]
    v_mfma_f32_16x16x32_bf16 v[244:247], a[224:227], a[216:219], v[244:247]
    v_mfma_f32_16x16x32_bf16 v[244:247], a[236:239], a[220:223], v[244:247]
    s_waitcnt lgkmcnt(0)
    v_mfma_f32_16x16x32_bf16 v[160:163], a[136:139], a[160:163], v[160:163]
    ds_read_b128 a[192:195], v8 offset:20480
    s_add_u32 m0, s23, 0
    v_mfma_f32_16x16x32_bf16 v[160:163], a[148:151], a[164:167], v[160:163]
    buffer_load_dwordx4 v42, s[56:59], s76 offen lds
    v_mfma_f32_16x16x32_bf16 v[164:167], a[152:155], a[164:167], v[164:167]
    ds_read_b128 a[196:199], v10 offset:20480
    v_mfma_f32_16x16x32_bf16 v[164:167], a[140:143], a[160:163], v[164:167]
    ds_read_b128 a[200:203], v8 offset:22528
    v_mfma_f32_16x16x32_bf16 v[168:171], a[144:147], a[160:163], v[168:171]
    s_add_u32 m0, s73, 15360
    v_mfma_f32_16x16x32_bf16 v[168:171], a[156:159], a[164:167], v[168:171]
    buffer_load_dwordx4 v6, s[44:47], s70 offen offset:0 lds
    v_mfma_f32_16x16x32_bf16 v[180:183], a[156:159], a[172:175], v[180:183]
    ds_read_b128 a[204:207], v10 offset:22528
    v_mfma_f32_16x16x32_bf16 v[180:183], a[144:147], a[168:171], v[180:183]
    ds_read_b128 a[208:211], v8 offset:61440
    s_add_u32 m0, s73, 16256
    v_mfma_f32_16x16x32_bf16 v[176:179], a[140:143], a[168:171], v[176:179]
    buffer_load_dwordx4 v5, s[44:47], s70 offen offset:128 lds
    v_mfma_f32_16x16x32_bf16 v[176:179], a[152:155], a[172:175], v[176:179]
    ds_read_b128 a[212:215], v10 offset:61440
    v_mfma_f32_16x16x32_bf16 v[172:175], a[148:151], a[172:175], v[172:175]
    ds_read_b128 a[216:219], v8 offset:63488
    v_mfma_f32_16x16x32_bf16 v[172:175], a[136:139], a[168:171], v[172:175]
    s_add_u32 m0, s73, 17280
    v_mfma_f32_16x16x32_bf16 v[184:187], a[136:139], a[176:179], v[184:187]
    buffer_load_dwordx4 v6, s[44:47], s70 offen offset:128 lds
    v_mfma_f32_16x16x32_bf16 v[184:187], a[148:151], a[180:183], v[184:187]
    ds_read_b128 a[220:223], v10 offset:63488
    v_mfma_f32_16x16x32_bf16 v[188:191], a[152:155], a[180:183], v[188:191]
    v_mfma_f32_16x16x32_bf16 v[188:191], a[140:143], a[176:179], v[188:191]
    s_add_u32 m0, s73, 18176
    v_mfma_f32_16x16x32_bf16 v[192:195], a[144:147], a[176:179], v[192:195]
    buffer_load_dwordx4 v5, s[44:47], s70 offen offset:256 lds
    v_mfma_f32_16x16x32_bf16 v[192:195], a[156:159], a[180:183], v[192:195]
    v_mfma_f32_16x16x32_bf16 v[204:207], a[156:159], a[188:191], v[204:207]
    v_mfma_f32_16x16x32_bf16 v[204:207], a[144:147], a[184:187], v[204:207]
    s_add_u32 m0, s73, 19200
    v_mfma_f32_16x16x32_bf16 v[200:203], a[140:143], a[184:187], v[200:203]
    buffer_load_dwordx4 v6, s[44:47], s70 offen offset:256 lds
    v_mfma_f32_16x16x32_bf16 v[200:203], a[152:155], a[188:191], v[200:203]
    v_mfma_f32_16x16x32_bf16 v[196:199], a[148:151], a[188:191], v[196:199]
    v_mfma_f32_16x16x32_bf16 v[196:199], a[136:139], a[184:187], v[196:199]
    s_waitcnt vmcnt(11) lgkmcnt(0)
    s_barrier
    v_mfma_f32_16x16x32_bf16 v[156:159], a[144:147], a[248:251], v[156:159]
    ds_read_b64_tr_b16 a[224:225], v11 offset:0
    s_cmp_lg_u32 s64, 1
    s_cbranch_scc1 L_rf
    s_lshl_b32 s3, s82, 7
    s_add_u32 s3, s3, 18481152
    s_mov_b64 exec, 0xff
    buffer_store_dwordx4 a[252:255], v21, s[52:55], s3 offen sc1
    s_mov_b64 exec, -1
L_rf:
    s_add_u32 m0, s23, 1024
    v_mfma_f32_16x16x32_bf16 v[156:159], a[156:159], a[248:251], v[156:159]
    buffer_load_dwordx4 v43, s[56:59], s76 offen lds
    v_mfma_f32_16x16x32_bf16 v[152:155], a[152:155], a[248:251], v[152:155]
    ds_read_b64_tr_b16 a[226:227], v11 offset:512
    ds_read_b64_tr_b16 a[236:237], v14 offset:0
    v_mfma_f32_16x16x32_bf16 v[152:155], a[140:143], a[248:251], v[152:155]
    ds_read_b64_tr_b16 a[238:239], v14 offset:512
    v_mfma_f32_16x16x32_bf16 v[148:151], a[136:139], a[248:251], v[148:151]
    s_add_u32 s68, s68, 1
    s_cmp_ge_u32 s68, 10
    s_cselect_b32 s68, 0, s68
    v_mfma_f32_16x16x32_bf16 v[148:151], a[148:151], a[248:251], v[148:151]
    ds_read_b64_tr_b16 a[228:229], v12 offset:0
    ds_read_b64_tr_b16 a[230:231], v12 offset:512
    v_mfma_f32_16x16x32_bf16 v[208:211], a[148:151], a[196:199], v[208:211]
    ds_read_b64_tr_b16 a[240:241], v15 offset:0
    v_mfma_f32_16x16x32_bf16 v[208:211], a[136:139], a[192:195], v[208:211]
    s_lshl_b32 s69, s68, 7
    ds_read_b64_tr_b16 a[242:243], v15 offset:512
    v_mfma_f32_16x16x32_bf16 v[212:215], a[140:143], a[192:195], v[212:215]
    v_mfma_f32_16x16x32_bf16 v[212:215], a[152:155], a[196:199], v[212:215]
    ds_read_b64_tr_b16 a[232:233], v13 offset:0
    v_mfma_f32_16x16x32_bf16 v[216:219], a[156:159], a[196:199], v[216:219]
    ds_read_b64_tr_b16 a[234:235], v13 offset:512
    v_mfma_f32_16x16x32_bf16 v[216:219], a[144:147], a[192:195], v[216:219]
    s_mul_i32 s70, s68, 221184
    ds_read_b64_tr_b16 a[244:245], v16 offset:0
    v_mfma_f32_16x16x32_bf16 v[228:231], a[144:147], a[200:203], v[228:231]
    ds_read_b64_tr_b16 a[246:247], v16 offset:512
    v_mfma_f32_16x16x32_bf16 v[228:231], a[156:159], a[204:207], v[228:231]
    ds_read_b128 a[160:163], v7 offset:0
    s_add_u32 m0, s73, 20480
    v_mfma_f32_16x16x32_bf16 v[224:227], a[152:155], a[204:207], v[224:227]
    buffer_load_dwordx4 v3, s[40:43], s69 offen offset:0 lds
    v_mfma_f32_16x16x32_bf16 v[224:227], a[140:143], a[200:203], v[224:227]
    ds_read_b128 a[164:167], v9 offset:0
    ds_read_b128 a[168:171], v7 offset:2048
    v_mfma_f32_16x16x32_bf16 v[220:223], a[136:139], a[200:203], v[220:223]
    ds_read_b128 a[172:175], v9 offset:2048
    s_add_u32 m0, s73, 21504
    v_mfma_f32_16x16x32_bf16 v[220:223], a[148:151], a[204:207], v[220:223]
    buffer_load_dwordx4 v4, s[40:43], s69 offen offset:0 lds
    v_mfma_f32_16x16x32_bf16 v[232:235], a[148:151], a[212:215], v[232:235]
    ds_read_b128 a[176:179], v7 offset:40960
    v_mfma_f32_16x16x32_bf16 v[232:235], a[136:139], a[208:211], v[232:235]
    ds_read_b128 a[180:183], v9 offset:40960
    s_add_u32 m0, s73, 21248
    v_mfma_f32_16x16x32_bf16 v[236:239], a[140:143], a[208:211], v[236:239]
    buffer_load_dwordx4 v3, s[40:43], s69 offen offset:1280 lds
    v_mfma_f32_16x16x32_bf16 v[236:239], a[152:155], a[212:215], v[236:239]
    ds_read_b128 a[184:187], v7 offset:43008
    ds_read_b128 a[188:191], v9 offset:43008
    v_mfma_f32_16x16x32_bf16 v[240:243], a[156:159], a[212:215], v[240:243]
    s_add_u32 m0, s73, 22272
    v_mfma_f32_16x16x32_bf16 v[240:243], a[144:147], a[208:211], v[240:243]
    buffer_load_dwordx4 v4, s[40:43], s69 offen offset:1280 lds
    v_mfma_f32_16x16x32_bf16 v[252:255], a[144:147], a[216:219], v[252:255]
    v_mfma_f32_16x16x32_bf16 v[252:255], a[156:159], a[220:223], v[252:255]
    s_add_u32 m0, s73, 24576
    v_mfma_f32_16x16x32_bf16 v[248:251], a[152:155], a[220:223], v[248:251]
    buffer_load_dwordx4 v5, s[44:47], s70 offen offset:0 lds
    v_mfma_f32_16x16x32_bf16 v[248:251], a[140:143], a[216:219], v[248:251]
    v_mfma_f32_16x16x32_bf16 v[244:247], a[136:139], a[216:219], v[244:247]
    v_mfma_f32_16x16x32_bf16 v[244:247], a[148:151], a[220:223], v[244:247]
    s_waitcnt lgkmcnt(0)
    v_mfma_f32_16x16x32_bf16 v[160:163], a[224:227], a[160:163], v[160:163]
    ds_read_b128 a[192:195], v8 offset:0
    s_add_u32 m0, s23, 2048
    v_mfma_f32_16x16x32_bf16 v[160:163], a[236:239], a[164:167], v[160:163]
    buffer_load_dwordx4 v42, s[56:59], s77 offen lds
    v_mfma_f32_16x16x32_bf16 v[164:167], a[240:243], a[164:167], v[164:167]
    ds_read_b128 a[196:199], v10 offset:0
    v_mfma_f32_16x16x32_bf16 v[164:167], a[228:231], a[160:163], v[164:167]
    ds_read_b128 a[200:203], v8 offset:2048
    v_mfma_f32_16x16x32_bf16 v[168:171], a[232:235], a[160:163], v[168:171]
    s_add_u32 m0, s73, 25600
    v_mfma_f32_16x16x32_bf16 v[168:171], a[244:247], a[164:167], v[168:171]
    buffer_load_dwordx4 v6, s[44:47], s70 offen offset:0 lds
    v_mfma_f32_16x16x32_bf16 v[180:183], a[244:247], a[172:175], v[180:183]
    ds_read_b128 a[204:207], v10 offset:2048
    v_mfma_f32_16x16x32_bf16 v[180:183], a[232:235], a[168:171], v[180:183]
    ds_read_b128 a[208:211], v8 offset:40960
    s_add_u32 m0, s73, 26496
    v_mfma_f32_16x16x32_bf16 v[176:179], a[228:231], a[168:171], v[176:179]
    buffer_load_dwordx4 v5, s[44:47], s70 offen offset:128 lds
    v_mfma_f32_16x16x32_bf16 v[176:179], a[240:243], a[172:175], v[176:179]
    ds_read_b128 a[212:215], v10 offset:40960
    v_mfma_f32_16x16x32_bf16 v[172:175], a[236:239], a[172:175], v[172:175]
    ds_read_b128 a[216:219], v8 offset:43008
    v_mfma_f32_16x16x32_bf16 v[172:175], a[224:227], a[168:171], v[172:175]
    s_add_u32 m0, s73, 27520
    v_mfma_f32_16x16x32_bf16 v[184:187], a[224:227], a[176:179], v[184:187]
    buffer_load_dwordx4 v6, s[44:47], s70 offen offset:128 lds
    v_mfma_f32_16x16x32_bf16 v[184:187], a[236:239], a[180:183], v[184:187]
    ds_read_b128 a[220:223], v10 offset:43008
    v_mfma_f32_16x16x32_bf16 v[188:191], a[240:243], a[180:183], v[188:191]
    v_mfma_f32_16x16x32_bf16 v[188:191], a[228:231], a[176:179], v[188:191]
    s_add_u32 m0, s73, 28416
    v_mfma_f32_16x16x32_bf16 v[192:195], a[232:235], a[176:179], v[192:195]
    buffer_load_dwordx4 v5, s[44:47], s70 offen offset:256 lds
    v_mfma_f32_16x16x32_bf16 v[192:195], a[244:247], a[180:183], v[192:195]
    v_mfma_f32_16x16x32_bf16 v[204:207], a[244:247], a[188:191], v[204:207]
    v_mfma_f32_16x16x32_bf16 v[204:207], a[232:235], a[184:187], v[204:207]
    s_add_u32 m0, s73, 29440
    v_mfma_f32_16x16x32_bf16 v[200:203], a[228:231], a[184:187], v[200:203]
    buffer_load_dwordx4 v6, s[44:47], s70 offen offset:256 lds
    v_mfma_f32_16x16x32_bf16 v[200:203], a[240:243], a[188:191], v[200:203]
    v_mfma_f32_16x16x32_bf16 v[196:199], a[236:239], a[188:191], v[196:199]
    v_mfma_f32_16x16x32_bf16 v[196:199], a[224:227], a[184:187], v[196:199]
    s_waitcnt vmcnt(12) lgkmcnt(0)
    s_barrier
    v_mfma_f32_16x16x32_bf16 v[156:159], a[232:235], a[248:251], v[156:159]
    ds_read_b64_tr_b16 a[136:137], v11 offset:10240
    buffer_load_dword v28, v29, s[52:55], 0 offen sc1
    s_add_u32 m0, s23, 3072
    v_mfma_f32_16x16x32_bf16 v[156:159], a[244:247], a[248:251], v[156:159]
    buffer_load_dwordx4 v43, s[56:59], s77 offen lds
    v_mfma_f32_16x16x32_bf16 v[152:155], a[240:243], a[248:251], v[152:155]
    ds_read_b64_tr_b16 a[138:139], v11 offset:10752
    ds_read_b64_tr_b16 a[148:149], v14 offset:10240
    v_mfma_f32_16x16x32_bf16 v[152:155], a[228:231], a[248:251], v[152:155]
    ds_read_b64_tr_b16 a[150:151], v14 offset:10752
    v_mfma_f32_16x16x32_bf16 v[148:151], a[224:227], a[248:251], v[148:151]
    s_add_u32 s68, s68, 1
    s_cmp_ge_u32 s68, 10
    s_cselect_b32 s68, 0, s68
    v_mfma_f32_16x16x32_bf16 v[148:151], a[236:239], a[248:251], v[148:151]
    ds_read_b64_tr_b16 a[140:141], v12 offset:10240
    ds_read_b64_tr_b16 a[142:143], v12 offset:10752
    v_mfma_f32_16x16x32_bf16 v[208:211], a[236:239], a[196:199], v[208:211]
    ds_read_b64_tr_b16 a[152:153], v15 offset:10240
    v_mfma_f32_16x16x32_bf16 v[208:211], a[224:227], a[192:195], v[208:211]
    s_lshl_b32 s69, s68, 7
    ds_read_b64_tr_b16 a[154:155], v15 offset:10752
    v_mfma_f32_16x16x32_bf16 v[212:215], a[228:231], a[192:195], v[212:215]
    v_mfma_f32_16x16x32_bf16 v[212:215], a[240:243], a[196:199], v[212:215]
    ds_read_b64_tr_b16 a[144:145], v13 offset:10240
    v_mfma_f32_16x16x32_bf16 v[216:219], a[244:247], a[196:199], v[216:219]
    ds_read_b64_tr_b16 a[146:147], v13 offset:10752
    v_mfma_f32_16x16x32_bf16 v[216:219], a[232:235], a[192:195], v[216:219]
    s_mul_i32 s70, s68, 221184
    ds_read_b64_tr_b16 a[156:157], v16 offset:10240
    v_mfma_f32_16x16x32_bf16 v[228:231], a[232:235], a[200:203], v[228:231]
    ds_read_b64_tr_b16 a[158:159], v16 offset:10752
    v_mfma_f32_16x16x32_bf16 v[228:231], a[244:247], a[204:207], v[228:231]
    ds_read_b128 a[160:163], v7 offset:10240
    s_add_u32 m0, s73, 0
    v_mfma_f32_16x16x32_bf16 v[224:227], a[240:243], a[204:207], v[224:227]
    buffer_load_dwordx4 v3, s[40:43], s69 offen offset:0 lds
    v_mfma_f32_16x16x32_bf16 v[224:227], a[228:231], a[200:203], v[224:227]
    ds_read_b128 a[164:167], v9 offset:10240
    ds_read_b128 a[168:171], v7 offset:12288
    v_mfma_f32_16x16x32_bf16 v[220:223], a[224:227], a[200:203], v[220:223]
    ds_read_b128 a[172:175], v9 offset:12288
    s_add_u32 m0, s73, 1024
    v_mfma_f32_16x16x32_bf16 v[220:223], a[236:239], a[204:207], v[220:223]
    buffer_load_dwordx4 v4, s[40:43], s69 offen offset:0 lds
    v_mfma_f32_16x16x32_bf16 v[232:235], a[236:239], a[212:215], v[232:235]
    ds_read_b128 a[176:179], v7 offset:51200
    v_mfma_f32_16x16x32_bf16 v[232:235], a[224:227], a[208:211], v[232:235]
    ds_read_b128 a[180:183], v9 offset:51200
    s_add_u32 m0, s73, 768
    v_mfma_f32_16x16x32_bf16 v[236:239], a[228:231], a[208:211], v[236:239]
    buffer_load_dwordx4 v3, s[40:43], s69 offen offset:1280 lds
    v_mfma_f32_16x16x32_bf16 v[236:239], a[240:243], a[212:215], v[236:239]
    ds_read_b128 a[184:187], v7 offset:53248
    ds_read_b128 a[188:191], v9 offset:53248
    v_mfma_f32_16x16x32_bf16 v[240:243], a[244:247], a[212:215], v[240:243]
    s_add_u32 m0, s73, 1792
    v_mfma_f32_16x16x32_bf16 v[240:243], a[232:235], a[208:211], v[240:243]
    buffer_load_dwordx4 v4, s[40:43], s69 offen offset:1280 lds
    v_mfma_f32_16x16x32_bf16 v[252:255], a[232:235], a[216:219], v[252:255]
    v_mfma_f32_16x16x32_bf16 v[252:255], a[244:247], a[220:223], v[252:255]
    s_add_u32 m0, s73, 4096
    v_mfma_f32_16x16x32_bf16 v[248:251], a[240:243], a[220:223], v[248:251]
    buffer_load_dwordx4 v5, s[44:47], s70 offen offset:0 lds
    v_mfma_f32_16x16x32_bf16 v[248:251], a[228:231], a[216:219], v[248:251]
    v_mfma_f32_16x16x32_bf16 v[244:247], a[224:227], a[216:219], v[244:247]
    v_mfma_f32_16x16x32_bf16 v[244:247], a[236:239], a[220:223], v[244:247]
    s_waitcnt lgkmcnt(0)
    v_mfma_f32_16x16x32_bf16 v[160:163], a[136:139], a[160:163], v[160:163]
    ds_read_b128 a[192:195], v8 offset:10240
    s_add_u32 m0, s23, 4096
    v_mfma_f32_16x16x32_bf16 v[160:163], a[148:151], a[164:167], v[160:163]
    buffer_load_dwordx4 v42, s[56:59], s78 offen lds
    v_mfma_f32_16x16x32_bf16 v[164:167], a[152:155], a[164:167], v[164:167]
    ds_read_b128 a[196:199], v10 offset:10240
    v_mfma_f32_16x16x32_bf16 v[164:167], a[140:143], a[160:163], v[164:167]
    ds_read_b128 a[200:203], v8 offset:12288
    v_mfma_f32_16x16x32_bf16 v[168:171], a[144:147], a[160:163], v[168:171]
    s_add_u32 m0, s73, 5120
    v_mfma_f32_16x16x32_bf16 v[168:171], a[156:159], a[164:167], v[168:171]
    buffer_load_dwordx4 v6, s[44:47], s70 offen offset:0 lds
    v_mfma_f32_16x16x32_bf16 v[180:183], a[156:159], a[172:175], v[180:183]
    ds_read_b128 a[204:207], v10 offset:12288
    v_mfma_f32_16x16x32_bf16 v[180:183], a[144:147], a[168:171], v[180:183]
    ds_read_b128 a[208:211], v8 offset:51200
    s_add_u32 m0, s73, 6016
    v_mfma_f32_16x16x32_bf16 v[176:179], a[140:143], a[168:171], v[176:179]
    buffer_load_dwordx4 v5, s[44:47], s70 offen offset:128 lds
    v_mfma_f32_16x16x32_bf16 v[176:179], a[152:155], a[172:175], v[176:179]
    ds_read_b128 a[212:215], v10 offset:51200
    v_mfma_f32_16x16x32_bf16 v[172:175], a[148:151], a[172:175], v[172:175]
    ds_read_b128 a[216:219], v8 offset:53248
    v_mfma_f32_16x16x32_bf16 v[172:175], a[136:139], a[168:171], v[172:175]
    s_add_u32 m0, s73, 7040
    v_mfma_f32_16x16x32_bf16 v[184:187], a[136:139], a[176:179], v[184:187]
    buffer_load_dwordx4 v6, s[44:47], s70 offen offset:128 lds
    v_mfma_f32_16x16x32_bf16 v[184:187], a[148:151], a[180:183], v[184:187]
    ds_read_b128 a[220:223], v10 offset:53248
    v_mfma_f32_16x16x32_bf16 v[188:191], a[152:155], a[180:183], v[188:191]
    v_mfma_f32_16x16x32_bf16 v[188:191], a[140:143], a[176:179], v[188:191]
    s_add_u32 m0, s73, 7936
    v_mfma_f32_16x16x32_bf16 v[192:195], a[144:147], a[176:179], v[192:195]
    buffer_load_dwordx4 v5, s[44:47], s70 offen offset:256 lds
    v_mfma_f32_16x16x32_bf16 v[192:195], a[156:159], a[180:183], v[192:195]
    s_waitcnt vmcnt(11)
    v_cmp_ne_u32 vcc, s34, v28
    v_mfma_f32_16x16x32_bf16 v[204:207], a[156:159], a[188:191], v[204:207]
    v_mfma_f32_16x16x32_bf16 v[204:207], a[144:147], a[184:187], v[204:207]
    s_add_u32 m0, s73, 8960
    v_mfma_f32_16x16x32_bf16 v[200:203], a[140:143], a[184:187], v[200:203]
    buffer_load_dwordx4 v6, s[44:47], s70 offen offset:256 lds
    v_mfma_f32_16x16x32_bf16 v[200:203], a[152:155], a[188:191], v[200:203]
    v_mfma_f32_16x16x32_bf16 v[196:199], a[148:151], a[188:191], v[196:199]
    v_mfma_f32_16x16x32_bf16 v[196:199], a[136:139], a[184:187], v[196:199]
    s_waitcnt lgkmcnt(0)
    s_cbranch_vccnz L_paF
L_paFd:
    s_barrier
    v_mfma_f32_16x16x32_bf16 v[156:159], a[144:147], a[248:251], v[156:159]
    ds_read_b64_tr_b16 a[224:225], v11 offset:20480
    s_add_u32 m0, s23, 40960
    v_mfma_f32_16x16x32_bf16 v[156:159], a[156:159], a[248:251], v[156:159]
    buffer_load_dwordx4 v21, s[52:55], s18 offen sc1 lds
    v_mfma_f32_16x16x32_bf16 v[152:155], a[152:155], a[248:251], v[152:155]
    ds_read_b64_tr_b16 a[226:227], v11 offset:20992
    ds_read_b64_tr_b16 a[236:237], v14 offset:20480
    v_mfma_f32_16x16x32_bf16 v[152:155], a[140:143], a[248:251], v[152:155]
    ds_read_b64_tr_b16 a[238:239], v14 offset:20992
    v_mfma_f32_16x16x32_bf16 v[148:151], a[136:139], a[248:251], v[148:151]
    ds_read_b64_tr_b16 a[228:229], v12 offset:20480
    v_mfma_f32_16x16x32_bf16 v[148:151], a[148:151], a[248:251], v[148:151]
    ds_read_b64_tr_b16 a[230:231], v12 offset:20992
    s_add_u32 m0, s73, 10240
    v_mfma_f32_16x16x32_bf16 v[208:211], a[148:151], a[196:199], v[208:211]
    buffer_load_dwordx4 v17, s[56:59], s76 offen lds
    v_mfma_f32_16x16x32_bf16 v[208:211], a[136:139], a[192:195], v[208:211]
    ds_read_b64_tr_b16 a[240:241], v15 offset:20480
    ds_read_b64_tr_b16 a[242:243], v15 offset:20992
    v_mfma_f32_16x16x32_bf16 v[212:215], a[140:143], a[192:195], v[212:215]
    v_mfma_f32_16x16x32_bf16 v[212:215], a[152:155], a[196:199], v[212:215]
    ds_read_b64_tr_b16 a[232:233], v13 offset:20480
    v_mfma_f32_16x16x32_bf16 v[216:219], a[156:159], a[196:199], v[216:219]
    ds_read_b64_tr_b16 a[234:235], v13 offset:20992
    s_add_u32 m0, s73, 11264
    v_mfma_f32_16x16x32_bf16 v[216:219], a[144:147], a[192:195], v[216:219]
    buffer_load_dwordx4 v18, s[56:59], s76 offen lds
    v_mfma_f32_16x16x32_bf16 v[228:231], a[144:147], a[200:203], v[228:231]
    ds_read_b64_tr_b16 a[244:245], v16 offset:20480
    ds_read_b64_tr_b16 a[246:247], v16 offset:20992
    v_mfma_f32_16x16x32_bf16 v[228:231], a[156:159], a[204:207], v[228:231]
    ds_read_b128 a[160:163], v7 offset:20480
    v_mfma_f32_16x16x32_bf16 v[224:227], a[152:155], a[204:207], v[224:227]
    ds_read_b128 a[164:167], v9 offset:20480
    s_add_u32 m0, s73, 12288
    v_mfma_f32_16x16x32_bf16 v[224:227], a[140:143], a[200:203], v[224:227]
    buffer_load_dwordx4 v17, s[56:59], s77 offen lds
    v_mfma_f32_16x16x32_bf16 v[220:223], a[136:139], a[200:203], v[220:223]
    ds_read_b128 a[168:171], v7 offset:22528
    ds_read_b128 a[172:175], v9 offset:22528
    v_mfma_f32_16x16x32_bf16 v[220:223], a[148:151], a[204:207], v[220:223]
    v_mfma_f32_16x16x32_bf16 v[232:235], a[148:151], a[212:215], v[232:235]
    ds_read_b128 a[176:179], v7 offset:61440
    v_mfma_f32_16x16x32_bf16 v[232:235], a[136:139], a[208:211], v[232:235]
    ds_read_b128 a[180:183], v9 offset:61440
    s_add_u32 m0, s73, 13312
    v_mfma_f32_16x16x32_bf16 v[236:239], a[140:143], a[208:211], v[236:239]
    buffer_load_dwordx4 v18, s[56:59], s77 offen lds
    v_mfma_f32_16x16x32_bf16 v[236:239], a[152:155], a[212:215], v[236:239]
    ds_read_b128 a[184:187], v7 offset:63488
    ds_read_b128 a[188:191], v9 offset:63488
    v_mfma_f32_16x16x32_bf16 v[240:243], a[156:159], a[212:215], v[240:243]
    v_mfma_f32_16x16x32_bf16 v[240:243], a[144:147], a[208:211], v[240:243]
    v_mfma_f32_16x16x32_bf16 v[252:255], a[144:147], a[216:219], v[252:255]
    s_add_u32 m0, s73, 14336
    v_mfma_f32_16x16x32_bf16 v[252:255], a[156:159], a[220:223], v[252:255]
    buffer_load_dwordx4 v17, s[56:59], s78 offen lds
    v_mfma_f32_16x16x32_bf16 v[248:251], a[152:155], a[220:223], v[248:251]
    v_mfma_f32_16x16x32_bf16 v[248:251], a[140:143], a[216:219], v[248:251]
    v_mfma_f32_16x16x32_bf16 v[244:247], a[136:139], a[216:219], v[244:247]
    v_mfma_f32_16x16x32_bf16 v[244:247], a[148:151], a[220:223], v[244:247]
    s_waitcnt lgkmcnt(0)
    v_mfma_f32_16x16x32_bf16 v[160:163], a[224:227], a[160:163], v[160:163]
    ds_read_b128 a[192:195], v8 offset:20480
    s_add_u32 m0, s73, 15360
    v_mfma_f32_16x16x32_bf16 v[160:163], a[236:239], a[164:167], v[160:163]
    buffer_load_dwordx4 v18, s[56:59], s78 offen lds
    v_mfma_f32_16x16x32_bf16 v[164:167], a[240:243], a[164:167], v[164:167]
    ds_read_b128 a[196:199], v10 offset:20480
    v_mfma_f32_16x16x32_bf16 v[164:167], a[228:231], a[160:163], v[164:167]
    ds_read_b128 a[200:203], v8 offset:22528
    v_mfma_f32_16x16x32_bf16 v[168:171], a[232:235], a[160:163], v[168:171]
    s_add_u32 m0, s73, 16384
    v_mfma_f32_16x16x32_bf16 v[168:171], a[244:247], a[164:167], v[168:171]
    buffer_load_dwordx4 v17, s[56:59], s79 offen lds
    v_mfma_f32_16x16x32_bf16 v[180:183], a[244:247], a[172:175], v[180:183]
    ds_read_b128 a[204:207], v10 offset:22528
    v_mfma_f32_16x16x32_bf16 v[180:183], a[232:235], a[168:171], v[180:183]
    ds_read_b128 a[208:211], v8 offset:61440
    s_add_u32 m0, s73, 17408
    v_mfma_f32_16x16x32_bf16 v[176:179], a[228:231], a[168:171], v[176:179]
    buffer_load_dwordx4 v18, s[56:59], s79 offen lds
    v_mfma_f32_16x16x32_bf16 v[176:179], a[240:243], a[172:175], v[176:179]
    ds_read_b128 a[212:215], v10 offset:61440
    v_mfma_f32_16x16x32_bf16 v[172:175], a[236:239], a[172:175], v[172:175]
    ds_read_b128 a[216:219], v8 offset:63488
    v_mfma_f32_16x16x32_bf16 v[172:175], a[224:227], a[168:171], v[172:175]
    s_add_u32 m0, s73, 18432
    v_mfma_f32_16x16x32_bf16 v[184:187], a[224:227], a[176:179], v[184:187]
    buffer_load_dwordx4 v17, s[56:59], s80 offen lds
    v_mfma_f32_16x16x32_bf16 v[184:187], a[236:239], a[180:183], v[184:187]
    ds_read_b128 a[220:223], v10 offset:63488
    v_mfma_f32_16x16x32_bf16 v[188:191], a[240:243], a[180:183], v[188:191]
    v_mfma_f32_16x16x32_bf16 v[188:191], a[228:231], a[176:179], v[188:191]
    s_add_u32 m0, s73, 19456
    v_mfma_f32_16x16x32_bf16 v[192:195], a[232:235], a[176:179], v[192:195]
    buffer_load_dwordx4 v18, s[56:59], s80 offen lds
    v_mfma_f32_16x16x32_bf16 v[192:195], a[244:247], a[180:183], v[192:195]
    v_mfma_f32_16x16x32_bf16 v[204:207], a[244:247], a[188:191], v[204:207]
    v_mfma_f32_16x16x32_bf16 v[204:207], a[232:235], a[184:187], v[204:207]
    v_mfma_f32_16x16x32_bf16 v[200:203], a[228:231], a[184:187], v[200:203]
    v_add_u32 v17, 128, v17
    v_add_u32 v18, 128, v18
    v_mfma_f32_16x16x32_bf16 v[200:203], a[240:243], a[188:191], v[200:203]
    v_mfma_f32_16x16x32_bf16 v[196:199], a[236:239], a[188:191], v[196:199]
    v_mfma_f32_16x16x32_bf16 v[196:199], a[224:227], a[184:187], v[196:199]
    s_waitcnt vmcnt(10) lgkmcnt(0)
    s_barrier
    v_mfma_f32_16x16x32_bf16 v[156:159], a[232:235], a[248:251], v[156:159]
    ds_read_b64_tr_b16 a[136:137], v11 offset:0
    buffer_load_dword v28, v31, s[52:55], 0 offen sc1
    s_add_u32 m0, s73, 20480
    v_mfma_f32_16x16x32_bf16 v[156:159], a[244:247], a[248:251], v[156:159]
    buffer_load_dwordx4 v17, s[56:59], s76 offen lds
    v_mfma_f32_16x16x32_bf16 v[152:155], a[240:243], a[248:251], v[152:155]
    ds_read_b64_tr_b16 a[138:139], v11 offset:512
    ds_read_b64_tr_b16 a[148:149], v14 offset:0
    v_mfma_f32_16x16x32_bf16 v[152:155], a[228:231], a[248:251], v[152:155]
    ds_read_b64_tr_b16 a[150:151], v14 offset:512
    v_lshl_add_u32 v110, v1, 6, s23
    v_mfma_f32_16x16x32_bf16 v[148:151], a[224:227], a[248:251], v[148:151]
    ds_read_b64_tr_b16 a[140:141], v12 offset:0
    v_mfma_f32_16x16x32_bf16 v[148:151], a[236:239], a[248:251], v[148:151]
    ds_read_b64_tr_b16 a[142:143], v12 offset:512
    v_mfma_f32_16x16x32_bf16 v[208:211], a[236:239], a[196:199], v[208:211]
    ds_read_b64_tr_b16 a[152:153], v15 offset:0
    s_add_u32 m0, s73, 21504
    v_mfma_f32_16x16x32_bf16 v[208:211], a[224:227], a[192:195], v[208:211]
    buffer_load_dwordx4 v18, s[56:59], s76 offen lds
    v_mfma_f32_16x16x32_bf16 v[212:215], a[228:231], a[192:195], v[212:215]
    ds_read_b64_tr_b16 a[154:155], v15 offset:512
    ds_read_b128 v[132:135], v110 offset:40960
    v_mfma_f32_16x16x32_bf16 v[212:215], a[240:243], a[196:199], v[212:215]
    ds_read_b64_tr_b16 a[144:145], v13 offset:0
    v_mfma_f32_16x16x32_bf16 v[216:219], a[244:247], a[196:199], v[216:219]
    ds_read_b64_tr_b16 a[146:147], v13 offset:512
    v_mfma_f32_16x16x32_bf16 v[216:219], a[232:235], a[192:195], v[216:219]
    ds_read_b64_tr_b16 a[156:157], v16 offset:0
    s_add_u32 m0, s73, 22528
    v_mfma_f32_16x16x32_bf16 v[228:231], a[232:235], a[200:203], v[228:231]
    buffer_load_dwordx4 v17, s[56:59], s77 offen lds
    v_mfma_f32_16x16x32_bf16 v[228:231], a[244:247], a[204:207], v[228:231]
    ds_read_b64_tr_b16 a[158:159], v16 offset:512
    ds_read_b128 a[160:163], v7 offset:0
    v_mfma_f32_16x16x32_bf16 v[224:227], a[240:243], a[204:207], v[224:227]
    ds_read_b128 a[164:167], v9 offset:0
    ds_read_b128 v[136:139], v110 offset:40976
    v_mfma_f32_16x16x32_bf16 v[224:227], a[228:231], a[200:203], v[224:227]
    ds_read_b128 a[168:171], v7 offset:2048
    v_mfma_f32_16x16x32_bf16 v[220:223], a[224:227], a[200:203], v[220:223]
    ds_read_b128 a[172:175], v9 offset:2048
    ds_read_b128 a[0:3], v30 offset:0
    v_mfma_f32_16x16x32_bf16 v[220:223], a[236:239], a[204:207], v[220:223]
    s_add_u32 m0, s73, 23552
    v_mfma_f32_16x16x32_bf16 v[232:235], a[236:239], a[212:215], v[232:235]
    buffer_load_dwordx4 v18, s[56:59], s77 offen lds
    v_mfma_f32_16x16x32_bf16 v[232:235], a[224:227], a[208:211], v[232:235]
    ds_read_b128 a[176:179], v7 offset:40960
    ds_read_b128 a[180:183], v9 offset:40960
    v_mfma_f32_16x16x32_bf16 v[236:239], a[228:231], a[208:211], v[236:239]
    ds_read_b128 a[184:187], v7 offset:43008
    ds_read_b128 a[4:7], v30 offset:2048
    v_mfma_f32_16x16x32_bf16 v[236:239], a[240:243], a[212:215], v[236:239]
    ds_read_b128 a[188:191], v9 offset:43008
    ds_read_b128 a[8:11], v30 offset:4096
    v_mfma_f32_16x16x32_bf16 v[240:243], a[244:247], a[212:215], v[240:243]
    ds_read_b128 v[140:143], v110 offset:40992
    v_mfma_f32_16x16x32_bf16 v[240:243], a[232:235], a[208:211], v[240:243]
    ds_read_b128 a[12:15], v30 offset:6144
    s_add_u32 m0, s73, 24576
    v_mfma_f32_16x16x32_bf16 v[252:255], a[232:235], a[216:219], v[252:255]
    buffer_load_dwordx4 v17, s[56:59], s78 offen lds
    v_mfma_f32_16x16x32_bf16 v[252:255], a[244:247], a[220:223], v[252:255]
    ds_read_b128 v[144:147], v110 offset:41008
    v_mfma_f32_16x16x32_bf16 v[248:251], a[240:243], a[220:223], v[248:251]
    ds_read_b128 a[16:19], v30 offset:8192
    v_mfma_f32_16x16x32_bf16 v[248:251], a[228:231], a[216:219], v[248:251]
    v_mfma_f32_16x16x32_bf16 v[244:247], a[224:227], a[216:219], v[244:247]
    v_mfma_f32_16x16x32_bf16 v[244:247], a[236:239], a[220:223], v[244:247]
    s_waitcnt lgkmcnt(0)
    v_mfma_f32_16x16x32_bf16 v[156:159], a[144:147], a[248:251], v[156:159]
    ds_read_b128 a[192:195], v8 offset:0
    s_add_u32 m0, s73, 25600
    v_mfma_f32_16x16x32_bf16 v[156:159], a[156:159], a[248:251], v[156:159]
    buffer_load_dwordx4 v18, s[56:59], s78 offen lds
    v_mfma_f32_16x16x32_bf16 v[152:155], a[152:155], a[248:251], v[152:155]
    ds_read_b128 a[196:199], v10 offset:0
    v_mfma_f32_16x16x32_bf16 v[152:155], a[140:143], a[248:251], v[152:155]
    v_mfma_f32_16x16x32_bf16 v[148:151], a[136:139], a[248:251], v[148:151]
    ds_read_b128 a[200:203], v8 offset:2048
    v_mfma_f32_16x16x32_bf16 v[148:151], a[148:151], a[248:251], v[148:151]
    v_mfma_f32_16x16x32_bf16 v[160:163], a[148:151], a[164:167], v[160:163]
    ds_read_b128 a[204:207], v10 offset:2048
    s_add_u32 m0, s73, 26624
    v_mfma_f32_16x16x32_bf16 v[160:163], a[136:139], a[160:163], v[160:163]
    buffer_load_dwordx4 v17, s[56:59], s79 offen lds
    v_mfma_f32_16x16x32_bf16 v[164:167], a[140:143], a[160:163], v[164:167]
    v_mfma_f32_16x16x32_bf16 v[164:167], a[152:155], a[164:167], v[164:167]
    ds_read_b128 a[208:211], v8 offset:40960
    v_mfma_f32_16x16x32_bf16 v[168:171], a[156:159], a[164:167], v[168:171]
    v_mfma_f32_16x16x32_bf16 v[168:171], a[144:147], a[160:163], v[168:171]
    ds_read_b128 a[212:215], v10 offset:40960
    s_add_u32 m0, s73, 27648
    v_mfma_f32_16x16x32_bf16 v[180:183], a[144:147], a[168:171], v[180:183]
    buffer_load_dwordx4 v18, s[56:59], s79 offen lds
    v_mfma_f32_16x16x32_bf16 v[180:183], a[156:159], a[172:175], v[180:183]
    ds_read_b128 a[216:219], v8 offset:43008
    v_mfma_f32_16x16x32_bf16 v[176:179], a[152:155], a[172:175], v[176:179]
    v_mfma_f32_16x16x32_bf16 v[176:179], a[140:143], a[168:171], v[176:179]
    ds_read_b128 a[220:223], v10 offset:43008
    v_mfma_f32_16x16x32_bf16 v[172:175], a[136:139], a[168:171], v[172:175]
    v_mfma_f32_16x16x32_bf16 v[172:175], a[148:151], a[172:175], v[172:175]
    s_add_u32 m0, s73, 28672
    v_mfma_f32_16x16x32_bf16 v[184:187], a[148:151], a[180:183], v[184:187]
    buffer_load_dwordx4 v17, s[56:59], s80 offen lds
    v_mfma_f32_16x16x32_bf16 v[184:187], a[136:139], a[176:179], v[184:187]
    v_mfma_f32_16x16x32_bf16 v[188:191], a[140:143], a[176:179], v[188:191]
    v_mfma_f32_16x16x32_bf16 v[188:191], a[152:155], a[180:183], v[188:191]
    v_mfma_f32_16x16x32_bf16 v[192:195], a[156:159], a[180:183], v[192:195]
    s_waitcnt vmcnt(9)
    v_cmp_ne_u32 vcc, s34, v28
    v_mfma_f32_16x16x32_bf16 v[192:195], a[144:147], a[176:179], v[192:195]
    s_add_u32 m0, s73, 29696
    v_mfma_f32_16x16x32_bf16 v[204:207], a[144:147], a[184:187], v[204:207]
    buffer_load_dwordx4 v18, s[56:59], s80 offen lds
    v_mfma_f32_16x16x32_bf16 v[204:207], a[156:159], a[188:191], v[204:207]
    v_mfma_f32_16x16x32_bf16 v[200:203], a[152:155], a[188:191], v[200:203]
    v_mfma_f32_16x16x32_bf16 v[200:203], a[140:143], a[184:187], v[200:203]
    v_mfma_f32_16x16x32_bf16 v[196:199], a[136:139], a[184:187], v[196:199]
    v_mfma_f32_16x16x32_bf16 v[196:199], a[148:151], a[188:191], v[196:199]
    s_waitcnt lgkmcnt(0)
    s_cbranch_vccnz L_prF
L_prFd:
    s_barrier
    s_add_u32 m0, s73, 30720
    v_mfma_f32_16x16x32_bf16 v[208:211], a[136:139], a[192:195], v[208:211]
    buffer_load_dwordx4 v21, s[52:55], s85 offen offset:0 sc1 lds
    v_mfma_f32_16x16x32_bf16 v[208:211], a[148:151], a[196:199], v[208:211]
    s_add_u32 m0, s73, 30720
    v_mfma_f32_16x16x32_bf16 v[212:215], a[152:155], a[196:199], v[212:215]
    buffer_load_dwordx4 v21, s[52:55], s85 offen offset:1024 sc1 lds
    v_mfma_f32_16x16x32_bf16 v[212:215], a[140:143], a[192:195], v[212:215]
    s_waitcnt lgkmcnt(0)
    s_nop 0
    v_pk_fma_f32 v[160:161], v[132:133], v[148:149], v[160:161] op_sel_hi:[0,1,1] neg_lo:[1,0,0] neg_hi:[1,0,0]
    v_pk_fma_f32 v[162:163], v[132:133], v[150:151], v[162:163] op_sel_hi:[0,1,1] neg_lo:[1,0,0] neg_hi:[1,0,0]
    v_pk_fma_f32 v[172:173], v[134:135], v[148:149], v[172:173] op_sel_hi:[0,1,1] neg_lo:[1,0,0] neg_hi:[1,0,0]
    v_pk_fma_f32 v[174:175], v[134:135], v[150:151], v[174:175] op_sel_hi:[0,1,1] neg_lo:[1,0,0] neg_hi:[1,0,0]
    v_pk_fma_f32 v[160:161], v[132:133], v[160:161], v[84:85] op_sel:[1,0,0] op_sel_hi:[1,1,1]
    v_pk_fma_f32 v[162:163], v[132:133], v[162:163], v[86:87] op_sel:[1,0,0] op_sel_hi:[1,1,1]
    v_pk_fma_f32 v[172:173], v[134:135], v[172:173], v[84:85] op_sel:[1,0,0] op_sel_hi:[1,1,1]
    v_pk_fma_f32 v[174:175], v[134:135], v[174:175], v[86:87] op_sel:[1,0,0] op_sel_hi:[1,1,1]
    v_mfma_f32_16x16x32_bf16 v[216:219], a[144:147], a[192:195], v[216:219]
    v_max_f32 v160, 0, v160
    v_max_f32 v161, 0, v161
    v_mfma_f32_16x16x32_bf16 v[216:219], a[156:159], a[196:199], v[216:219]
    v_max_f32 v162, 0, v162
    v_max_f32 v163, 0, v163
    v_mfma_f32_16x16x32_bf16 v[228:231], a[156:159], a[204:207], v[228:231]
    v_max_f32 v172, 0, v172
    v_max_f32 v173, 0, v173
    s_add_u32 m0, s73, 30720
    v_mfma_f32_16x16x32_bf16 v[228:231], a[144:147], a[200:203], v[228:231]
    buffer_load_dwordx4 v21, s[52:55], s85 offen offset:2048 sc1 lds
    v_max_f32 v174, 0, v174
    v_max_f32 v175, 0, v175
    v_pk_mul_f32 v[160:161], v[160:161], v[160:161]
    v_pk_mul_f32 v[162:163], v[162:163], v[162:163]
    v_pk_mul_f32 v[172:173], v[172:173], v[172:173]
    v_pk_mul_f32 v[174:175], v[174:175], v[174:175]
    v_cvt_pk_bf16_f32 v48, v160, v161
    v_cvt_pk_bf16_f32 v50, v172, v173
    v_cvt_pk_bf16_f32 v49, v162, v163
    v_cvt_pk_bf16_f32 v51, v174, v175
    v_permlane16_swap_b32 v48, v50
    s_mov_b32 s38, 0
    v_permlane16_swap_b32_e64 v49, v51
    buffer_store_dwordx4 v[48:51], v23, s[52:55], s38 offen offset:0 sc1
    v_pk_fma_f32 v[164:165], v[132:133], v[152:153], v[164:165] op_sel_hi:[0,1,1] neg_lo:[1,0,0] neg_hi:[1,0,0]
    v_pk_fma_f32 v[166:167], v[132:133], v[154:155], v[166:167] op_sel_hi:[0,1,1] neg_lo:[1,0,0] neg_hi:[1,0,0]
    v_pk_fma_f32 v[176:177], v[134:135], v[152:153], v[176:177] op_sel_hi:[0,1,1] neg_lo:[1,0,0] neg_hi:[1,0,0]
    v_pk_fma_f32 v[178:179], v[134:135], v[154:155], v[178:179] op_sel_hi:[0,1,1] neg_lo:[1,0,0] neg_hi:[1,0,0]
    v_pk_fma_f32 v[164:165], v[132:133], v[164:165], v[88:89] op_sel:[1,0,0] op_sel_hi:[1,1,1]
    v_pk_fma_f32 v[166:167], v[132:133], v[166:167], v[90:91] op_sel:[1,0,0] op_sel_hi:[1,1,1]
    v_pk_fma_f32 v[176:177], v[134:135], v[176:177], v[88:89] op_sel:[1,0,0] op_sel_hi:[1,1,1]
    v_pk_fma_f32 v[178:179], v[134:135], v[178:179], v[90:91] op_sel:[1,0,0] op_sel_hi:[1,1,1]
    v_mfma_f32_16x16x32_bf16 v[224:227], a[140:143], a[200:203], v[224:227]
    v_max_f32 v164, 0, v164
    v_max_f32 v165, 0, v165
    v_mfma_f32_16x16x32_bf16 v[224:227], a[152:155], a[204:207], v[224:227]
    v_max_f32 v166, 0, v166
    v_max_f32 v167, 0, v167
    v_mfma_f32_16x16x32_bf16 v[220:223], a[148:151], a[204:207], v[220:223]
    v_max_f32 v176, 0, v176
    v_max_f32 v177, 0, v177
    s_add_u32 m0, s73, 30720
    v_mfma_f32_16x16x32_bf16 v[220:223], a[136:139], a[200:203], v[220:223]
    buffer_load_dwordx4 v21, s[52:55], s85 offen offset:3072 sc1 lds
    v_max_f32 v178, 0, v178
    v_max_f32 v179, 0, v179
    v_pk_mul_f32 v[164:165], v[164:165], v[164:165]
    v_pk_mul_f32 v[166:167], v[166:167], v[166:167]
    v_pk_mul_f32 v[176:177], v[176:177], v[176:177]
    v_pk_mul_f32 v[178:179], v[178:179], v[178:179]
    v_cvt_pk_bf16_f32 v52, v164, v165
    v_cvt_pk_bf16_f32 v54, v176, v177
    v_cvt_pk_bf16_f32 v53, v166, v167
    v_cvt_pk_bf16_f32 v55, v178, v179
    v_permlane16_swap_b32 v52, v54
    s_mov_b32 s38, 0
    v_permlane16_swap_b32_e64 v53, v55
    buffer_store_dwordx4 v[52:55], v23, s[52:55], s38 offen offset:512 sc1
    v_pk_fma_f32 v[168:169], v[132:133], v[156:157], v[168:169] op_sel_hi:[0,1,1] neg_lo:[1,0,0] neg_hi:[1,0,0]
    v_pk_fma_f32 v[170:171], v[132:133], v[158:159], v[170:171] op_sel_hi:[0,1,1] neg_lo:[1,0,0] neg_hi:[1,0,0]
    v_pk_fma_f32 v[180:181], v[134:135], v[156:157], v[180:181] op_sel_hi:[0,1,1] neg_lo:[1,0,0] neg_hi:[1,0,0]
    v_pk_fma_f32 v[182:183], v[134:135], v[158:159], v[182:183] op_sel_hi:[0,1,1] neg_lo:[1,0,0] neg_hi:[1,0,0]
    v_pk_fma_f32 v[168:169], v[132:133], v[168:169], v[92:93] op_sel:[1,0,0] op_sel_hi:[1,1,1]
    v_pk_fma_f32 v[170:171], v[132:133], v[170:171], v[94:95] op_sel:[1,0,0] op_sel_hi:[1,1,1]
    v_pk_fma_f32 v[180:181], v[134:135], v[180:181], v[92:93] op_sel:[1,0,0] op_sel_hi:[1,1,1]
    v_pk_fma_f32 v[182:183], v[134:135], v[182:183], v[94:95] op_sel:[1,0,0] op_sel_hi:[1,1,1]
    v_mfma_f32_16x16x32_bf16 v[232:235], a[136:139], a[208:211], v[232:235]
    v_max_f32 v168, 0, v168
    v_max_f32 v169, 0, v169
    v_mfma_f32_16x16x32_bf16 v[232:235], a[148:151], a[212:215], v[232:235]
    v_max_f32 v170, 0, v170
    v_max_f32 v171, 0, v171
    v_mfma_f32_16x16x32_bf16 v[236:239], a[152:155], a[212:215], v[236:239]
    v_max_f32 v180, 0, v180
    v_max_f32 v181, 0, v181
    s_add_u32 m0, s73, 34816
    v_mfma_f32_16x16x32_bf16 v[236:239], a[140:143], a[208:211], v[236:239]
    buffer_load_dwordx4 v22, s[52:55], s85 offen offset:0 sc1 lds
    v_max_f32 v182, 0, v182
    v_max_f32 v183, 0, v183
    v_pk_mul_f32 v[168:169], v[168:169], v[168:169]
    v_pk_mul_f32 v[170:171], v[170:171], v[170:171]
    v_pk_mul_f32 v[180:181], v[180:181], v[180:181]
    v_pk_mul_f32 v[182:183], v[182:183], v[182:183]
    v_cvt_pk_bf16_f32 v56, v168, v169
    v_cvt_pk_bf16_f32 v58, v180, v181
    v_cvt_pk_bf16_f32 v57, v170, v171
    v_cvt_pk_bf16_f32 v59, v182, v183
    v_permlane16_swap_b32 v56, v58
    s_mov_b32 s38, 0
    v_permlane16_swap_b32_e64 v57, v59
    buffer_store_dwordx4 v[56:59], v23, s[52:55], s38 offen offset:1024 sc1
    v_pk_fma_f32 v[184:185], v[136:137], v[148:149], v[184:185] op_sel_hi:[0,1,1] neg_lo:[1,0,0] neg_hi:[1,0,0]
    v_pk_fma_f32 v[186:187], v[136:137], v[150:151], v[186:187] op_sel_hi:[0,1,1] neg_lo:[1,0,0] neg_hi:[1,0,0]
    v_pk_fma_f32 v[196:197], v[138:139], v[148:149], v[196:197] op_sel_hi:[0,1,1] neg_lo:[1,0,0] neg_hi:[1,0,0]
    v_pk_fma_f32 v[198:199], v[138:139], v[150:151], v[198:199] op_sel_hi:[0,1,1] neg_lo:[1,0,0] neg_hi:[1,0,0]
    v_pk_fma_f32 v[184:185], v[136:137], v[184:185], v[84:85] op_sel:[1,0,0] op_sel_hi:[1,1,1]
    v_pk_fma_f32 v[186:187], v[136:137], v[186:187], v[86:87] op_sel:[1,0,0] op_sel_hi:[1,1,1]
    v_pk_fma_f32 v[196:197], v[138:139], v[196:197], v[84:85] op_sel:[1,0,0] op_sel_hi:[1,1,1]
    v_pk_fma_f32 v[198:199], v[138:139], v[198:199], v[86:87] op_sel:[1,0,0] op_sel_hi:[1,1,1]
    v_mfma_f32_16x16x32_bf16 v[240:243], a[144:147], a[208:211], v[240:243]
    v_max_f32 v184, 0, v184
    v_max_f32 v185, 0, v185
    v_mfma_f32_16x16x32_bf16 v[240:243], a[156:159], a[212:215], v[240:243]
    v_max_f32 v186, 0, v186
    v_max_f32 v187, 0, v187
    v_mfma_f32_16x16x32_bf16 v[252:255], a[156:159], a[220:223], v[252:255]
    v_max_f32 v196, 0, v196
    v_max_f32 v197, 0, v197
    v_mfma_f32_16x16x32_bf16 v[252:255], a[144:147], a[216:219], v[252:255]
    s_add_u32 s85, s85, 5120
    v_max_f32 v198, 0, v198
    v_max_f32 v199, 0, v199
    v_pk_mul_f32 v[184:185], v[184:185], v[184:185]
    v_pk_mul_f32 v[186:187], v[186:187], v[186:187]
    v_pk_mul_f32 v[196:197], v[196:197], v[196:197]
    v_pk_mul_f32 v[198:199], v[198:199], v[198:199]
    v_cvt_pk_bf16_f32 v60, v184, v185
    v_cvt_pk_bf16_f32 v62, v196, v197
    v_cvt_pk_bf16_f32 v61, v186, v187
    v_cvt_pk_bf16_f32 v63, v198, v199
    v_permlane16_swap_b32_e64 v60, v62
    s_mov_b32 s38, 192512
    v_permlane16_swap_b32_e64 v61, v63
    buffer_store_dwordx4 v[60:63], v23, s[52:55], s38 offen offset:0 sc1
    v_pk_fma_f32 v[188:189], v[136:137], v[152:153], v[188:189] op_sel_hi:[0,1,1] neg_lo:[1,0,0] neg_hi:[1,0,0]
    v_pk_fma_f32 v[190:191], v[136:137], v[154:155], v[190:191] op_sel_hi:[0,1,1] neg_lo:[1,0,0] neg_hi:[1,0,0]
    v_pk_fma_f32 v[200:201], v[138:139], v[152:153], v[200:201] op_sel_hi:[0,1,1] neg_lo:[1,0,0] neg_hi:[1,0,0]
    v_pk_fma_f32 v[202:203], v[138:139], v[154:155], v[202:203] op_sel_hi:[0,1,1] neg_lo:[1,0,0] neg_hi:[1,0,0]
    v_pk_fma_f32 v[188:189], v[136:137], v[188:189], v[88:89] op_sel:[1,0,0] op_sel_hi:[1,1,1]
    v_pk_fma_f32 v[190:191], v[136:137], v[190:191], v[90:91] op_sel:[1,0,0] op_sel_hi:[1,1,1]
    v_pk_fma_f32 v[200:201], v[138:139], v[200:201], v[88:89] op_sel:[1,0,0] op_sel_hi:[1,1,1]
    v_pk_fma_f32 v[202:203], v[138:139], v[202:203], v[90:91] op_sel:[1,0,0] op_sel_hi:[1,1,1]
    v_mfma_f32_16x16x32_bf16 v[248:251], a[140:143], a[216:219], v[248:251]
    v_max_f32 v188, 0, v188
    v_max_f32 v189, 0, v189
    v_mfma_f32_16x16x32_bf16 v[248:251], a[152:155], a[220:223], v[248:251]
    v_max_f32 v190, 0, v190
    v_max_f32 v191, 0, v191
    v_mfma_f32_16x16x32_bf16 v[244:247], a[148:151], a[220:223], v[244:247]
    v_max_f32 v200, 0, v200
    v_max_f32 v201, 0, v201
    s_add_u32 m0, s73, 35840
    v_mfma_f32_16x16x32_bf16 v[244:247], a[136:139], a[216:219], v[244:247]
    buffer_load_dwordx4 v21, s[52:55], s85 offen offset:0 sc1 lds
    v_max_f32 v202, 0, v202
    v_max_f32 v203, 0, v203
    v_pk_mul_f32 v[188:189], v[188:189], v[188:189]
    v_pk_mul_f32 v[190:191], v[190:191], v[190:191]
    v_pk_mul_f32 v[200:201], v[200:201], v[200:201]
    v_pk_mul_f32 v[202:203], v[202:203], v[202:203]
    v_cvt_pk_bf16_f32 v48, v188, v189
    v_cvt_pk_bf16_f32 v50, v200, v201
    v_cvt_pk_bf16_f32 v49, v190, v191
    v_cvt_pk_bf16_f32 v51, v202, v203
    v_permlane16_swap_b32_e64 v48, v50
    s_mov_b32 s38, 192512
    v_permlane16_swap_b32_e64 v49, v51
    buffer_store_dwordx4 v[48:51], v23, s[52:55], s38 offen offset:512 sc1
    v_pk_fma_f32 v[192:193], v[136:137], v[156:157], v[192:193] op_sel_hi:[0,1,1] neg_lo:[1,0,0] neg_hi:[1,0,0]
    v_pk_fma_f32 v[194:195], v[136:137], v[158:159], v[194:195] op_sel_hi:[0,1,1] neg_lo:[1,0,0] neg_hi:[1,0,0]
    v_pk_fma_f32 v[204:205], v[138:139], v[156:157], v[204:205] op_sel_hi:[0,1,1] neg_lo:[1,0,0] neg_hi:[1,0,0]
    v_pk_fma_f32 v[206:207], v[138:139], v[158:159], v[206:207] op_sel_hi:[0,1,1] neg_lo:[1,0,0] neg_hi:[1,0,0]
    v_pk_fma_f32 v[192:193], v[136:137], v[192:193], v[92:93] op_sel:[1,0,0] op_sel_hi:[1,1,1]
    v_pk_fma_f32 v[194:195], v[136:137], v[194:195], v[94:95] op_sel:[1,0,0] op_sel_hi:[1,1,1]
    v_pk_fma_f32 v[204:205], v[138:139], v[204:205], v[92:93] op_sel:[1,0,0] op_sel_hi:[1,1,1]
    v_pk_fma_f32 v[206:207], v[138:139], v[206:207], v[94:95] op_sel:[1,0,0] op_sel_hi:[1,1,1]
    v_max_f32 v192, 0, v192
    v_max_f32 v193, 0, v193
    v_max_f32 v194, 0, v194
    v_max_f32 v195, 0, v195
    v_max_f32 v204, 0, v204
    v_max_f32 v205, 0, v205
    v_max_f32 v206, 0, v206
    v_max_f32 v207, 0, v207
    v_pk_mul_f32 v[192:193], v[192:193], v[192:193]
    v_pk_mul_f32 v[194:195], v[194:195], v[194:195]
    s_add_u32 m0, s73, 35840
    v_pk_mul_f32 v[204:205], v[204:205], v[204:205]
    buffer_load_dwordx4 v21, s[52:55], s85 offen offset:1024 sc1 lds
    v_pk_mul_f32 v[206:207], v[206:207], v[206:207]
    v_cvt_pk_bf16_f32 v52, v192, v193
    v_cvt_pk_bf16_f32 v54, v204, v205
    v_cvt_pk_bf16_f32 v53, v194, v195
    v_cvt_pk_bf16_f32 v55, v206, v207
    v_permlane16_swap_b32_e64 v52, v54
    s_mov_b32 s38, 192512
    v_permlane16_swap_b32_e64 v53, v55
    buffer_store_dwordx4 v[52:55], v23, s[52:55], s38 offen offset:1024 sc1
    v_pk_fma_f32 v[208:209], v[140:141], v[148:149], v[208:209] op_sel_hi:[0,1,1] neg_lo:[1,0,0] neg_hi:[1,0,0]
    v_pk_fma_f32 v[210:211], v[140:141], v[150:151], v[210:211] op_sel_hi:[0,1,1] neg_lo:[1,0,0] neg_hi:[1,0,0]
    v_pk_fma_f32 v[220:221], v[142:143], v[148:149], v[220:221] op_sel_hi:[0,1,1] neg_lo:[1,0,0] neg_hi:[1,0,0]
    v_pk_fma_f32 v[222:223], v[142:143], v[150:151], v[222:223] op_sel_hi:[0,1,1] neg_lo:[1,0,0] neg_hi:[1,0,0]
    v_pk_fma_f32 v[208:209], v[140:141], v[208:209], v[84:85] op_sel:[1,0,0] op_sel_hi:[1,1,1]
    v_pk_fma_f32 v[210:211], v[140:141], v[210:211], v[86:87] op_sel:[1,0,0] op_sel_hi:[1,1,1]
    v_pk_fma_f32 v[220:221], v[142:143], v[220:221], v[84:85] op_sel:[1,0,0] op_sel_hi:[1,1,1]
    v_pk_fma_f32 v[222:223], v[142:143], v[222:223], v[86:87] op_sel:[1,0,0] op_sel_hi:[1,1,1]
    v_max_f32 v208, 0, v208
    v_max_f32 v209, 0, v209
    v_max_f32 v210, 0, v210
    v_max_f32 v211, 0, v211
    v_max_f32 v220, 0, v220
    v_max_f32 v221, 0, v221
    v_max_f32 v222, 0, v222
    v_max_f32 v223, 0, v223
    v_pk_mul_f32 v[208:209], v[208:209], v[208:209]
    v_pk_mul_f32 v[210:211], v[210:211], v[210:211]
    v_pk_mul_f32 v[220:221], v[220:221], v[220:221]
    v_pk_mul_f32 v[222:223], v[222:223], v[222:223]
    v_cvt_pk_bf16_f32 v56, v208, v209
    v_cvt_pk_bf16_f32 v58, v220, v221
    s_add_u32 m0, s73, 35840
    v_cvt_pk_bf16_f32 v57, v210, v211
    buffer_load_dwordx4 v21, s[52:55], s85 offen offset:2048 sc1 lds
    v_cvt_pk_bf16_f32 v59, v222, v223
    v_permlane16_swap_b32_e64 v56, v58
    s_mov_b32 s38, 385024
    v_permlane16_swap_b32_e64 v57, v59
    buffer_store_dwordx4 v[56:59], v23, s[52:55], s38 offen offset:0 sc1
    v_pk_fma_f32 v[212:213], v[140:141], v[152:153], v[212:213] op_sel_hi:[0,1,1] neg_lo:[1,0,0] neg_hi:[1,0,0]
    v_pk_fma_f32 v[214:215], v[140:141], v[154:155], v[214:215] op_sel_hi:[0,1,1] neg_lo:[1,0,0] neg_hi:[1,0,0]
    v_pk_fma_f32 v[224:225], v[142:143], v[152:153], v[224:225] op_sel_hi:[0,1,1] neg_lo:[1,0,0] neg_hi:[1,0,0]
    v_pk_fma_f32 v[226:227], v[142:143], v[154:155], v[226:227] op_sel_hi:[0,1,1] neg_lo:[1,0,0] neg_hi:[1,0,0]
    v_pk_fma_f32 v[212:213], v[140:141], v[212:213], v[88:89] op_sel:[1,0,0] op_sel_hi:[1,1,1]
    v_pk_fma_f32 v[214:215], v[140:141], v[214:215], v[90:91] op_sel:[1,0,0] op_sel_hi:[1,1,1]
    v_pk_fma_f32 v[224:225], v[142:143], v[224:225], v[88:89] op_sel:[1,0,0] op_sel_hi:[1,1,1]
    v_pk_fma_f32 v[226:227], v[142:143], v[226:227], v[90:91] op_sel:[1,0,0] op_sel_hi:[1,1,1]
    v_max_f32 v212, 0, v212
    v_max_f32 v213, 0, v213
    v_max_f32 v214, 0, v214
    v_max_f32 v215, 0, v215
    v_max_f32 v224, 0, v224
    v_max_f32 v225, 0, v225
    v_max_f32 v226, 0, v226
    v_max_f32 v227, 0, v227
    v_pk_mul_f32 v[212:213], v[212:213], v[212:213]
    v_pk_mul_f32 v[214:215], v[214:215], v[214:215]
    v_pk_mul_f32 v[224:225], v[224:225], v[224:225]
    v_pk_mul_f32 v[226:227], v[226:227], v[226:227]
    v_cvt_pk_bf16_f32 v60, v212, v213
    v_cvt_pk_bf16_f32 v62, v224, v225
    v_cvt_pk_bf16_f32 v61, v214, v215
    v_cvt_pk_bf16_f32 v63, v226, v227
    v_permlane16_swap_b32_e64 v60, v62
    s_mov_b32 s38, 385024
    s_add_u32 m0, s73, 35840
    v_permlane16_swap_b32_e64 v61, v63
    buffer_load_dwordx4 v21, s[52:55], s85 offen offset:3072 sc1 lds
    buffer_store_dwordx4 v[60:63], v23, s[52:55], s38 offen offset:512 sc1
    v_pk_fma_f32 v[216:217], v[140:141], v[156:157], v[216:217] op_sel_hi:[0,1,1] neg_lo:[1,0,0] neg_hi:[1,0,0]
    v_pk_fma_f32 v[218:219], v[140:141], v[158:159], v[218:219] op_sel_hi:[0,1,1] neg_lo:[1,0,0] neg_hi:[1,0,0]
    v_pk_fma_f32 v[228:229], v[142:143], v[156:157], v[228:229] op_sel_hi:[0,1,1] neg_lo:[1,0,0] neg_hi:[1,0,0]
    v_pk_fma_f32 v[230:231], v[142:143], v[158:159], v[230:231] op_sel_hi:[0,1,1] neg_lo:[1,0,0] neg_hi:[1,0,0]
    v_pk_fma_f32 v[216:217], v[140:141], v[216:217], v[92:93] op_sel:[1,0,0] op_sel_hi:[1,1,1]
    v_pk_fma_f32 v[218:219], v[140:141], v[218:219], v[94:95] op_sel:[1,0,0] op_sel_hi:[1,1,1]
    v_pk_fma_f32 v[228:229], v[142:143], v[228:229], v[92:93] op_sel:[1,0,0] op_sel_hi:[1,1,1]
    v_pk_fma_f32 v[230:231], v[142:143], v[230:231], v[94:95] op_sel:[1,0,0] op_sel_hi:[1,1,1]
    v_max_f32 v216, 0, v216
    v_max_f32 v217, 0, v217
    v_max_f32 v218, 0, v218
    v_max_f32 v219, 0, v219
    v_max_f32 v228, 0, v228
    v_max_f32 v229, 0, v229
    v_max_f32 v230, 0, v230
    v_max_f32 v231, 0, v231
    v_pk_mul_f32 v[216:217], v[216:217], v[216:217]
    v_pk_mul_f32 v[218:219], v[218:219], v[218:219]
    v_pk_mul_f32 v[228:229], v[228:229], v[228:229]
    v_pk_mul_f32 v[230:231], v[230:231], v[230:231]
    v_cvt_pk_bf16_f32 v48, v216, v217
    v_cvt_pk_bf16_f32 v50, v228, v229
    v_cvt_pk_bf16_f32 v49, v218, v219
    v_cvt_pk_bf16_f32 v51, v230, v231
    v_permlane16_swap_b32_e64 v48, v50
    s_mov_b32 s38, 385024
    v_permlane16_swap_b32_e64 v49, v51
    buffer_store_dwordx4 v[48:51], v23, s[52:55], s38 offen offset:1024 sc1
    v_pk_fma_f32 v[232:233], v[144:145], v[148:149], v[232:233] op_sel_hi:[0,1,1] neg_lo:[1,0,0] neg_hi:[1,0,0]
    v_pk_fma_f32 v[234:235], v[144:145], v[150:151], v[234:235] op_sel_hi:[0,1,1] neg_lo:[1,0,0] neg_hi:[1,0,0]
    s_add_u32 m0, s73, 39936
    v_pk_fma_f32 v[244:245], v[146:147], v[148:149], v[244:245] op_sel_hi:[0,1,1] neg_lo:[1,0,0] neg_hi:[1,0,0]
    buffer_load_dwordx4 v22, s[52:55], s85 offen offset:0 sc1 lds
    v_pk_fma_f32 v[246:247], v[146:147], v[150:151], v[246:247] op_sel_hi:[0,1,1] neg_lo:[1,0,0] neg_hi:[1,0,0]
    v_pk_fma_f32 v[232:233], v[144:145], v[232:233], v[84:85] op_sel:[1,0,0] op_sel_hi:[1,1,1]
    v_pk_fma_f32 v[234:235], v[144:145], v[234:235], v[86:87] op_sel:[1,0,0] op_sel_hi:[1,1,1]
    v_pk_fma_f32 v[244:245], v[146:147], v[244:245], v[84:85] op_sel:[1,0,0] op_sel_hi:[1,1,1]
    v_pk_fma_f32 v[246:247], v[146:147], v[246:247], v[86:87] op_sel:[1,0,0] op_sel_hi:[1,1,1]
    v_max_f32 v232, 0, v232
    v_max_f32 v233, 0, v233
    v_max_f32 v234, 0, v234
    v_max_f32 v235, 0, v235
    v_max_f32 v244, 0, v244
    v_max_f32 v245, 0, v245
    v_max_f32 v246, 0, v246
    v_max_f32 v247, 0, v247
    v_pk_mul_f32 v[232:233], v[232:233], v[232:233]
    v_pk_mul_f32 v[234:235], v[234:235], v[234:235]
    v_pk_mul_f32 v[244:245], v[244:245], v[244:245]
    v_pk_mul_f32 v[246:247], v[246:247], v[246:247]
    v_cvt_pk_bf16_f32 v52, v232, v233
    v_cvt_pk_bf16_f32 v54, v244, v245
    v_cvt_pk_bf16_f32 v53, v234, v235
    v_cvt_pk_bf16_f32 v55, v246, v247
    v_permlane16_swap_b32_e64 v52, v54
    s_mov_b32 s38, 577536
    v_permlane16_swap_b32_e64 v53, v55
    buffer_store_dwordx4 v[52:55], v23, s[52:55], s38 offen offset:0 sc1
    v_pk_fma_f32 v[236:237], v[144:145], v[152:153], v[236:237] op_sel_hi:[0,1,1] neg_lo:[1,0,0] neg_hi:[1,0,0]
    v_pk_fma_f32 v[238:239], v[144:145], v[154:155], v[238:239] op_sel_hi:[0,1,1] neg_lo:[1,0,0] neg_hi:[1,0,0]
    v_pk_fma_f32 v[248:249], v[146:147], v[152:153], v[248:249] op_sel_hi:[0,1,1] neg_lo:[1,0,0] neg_hi:[1,0,0]
    v_pk_fma_f32 v[250:251], v[146:147], v[154:155], v[250:251] op_sel_hi:[0,1,1] neg_lo:[1,0,0] neg_hi:[1,0,0]
    v_pk_fma_f32 v[236:237], v[144:145], v[236:237], v[88:89] op_sel:[1,0,0] op_sel_hi:[1,1,1]
    v_pk_fma_f32 v[238:239], v[144:145], v[238:239], v[90:91] op_sel:[1,0,0] op_sel_hi:[1,1,1]
    v_pk_fma_f32 v[248:249], v[146:147], v[248:249], v[88:89] op_sel:[1,0,0] op_sel_hi:[1,1,1]
    s_add_u32 s85, s85, 5120
    v_pk_fma_f32 v[250:251], v[146:147], v[250:251], v[90:91] op_sel:[1,0,0] op_sel_hi:[1,1,1]
    v_max_f32 v236, 0, v236
    v_max_f32 v237, 0, v237
    v_max_f32 v238, 0, v238
    v_max_f32 v239, 0, v239
    v_max_f32 v248, 0, v248
    v_max_f32 v249, 0, v249
    v_max_f32 v250, 0, v250
    v_max_f32 v251, 0, v251
    v_pk_mul_f32 v[236:237], v[236:237], v[236:237]
    v_pk_mul_f32 v[238:239], v[238:239], v[238:239]
    v_pk_mul_f32 v[248:249], v[248:249], v[248:249]
    v_pk_mul_f32 v[250:251], v[250:251], v[250:251]
    v_cvt_pk_bf16_f32 v56, v236, v237
    v_cvt_pk_bf16_f32 v58, v248, v249
    v_cvt_pk_bf16_f32 v57, v238, v239
    v_cvt_pk_bf16_f32 v59, v250, v251
    v_permlane16_swap_b32_e64 v56, v58
    s_mov_b32 s38, 577536
    v_permlane16_swap_b32_e64 v57, v59
    buffer_store_dwordx4 v[56:59], v23, s[52:55], s38 offen offset:512 sc1
    v_pk_fma_f32 v[240:241], v[144:145], v[156:157], v[240:241] op_sel_hi:[0,1,1] neg_lo:[1,0,0] neg_hi:[1,0,0]
    v_pk_fma_f32 v[242:243], v[144:145], v[158:159], v[242:243] op_sel_hi:[0,1,1] neg_lo:[1,0,0] neg_hi:[1,0,0]
    v_pk_fma_f32 v[252:253], v[146:147], v[156:157], v[252:253] op_sel_hi:[0,1,1] neg_lo:[1,0,0] neg_hi:[1,0,0]
    v_pk_fma_f32 v[254:255], v[146:147], v[158:159], v[254:255] op_sel_hi:[0,1,1] neg_lo:[1,0,0] neg_hi:[1,0,0]
    v_pk_fma_f32 v[240:241], v[144:145], v[240:241], v[92:93] op_sel:[1,0,0] op_sel_hi:[1,1,1]
    v_pk_fma_f32 v[242:243], v[144:145], v[242:243], v[94:95] op_sel:[1,0,0] op_sel_hi:[1,1,1]
    v_pk_fma_f32 v[252:253], v[146:147], v[252:253], v[92:93] op_sel:[1,0,0] op_sel_hi:[1,1,1]
    v_pk_fma_f32 v[254:255], v[146:147], v[254:255], v[94:95] op_sel:[1,0,0] op_sel_hi:[1,1,1]
    v_max_f32 v240, 0, v240
    v_max_f32 v241, 0, v241
    v_max_f32 v242, 0, v242
    v_max_f32 v243, 0, v243
    v_max_f32 v252, 0, v252
    v_max_f32 v253, 0, v253
    v_max_f32 v254, 0, v254
    v_max_f32 v255, 0, v255
    v_pk_mul_f32 v[240:241], v[240:241], v[240:241]
    v_pk_mul_f32 v[242:243], v[242:243], v[242:243]
    v_pk_mul_f32 v[252:253], v[252:253], v[252:253]
    v_pk_mul_f32 v[254:255], v[254:255], v[254:255]
    v_cvt_pk_bf16_f32 v60, v240, v241
    v_cvt_pk_bf16_f32 v62, v252, v253
    v_cvt_pk_bf16_f32 v61, v242, v243
    v_cvt_pk_bf16_f32 v63, v254, v255
    v_permlane16_swap_b32_e64 v60, v62
    s_mov_b32 s38, 577536
    v_permlane16_swap_b32_e64 v61, v63
    buffer_store_dwordx4 v[60:63], v23, s[52:55], s38 offen offset:1024 sc1
    ds_read_b128 a[20:23], v19 offset:10240
    ds_read_b128 a[24:27], v19 offset:12288
    ds_read_b128 a[28:31], v19 offset:14336
    ds_read_b128 a[32:35], v19 offset:16384
    ds_read_b128 a[36:39], v19 offset:18432
    ds_read_b128 a[40:43], v20 offset:10240
    ds_read_b128 a[44:47], v20 offset:12288
    ds_read_b128 a[48:51], v20 offset:14336
    ds_read_b128 a[52:55], v20 offset:16384
    ds_read_b128 a[56:59], v20 offset:18432
    s_add_u32 m0, s73, 0
    s_nop 0
    buffer_load_dwordx4 v21, s[52:55], s85 offen offset:0 sc1 lds
    s_add_u32 m0, s73, 0
    s_nop 0
    buffer_load_dwordx4 v21, s[52:55], s85 offen offset:1024 sc1 lds
    s_add_u32 m0, s73, 0
    s_nop 0
    buffer_load_dwordx4 v21, s[52:55], s85 offen offset:2048 sc1 lds
    s_add_u32 m0, s73, 0
    s_nop 0
    buffer_load_dwordx4 v21, s[52:55], s85 offen offset:3072 sc1 lds
    s_add_u32 m0, s73, 4096
    s_nop 0
    buffer_load_dwordx4 v22, s[52:55], s85 offen offset:0 sc1 lds
    s_add_u32 s85, s85, 5120
    s_add_u32 m0, s73, 5120
    s_nop 0
    buffer_load_dwordx4 v21, s[52:55], s85 offen offset:0 sc1 lds
    s_add_u32 m0, s73, 5120
    s_nop 0
    buffer_load_dwordx4 v21, s[52:55], s85 offen offset:1024 sc1 lds
    s_add_u32 m0, s73, 5120
    s_nop 0
    buffer_load_dwordx4 v21, s[52:55], s85 offen offset:2048 sc1 lds
    s_waitcnt vmcnt(30)
    ds_read_b128 a[60:63], v19 offset:20480
    ds_read_b128 a[64:67], v19 offset:22528
    ds_read_b128 a[68:71], v19 offset:24576
    ds_read_b128 a[72:75], v19 offset:26624
    ds_read_b128 a[76:79], v19 offset:28672
    ds_read_b128 a[80:83], v20 offset:20480
    ds_read_b128 a[84:87], v20 offset:22528
    ds_read_b128 a[88:91], v20 offset:24576
    ds_read_b128 a[92:95], v20 offset:26624
    ds_read_b128 a[96:99], v20 offset:28672
    s_nop 0
    v_accvgpr_read_b32 v3, a108
    v_accvgpr_read_b32 v4, a109
    v_accvgpr_read_b32 v13, a110
    v_accvgpr_read_b32 v5, a111
    v_accvgpr_read_b32 v148, a112
    v_accvgpr_read_b32 v149, a113
    v_accvgpr_read_b32 v150, a114
    v_accvgpr_read_b32 v151, a115
    v_accvgpr_read_b32 v6, a116
    v_accvgpr_read_b32 v152, a117
    v_add_u32 v12, 4096, v3
    s_cmp_eq_u32 s64, 3
    s_cselect_b32 s3, 134217728, 0
    v_add_u32 v7, s3, v12
    s_waitcnt vmcnt(8) lgkmcnt(0)
    s_barrier
    s_cmp_lg_u32 s64, 0
    s_cbranch_scc1 L_fsF
    s_lshl4_add_u32 s3, s65, s67
    s_lshl_b32 s3, s3, 7
    s_add_u32 s3, s3, 18087936
    s_mov_b64 exec, 0xff
    buffer_store_dwordx4 a[252:255], v21, s[52:55], s3 offen sc1
    s_mov_b64 exec, -1
L_fsF:
    s_add_u32 m0, s73, 25600
    s_nop 0
    buffer_load_dwordx4 v148, s[40:43], s5 offen lds
    s_add_u32 m0, s73, 26624
    s_nop 0
    buffer_load_dwordx4 v149, s[40:43], s5 offen lds
    s_add_u32 m0, s73, 27648
    s_nop 0
    buffer_load_dwordx4 v150, s[40:43], s5 offen lds
    s_add_u32 m0, s73, 28672
    s_nop 0
    global_load_lds_dwordx4 v151, s[20:21]
    s_add_u32 m0, s73, 29696
    s_nop 0
    global_load_lds_dwordx4 v151, s[30:31]
    buffer_load_dwordx2 a[244:245], v152, s[52:55], 0 offen sc1
    s_add_u32 m0, s73, 5120
    s_nop 0
    buffer_load_dwordx4 v21, s[52:55], s85 offen offset:3072 sc1 lds
    s_add_u32 m0, s73, 9216
    s_nop 0
    buffer_load_dwordx4 v22, s[52:55], s85 offen offset:0 sc1 lds
    s_add_u32 s85, s85, 5120
    s_add_u32 m0, s73, 10240
    s_nop 0
    buffer_load_dwordx4 v21, s[52:55], s85 offen offset:0 sc1 lds
    s_add_u32 m0, s73, 10240
    s_nop 0
    buffer_load_dwordx4 v21, s[52:55], s85 offen offset:1024 sc1 lds
    s_add_u32 m0, s73, 10240
    s_nop 0
    buffer_load_dwordx4 v21, s[52:55], s85 offen offset:2048 sc1 lds
    s_add_u32 m0, s73, 10240
    s_nop 0
    buffer_load_dwordx4 v21, s[52:55], s85 offen offset:3072 sc1 lds
    s_add_u32 m0, s73, 14336
    s_nop 0
    buffer_load_dwordx4 v22, s[52:55], s85 offen offset:0 sc1 lds
    s_add_u32 s85, s85, 5120
    s_add_u32 m0, s73, 15360
    s_nop 0
    buffer_load_dwordx4 v21, s[52:55], s85 offen offset:0 sc1 lds
    s_add_u32 m0, s73, 15360
    s_nop 0
    buffer_load_dwordx4 v21, s[52:55], s85 offen offset:1024 sc1 lds
    s_load_dword s16, s[14:15], 0 glc
    s_load_dword s17, s[14:15], 128 glc
    s_add_u32 m0, s73, 15360
    s_nop 0
    buffer_load_dwordx4 v21, s[52:55], s85 offen offset:2048 sc1 lds
    s_add_u32 m0, s73, 15360
    s_nop 0
    buffer_load_dwordx4 v21, s[52:55], s85 offen offset:3072 sc1 lds
    s_add_u32 m0, s73, 19456
    s_nop 0
    buffer_load_dwordx4 v22, s[52:55], s85 offen offset:0 sc1 lds
    s_add_u32 s85, s85, 5120
    s_cmp_eq_u32 s64, 3
    s_cselect_b32 s3, 134217728, 0
    v_add_u32 v47, s3, v21
    v_add_u32_e64 v22, s3, v22
    s_add_u32 m0, s73, 20480
    s_nop 0
    buffer_load_dwordx4 v47, s[52:55], s85 offen offset:0 sc1 lds
    s_add_u32 m0, s73, 20480
    s_nop 0
    buffer_load_dwordx4 v47, s[52:55], s85 offen offset:1024 sc1 lds
    s_add_u32 m0, s73, 20480
    s_nop 0
    buffer_load_dwordx4 v47, s[52:55], s85 offen offset:2048 sc1 lds
    s_add_u32 m0, s73, 20480
    s_nop 0
    buffer_load_dwordx4 v47, s[52:55], s85 offen offset:3072 sc1 lds
    s_add_u32 m0, s73, 24576
    s_nop 0
    buffer_load_dwordx4 v22, s[52:55], s85 offen offset:0 sc1 lds
    s_waitcnt lgkmcnt(0)
    s_xor_b32 s16, s16, s34
    s_xor_b32 s17, s17, s34
    s_or_b32 s16, s16, s17
    s_cbranch_scc0 L_pfFd
    s_mov_b32 s3, 0
L_pfFl:
    s_load_dword s16, s[14:15], 0 glc
    s_load_dword s17, s[14:15], 128 glc
    s_add_u32 s3, s3, 1
    s_cmp_ge_u32 s3, 400000
    s_cbranch_scc1 L_pfFd
    s_waitcnt lgkmcnt(0)
    s_xor_b32 s16, s16, s34
    s_xor_b32 s17, s17, s34
    s_or_b32 s16, s16, s17
    s_cbranch_scc1 L_pfFl
L_pfFd:
    buffer_load_dwordx4 a[100:103], v3, s[52:55], s10 offen offset:0 sc1
    buffer_load_dwordx4 a[104:107], v3, s[52:55], s10 offen offset:1024 sc1
    buffer_load_dwordx4 a[108:111], v3, s[52:55], s10 offen offset:2048 sc1
    buffer_load_dwordx4 a[112:115], v3, s[52:55], s10 offen offset:3072 sc1
    s_waitcnt vmcnt(19)
    ds_read_b64_tr_b16 a[164:165], v5 offset:30720
    ds_read_b64_tr_b16 a[166:167], v5 offset:32000
    ds_read_b64_tr_b16 a[184:185], v5 offset:35840
    ds_read_b64_tr_b16 a[186:187], v5 offset:37120
    ds_read_b64_tr_b16 a[204:205], v5 offset:0
    ds_read_b64_tr_b16 a[206:207], v5 offset:1280
    ds_read_b64_tr_b16 a[224:225], v5 offset:5120
    ds_read_b64_tr_b16 a[226:227], v5 offset:6400
    ds_read_b64_tr_b16 a[168:169], v5 offset:30752
    ds_read_b64_tr_b16 a[170:171], v5 offset:32032
    ds_read_b64_tr_b16 a[188:189], v5 offset:35872
    ds_read_b64_tr_b16 a[190:191], v5 offset:37152
    ds_read_b64_tr_b16 a[208:209], v5 offset:32
    ds_read_b64_tr_b16 a[210:211], v5 offset:1312
    ds_read_b64_tr_b16 a[228:229], v5 offset:5152
    ds_read_b64_tr_b16 a[230:231], v5 offset:6432
    ds_read_b64_tr_b16 a[172:173], v5 offset:30784
    ds_read_b64_tr_b16 a[174:175], v5 offset:32064
    ds_read_b64_tr_b16 a[192:193], v5 offset:35904
    ds_read_b64_tr_b16 a[194:195], v5 offset:37184
    ds_read_b64_tr_b16 a[212:213], v5 offset:64
    ds_read_b64_tr_b16 a[214:215], v5 offset:1344
    ds_read_b64_tr_b16 a[232:233], v5 offset:5184
    ds_read_b64_tr_b16 a[234:235], v5 offset:6464
    ds_read_b64_tr_b16 a[176:177], v5 offset:30816
    ds_read_b64_tr_b16 a[178:179], v5 offset:32096
    ds_read_b64_tr_b16 a[196:197], v5 offset:35936
    ds_read_b64_tr_b16 a[198:199], v5 offset:37216
    ds_read_b64_tr_b16 a[216:217], v5 offset:96
    ds_read_b64_tr_b16 a[218:219], v5 offset:1376
    ds_read_b64_tr_b16 a[236:237], v5 offset:5216
    ds_read_b64_tr_b16 a[238:239], v5 offset:6496
    ds_read_b64_tr_b16 a[180:181], v5 offset:30848
    ds_read_b64_tr_b16 a[182:183], v5 offset:32128
    ds_read_b64_tr_b16 a[200:201], v5 offset:35968
    ds_read_b64_tr_b16 a[202:203], v5 offset:37248
    ds_read_b64_tr_b16 a[220:221], v5 offset:128
    ds_read_b64_tr_b16 a[222:223], v5 offset:1408
    ds_read_b64_tr_b16 a[240:241], v5 offset:5248
    ds_read_b64_tr_b16 a[242:243], v5 offset:6528
    s_branch L_join
L_ssm:
    s_lshl2_add_u32 s0, s67, s64
    v_and_b32 v34, 1, v1
    v_lshrrev_b32 v35, 1, v1
    v_and_b32 v39, 6, v35
    v_or_b32 v39, v39, v34
    v_xor_b32 v39, v39, v2
    v_lshlrev_b32_e64 v43, 10, v34
    v_lshl_add_u32 v43, v35, 7, v43
    v_lshl_add_u32 v43, v39, 4, v43
    s_add_u32 s3, s73, 4096
    v_add_u32 v11, s3, v43
    v_xor_b32_e64 v12, 64, v11
    s_mul_i32 s1, s0, 3
    s_mul_i32 s3, s65, 770048
    s_lshl_b32 s38, s1, 8
    s_add_u32 s3, s3, s38
    s_add_u32 s3, s3, 55296
    v_lshrrev_b32 v34, 1, v2
    v_and_b32 v35, 1, v2
    v_mul_u32_u24 v43, 96256, v34
    v_mul_u32_u24 v35, 20480, v35
    v_lshl_add_u32 v43, v1, 4, v43
    v_add3_u32 v43, v43, v35, s3
    s_cmp_lt_u32 s1, 80
    s_cselect_b32 s38, 0, 134217728
    v_add_u32_e64 v23, s38, v43
    s_cmp_lt_u32 s1, 79
    s_cselect_b32 s38, 0, 134217728
    v_add_u32_e64 v24, s38, v43
    s_cmp_lt_u32 s1, 78
    s_cselect_b32 s38, 0, 134217728
    v_add_u32 v25, s38, v43
    s_lshl_b32 s3, s67, 14
    s_lshl_b32 s38, s64, 8
    s_add_u32 s3, s3, s38
    s_add_u32 s3, s3, 17891328
    v_cmp_gt_u32 vcc, s65, v1
    v_lshl_add_u32 v34, v2, 4, s3
    v_lshl_add_u32 v35, v1, 10, v34
    v_cndmask_b32 v27, v38, v35, vcc
    v_cmp_le_u32 vcc, 15, v1
    s_lshl_b32 s38, s65, 10
    v_add_u32 v34, s38, v34
    v_cndmask_b32 v26, v38, v34, vcc
    s_add_u32 s83, s3, s38
    v_mov_b32 v39, -1
    v_lshlrev_b32 v43, 2, v0
    s_lshl3_add_u32 s3, s74, s75
    s_lshl1_add_u32 s3, s3, s35
    s_lshl2_add_u32 s3, s3, s64
    s_xor_b32 s3, s3, 4
    s_lshl_b32 s3, s3, 7
    s_add_u32 s3, s3, 18612224
    v_add_u32_e64 v34, s3, v21
    s_lshl4_add_u32 s3, s65, s67
    s_lshl_b32 s3, s3, 7
    s_add_u32 s3, s3, 18088960
    s_cmp_eq_u32 s64, 0
    s_cselect_b32 s3, s3, 134217728
    s_lshl3_add_u32 s82, s65, s67
    s_lshl2_add_u32 s82, s82, s64
    s_lshl_b32 s82, s82, 7
    s_add_u32 s82, s82, 18153472
    s_sub_u32 s3, s82, 128
    v_cmp_gt_u32 vcc, 8, v0
    v_add_u32_e64 v35, s3, v21
    s_nop 0
    v_cndmask_b32 v34, v35, v34, vcc
    s_waitcnt lgkmcnt(0)
    s_mul_i32 s34, s34, 0x9e3779b1
    s_add_u32 s34, s34, 0x7f4a7c15
    s_or_b32 s34, s34, 1
    v_accvgpr_write_b32 a252, s34
    v_accvgpr_write_b32 a253, s34
    v_accvgpr_write_b32 a254, s34
    v_accvgpr_write_b32 a255, s34
    s_mul_i32 s3, s35, 27
    s_mul_i32 s0, s64, 7
    s_add_u32 s3, s3, s0
    s_lshl_b32 s3, s3, 10
    v_add_u32 v202, s3, v21
    v_accvgpr_write_b32 a108, v202
    s_lshl2_add_u32 s0, s35, s64
    s_mul_i32 s0, s0, 5120
    s_add_u32 s0, s0, 55296
    s_bitcmp1_b32 s64, 0
    s_cselect_b32 s3, 1024, 0
    s_cselect_b32 s1, 0, 4096
    s_add_u32 s3, s3, s0
    v_add_u32 v202, s3, v21
    v_accvgpr_write_b32 a109, v202
    s_add_u32 s1, s1, s0
    v_add_u32 v202, s1, v21
    v_accvgpr_write_b32 a110, v202
    v_lshrrev_b32 v200, 1, v2
    v_lshlrev_b32 v200, 4, v200
    v_and_b32_e64 v201, 1, v2
    v_lshl_add_u32 v200, v201, 2, v200
    v_lshrrev_b32 v201, 2, v1
    v_add_u32 v200, v200, v201
    v_mul_u32_u24 v200, 160, v200
    v_and_b32_e64 v201, 3, v1
    v_lshl_add_u32 v200, v201, 3, v200
    v_add_u32_e64 v202, s73, v200
    v_accvgpr_write_b32 a111, v202
    s_lshl1_add_u32 s0, s74, s35
    s_mul_i32 s24, s0, 385024
    s_xor_b32 s0, s0, 1
    s_mul_i32 s10, s0, 385024
    s_add_u32 s11, s10, 96256
    s_add_u32 s12, s10, 192512
    s_add_u32 s13, s10, 288768
    s_add_u32 s25, s24, 96256
    s_add_u32 s28, s24, 192512
    s_add_u32 s29, s24, 288768
    s_lshl2_add_u32 s0, s35, s64
    s_lshl_b32 s1, s74, 7
    s_add_u32 s0, s0, s1
    s_mul_i32 s1, s75, 160
    s_mul_i32 s5, s0, 1280
    s_add_u32 s5, s5, s1
    v_add_u32_e64 v200, 0, v0
    buffer_load_dwordx4 v[44:47], v36, s[40:43], 0 offen
    v_mul_u32_u24 v201, 6554, v200
    v_lshrrev_b32_e64 v201, 16, v201
    v_mul_u32_u24 v201, 10080, v201
    v_lshl_add_u32 v202, v200, 4, v201
    v_accvgpr_write_b32 a112, v202
    v_add_u32_e64 v200, 64, v0
    buffer_load_dwordx4 v[142:145], v36, s[40:43], 0 offen offset:512
    v_mul_u32_u24 v201, 6554, v200
    v_lshrrev_b32_e64 v201, 16, v201
    v_mul_u32_u24 v201, 10080, v201
    v_lshl_add_u32 v202, v200, 4, v201
    v_accvgpr_write_b32 a113, v202
    v_add_u32 v200, 128, v0
    buffer_load_dwordx2 v[146:147], v37, s[40:43], 0 offen offset:1024
    v_min_u32 v200, 159, v200
    v_mul_u32_u24 v201, 6554, v200
    v_lshrrev_b32_e64 v201, 16, v201
    v_mul_u32_u24 v201, 10080, v201
    v_lshl_add_u32 v202, v200, 4, v201
    v_accvgpr_write_b32 a114, v202
    buffer_store_dword v39, v43, s[52:55], s83 offen sc1
    v_min_u32_e64 v200, 9, v0
    v_lshl_add_u32 v202, v200, 4, s1
    v_accvgpr_write_b32 a115, v202
    v_and_b32 v201, 12, v0
    v_add_u32 v202, v201, v2
    v_lshl_add_u32 v200, v202, 3, s0
    v_accvgpr_write_b32 a116, v202
    s_mov_b64 exec, 0xffff
    buffer_store_dwordx4 a[248:251], v34, s[52:55], 0 offen sc1
    s_mov_b64 exec, -1
    v_lshlrev_b32 v200, 3, v200
    v_add_u32 v202, 17825792, v200
    v_accvgpr_write_b32 a117, v202
    s_mul_i32 s3, s35, 27
    s_mul_i32 s0, s64, 7
    s_add_u32 s3, s3, s0
    s_mul_i32 s3, s3, 43
    s_lshr_b32 s3, s3, 8
    s_min_u32 s3, s3, 7
    s_lshl4_add_u32 s3, s74, s3
    s_lshl_b32 s3, s3, 7
    s_add_u32 s3, s3, 18087936
    s_add_u32 s14, s36, s3
    s_addc_u32 s15, s37, 0
    v_min_u32 v13, 11, v0
    v_and_b32 v13, 3, v13
    v_lshl_add_u32 v13, s64, 2, v13
    s_max_u32 s3, s65, 1
    s_sub_u32 s3, s3, 1
    v_min_u32_e64 v14, s3, v13
    v_lshl_add_u32 v14, v14, 4, s66
    s_add_u32 s68, s68, 1
    s_cmp_ge_u32 s68, 10
    s_cselect_b32 s68, 0, s68
    v_cmp_gt_u32 vcc, 8, v0
    s_lshl_b32 s3, s74, 4
    v_add_u32 v29, s3, v13
    v_cndmask_b32 v14, v29, v14, vcc
    v_cmp_gt_u32 vcc, 4, v0
    s_lshl_b32 s3, s65, 4
    v_add_u32 v13, s3, v13
    v_cndmask_b32 v13, v14, v13, vcc
    v_lshlrev_b32 v13, 7, v13
    v_add_u32 v29, 18415616, v13
    s_and_b32 s3, s64, 1
    s_mul_i32 s23, s3, 5120
    s_add_u32 s23, s23, s22
    s_bitcmp1_b32 s64, 0
    s_cselect_b64 vcc, -1, 0
    s_movk_i32 s3, 0x100
    s_cselect_b32 s3, 40832, s3
    v_cndmask_b32 v204, v17, v18, vcc
    v_cndmask_b32 v205, v18, v17, vcc
    v_cndmask_b32 v206, v7, v9, vcc
    v_add_u32_e64 v204, s3, v204
    s_bitcmp1_b32 s64, 0
    s_movk_i32 s3, 0x100
    s_cselect_b32 s3, 61312, s3
    v_add_u32 v205, s3, v205
    s_lshl_b32 s69, s68, 7
    v_add_u32_e64 v206, s22, v206
    v_accvgpr_write_b32 a124, v204
    v_accvgpr_write_b32 a125, v205
    v_accvgpr_write_b32 a126, v206
    v_add_u32 v22, 4096, v21
    s_mul_i32 s3, s64, 7
    v_min_u32 v31, 6, v0
    v_add_u32 v31, s3, v31
    v_min_u32 v31, 26, v31
    s_add_u32 s71, s69, 10240
    s_mul_i32 s3, s35, 216
    s_add_u32 s3, s3, s75
    v_lshl_add_u32 v31, v31, 3, s3
    v_mul_u32_u24 v31, 21846, v31
    v_lshrrev_b32 v31, 16, v31
    v_lshlrev_b32_e64 v31, 7, v31
    v_add_u32 v31, 18481152, v31
    s_lshl_b32 s18, s65, 10
    s_add_u32 s18, s18, 17825792
    s_waitcnt vmcnt(11)
    v_lshlrev_b32_e64 v160, 16, v132
    v_mul_f32 v160, 0x3fb8aa3b, v160
    s_add_u32 s72, s69, 20480
    v_exp_f32 v160, v160
    v_lshlrev_b32 v162, 16, v133
    v_lshlrev_b32 v163, 16, v134
    v_mul_f32 v165, v162, v162
    v_cvt_pk_bf16_f32 v160, v160, v160
    v_fmac_f32_e64 v165, v163, v163
    s_add_u32 m0, s73, 10240
    v_lshlrev_b32_e64 v160, 16, v160
    buffer_load_dwordx4 v3, s[40:43], s69 offen offset:0 lds
    v_rcp_f32 v165, v165
    v_mul_f32 v181, v163, v160
    v_mul_f32 v180, v162, v160
    v_mul_f32 v181, 0.15915494, v181
    v_mul_f32 v180, 0x3fb8aa3b, v180
    s_add_u32 m0, s73, 11264
    v_fract_f32_e64 v161, v181
    buffer_load_dwordx4 v4, s[40:43], s69 offen offset:0 lds
    v_exp_f32 v160, v180
    v_cos_f32 v168, v161
    v_sin_f32_e64 v169, v161
    v_lshl_add_u32 v166, v0, 3, s73
    v_lshl_add_u32 v167, v2, 4, s73
    s_add_u32 m0, s73, 11008
    v_add_f32_e64 v165, v165, v165
    buffer_load_dwordx4 v3, s[40:43], s69 offen offset:1280 lds
    ds_write_b64 v166, v[180:181] offset:33792
    v_pk_mul_f32 v[168:169], v[168:169], v[160:161] op_sel_hi:[1,0]
    v_pk_mul_f32 v[172:173], v[168:169], v[168:169] op_sel_hi:[0,1]
    v_add_f32_e64 v164, -1.0, v168
    v_pk_fma_f32 v[172:173], v[168:169], v[168:169], v[172:173] op_sel:[1,1,0] op_sel_hi:[1,0,1] neg_lo:[1,0,0]
    s_add_u32 m0, s73, 12032
    v_mul_f32_e64 v179, v169, v162
    buffer_load_dwordx4 v4, s[40:43], s69 offen offset:1280 lds
    v_pk_mul_f32 v[174:175], v[172:173], v[172:173] op_sel_hi:[0,1]
    v_mul_f32_e64 v178, v164, v162
    v_pk_fma_f32 v[174:175], v[172:173], v[172:173], v[174:175] op_sel:[1,1,0] op_sel_hi:[1,0,1] neg_lo:[1,0,0]
    v_fma_f32 v179, -v164, v163, v179
    v_pk_mul_f32 v[170:171], v[174:175], v[174:175] op_sel_hi:[0,1]
    s_add_u32 m0, s73, 14336
    v_fmac_f32_e64 v178, v169, v163
    buffer_load_dwordx4 v5, s[44:47], s69 offen lds
    v_pk_fma_f32 v[170:171], v[174:175], v[174:175], v[170:171] op_sel:[1,1,0] op_sel_hi:[1,0,1] neg_lo:[1,0,0]
    v_mul_f32_e64 v179, v179, v165
    v_pk_mul_f32 v[172:173], v[170:171], v[170:171] op_sel_hi:[0,1]
    v_mul_f32_e64 v178, v178, v165
    v_pk_fma_f32 v[172:173], v[170:171], v[170:171], v[172:173] op_sel:[1,1,0] op_sel_hi:[1,0,1] neg_lo:[1,0,0]
    ds_write_b64 v166, v[168:169] offset:30720
    s_add_u32 m0, s73, 15360
    v_pk_mul_f32 v[174:175], v[172:173], v[172:173] op_sel_hi:[0,1]
    buffer_load_dwordx4 v6, s[48:51], s69 offen lds
    ds_write_b64 v166, v[178:179] offset:33280
    v_pk_fma_f32 v[174:175], v[172:173], v[172:173], v[174:175] op_sel:[1,1,0] op_sel_hi:[1,0,1] neg_lo:[1,0,0]
    ds_write_b64 v166, v[170:171] offset:31232
    v_pk_mul_f32 v[176:177], v[174:175], v[174:175] op_sel_hi:[0,1]
    ds_write_b64 v166, v[172:173] offset:31744
    s_add_u32 m0, s73, 16384
    v_pk_fma_f32 v[176:177], v[174:175], v[174:175], v[176:177] op_sel:[1,1,0] op_sel_hi:[1,0,1] neg_lo:[1,0,0]
    buffer_load_dwordx4 v5, s[44:47], s71 offen lds
    ds_write_b64 v166, v[174:175] offset:32256
    ds_write_b64 v166, v[176:177] offset:32768
    s_waitcnt lgkmcnt(0)
    ds_read_b128 v[48:51], v167 offset:30720
    ds_read_b128 v[52:55], v167 offset:30784
    s_add_u32 m0, s73, 17408
    ds_read_b128 v[56:59], v167 offset:30848
    buffer_load_dwordx4 v6, s[48:51], s71 offen lds
    ds_read_b128 v[60:63], v167 offset:31232
    ds_read_b128 v[64:67], v167 offset:31296
    ds_read_b128 v[68:71], v167 offset:31360
    ds_read_b128 v[72:75], v167 offset:31744
    ds_read_b128 v[76:79], v167 offset:31808
    s_add_u32 m0, s73, 18432
    ds_read_b128 v[80:83], v167 offset:31872
    buffer_load_dwordx4 v5, s[44:47], s72 offen lds
    ds_read_b128 v[84:87], v167 offset:32256
    ds_read_b128 v[88:91], v167 offset:32320
    ds_read_b128 v[92:95], v167 offset:32384
    ds_read_b128 v[96:99], v167 offset:32768
    ds_read_b128 v[100:103], v167 offset:32832
    s_add_u32 m0, s73, 19456
    ds_read_b128 v[104:107], v167 offset:32896
    buffer_load_dwordx4 v6, s[48:51], s72 offen lds
    ds_read_b128 v[108:111], v167 offset:33280
    ds_read_b128 v[112:115], v167 offset:33344
    ds_read_b128 v[116:119], v167 offset:33408
    ds_read_b128 v[120:123], v167 offset:33792
    ds_read_b128 v[124:127], v167 offset:33856
    ds_read_b128 v[128:131], v167 offset:33920
    s_waitcnt vmcnt(15)
    s_barrier
    ds_read_b128 a[224:227], v11 offset:0
    ds_read_b128 a[236:239], v12 offset:0
    ds_read_b128 a[228:231], v11 offset:2048
    ds_read_b128 a[240:243], v12 offset:2048
    ds_read_b128 a[232:235], v11 offset:4096
    ds_read_b128 a[244:247], v12 offset:4096
    ds_read_b128 a[160:163], v7 offset:0
    ds_read_b128 a[164:167], v9 offset:0
    ds_read_b128 a[168:171], v7 offset:2048
    ds_read_b128 a[172:175], v9 offset:2048
    ds_read_b128 a[176:179], v7 offset:40960
    ds_read_b128 a[180:183], v9 offset:40960
    ds_read_b128 a[184:187], v7 offset:43008
    ds_read_b128 a[188:191], v9 offset:43008
    s_waitcnt lgkmcnt(0)
    v_mfma_f32_16x16x32_bf16 v[160:163], a[224:227], a[160:163], 0
    ds_read_b128 a[192:195], v8 offset:0
    v_mfma_f32_16x16x32_bf16 v[160:163], a[236:239], a[164:167], v[160:163]
    s_add_u32 s68, s68, 1
    s_cmp_ge_u32 s68, 10
    s_cselect_b32 s68, 0, s68
    v_mfma_f32_16x16x32_bf16 v[164:167], a[240:243], a[164:167], 0
    ds_read_b128 a[196:199], v10 offset:0
    v_mfma_f32_16x16x32_bf16 v[164:167], a[228:231], a[160:163], v[164:167]
    ds_read_b128 a[200:203], v8 offset:2048
    v_mfma_f32_16x16x32_bf16 v[168:171], a[232:235], a[160:163], 0
    s_lshl_b32 s69, s68, 7
    v_mfma_f32_16x16x32_bf16 v[168:171], a[244:247], a[164:167], v[168:171]
    ds_read_b128 a[204:207], v10 offset:2048
    v_mfma_f32_16x16x32_bf16 v[180:183], a[244:247], a[172:175], 0
    v_mfma_f32_16x16x32_bf16 v[180:183], a[232:235], a[168:171], v[180:183]
    s_add_u32 s71, s69, 10240
    ds_read_b128 a[208:211], v8 offset:40960
    v_mfma_f32_16x16x32_bf16 v[176:179], a[228:231], a[168:171], 0
    v_mfma_f32_16x16x32_bf16 v[176:179], a[240:243], a[172:175], v[176:179]
    ds_read_b128 a[212:215], v10 offset:40960
    v_mfma_f32_16x16x32_bf16 v[172:175], a[236:239], a[172:175], 0
    s_add_u32 s72, s69, 20480
    ds_read_b128 a[216:219], v8 offset:43008
    v_mfma_f32_16x16x32_bf16 v[172:175], a[224:227], a[168:171], v[172:175]
    v_mfma_f32_16x16x32_bf16 v[184:187], a[224:227], a[176:179], 0
    ds_read_b128 a[220:223], v10 offset:43008
    v_mfma_f32_16x16x32_bf16 v[184:187], a[236:239], a[180:183], v[184:187]
    s_add_u32 m0, s73, 20480
    v_mfma_f32_16x16x32_bf16 v[188:191], a[240:243], a[180:183], 0
    buffer_load_dwordx4 v3, s[40:43], s69 offen offset:0 lds
    v_mfma_f32_16x16x32_bf16 v[188:191], a[228:231], a[176:179], v[188:191]
    v_mfma_f32_16x16x32_bf16 v[192:195], a[232:235], a[176:179], 0
    s_add_u32 m0, s73, 21504
    v_mfma_f32_16x16x32_bf16 v[192:195], a[244:247], a[180:183], v[192:195]
    buffer_load_dwordx4 v4, s[40:43], s69 offen offset:0 lds
    v_mfma_f32_16x16x32_bf16 v[204:207], a[244:247], a[188:191], 0
    v_mfma_f32_16x16x32_bf16 v[204:207], a[232:235], a[184:187], v[204:207]
    s_add_u32 m0, s73, 21248
    v_mfma_f32_16x16x32_bf16 v[200:203], a[228:231], a[184:187], 0
    buffer_load_dwordx4 v3, s[40:43], s69 offen offset:1280 lds
    v_mfma_f32_16x16x32_bf16 v[200:203], a[240:243], a[188:191], v[200:203]
    v_mfma_f32_16x16x32_bf16 v[196:199], a[236:239], a[188:191], 0
    v_mfma_f32_16x16x32_bf16 v[196:199], a[224:227], a[184:187], v[196:199]
    s_add_u32 m0, s73, 22272
    s_waitcnt vmcnt(15)
    buffer_load_dwordx4 v4, s[40:43], s69 offen offset:1280 lds
    v_lshlrev_b32 v32, 16, v44
    v_and_b32 v33, 0xffff0000, v44
    v_lshlrev_b32_e64 v34, 16, v45
    v_and_b32 v35, 0xffff0000, v45
    v_lshlrev_b32_e64 v36, 16, v46
    v_and_b32 v37, 0xffff0000, v46
    v_lshlrev_b32_e64 v38, 16, v47
    v_and_b32 v39, 0xffff0000, v47
    v_lshlrev_b32_e64 v40, 16, v142
    v_and_b32 v41, 0xffff0000, v142
    s_add_u32 m0, s73, 24576
    v_lshlrev_b32_e64 v42, 16, v143
    buffer_load_dwordx4 v5, s[44:47], s69 offen lds
    v_and_b32 v43, 0xffff0000, v143
    v_lshlrev_b32_e64 v132, 16, v144
    v_and_b32 v133, 0xffff0000, v144
    v_lshlrev_b32_e64 v134, 16, v145
    v_and_b32 v135, 0xffff0000, v145
    v_lshlrev_b32_e64 v136, 16, v146
    v_and_b32 v137, 0xffff0000, v146
    v_lshlrev_b32_e64 v138, 16, v147
    v_and_b32 v139, 0xffff0000, v147
    v_pk_add_f32 v[140:141], v[32:33], v[34:35]
    v_pk_add_f32 v[140:141], v[140:141], v[36:37]
    s_add_u32 m0, s73, 25600
    v_pk_add_f32 v[140:141], v[140:141], v[38:39]
    buffer_load_dwordx4 v6, s[48:51], s69 offen lds
    v_pk_add_f32 v[140:141], v[140:141], v[40:41]
    v_pk_add_f32 v[140:141], v[140:141], v[42:43]
    v_pk_add_f32 v[140:141], v[140:141], v[132:133]
    v_pk_add_f32 v[140:141], v[140:141], v[134:135]
    v_pk_add_f32 v[140:141], v[140:141], v[136:137]
    v_pk_add_f32 v[140:141], v[140:141], v[138:139]
    v_add_f32 v140, v140, v141
    s_nop 1
    v_add_f32_dpp v140, v140, v140 row_ror:8 row_mask:0xf bank_mask:0xf
    s_nop 1
    v_add_f32_dpp v140, v140, v140 row_ror:4 row_mask:0xf bank_mask:0xf
    s_nop 1
    v_add_f32_dpp v140, v140, v140 row_ror:2 row_mask:0xf bank_mask:0xf
    s_add_u32 m0, s73, 26624
    s_nop 0
    v_add_f32_dpp v140, v140, v140 row_ror:1 row_mask:0xf bank_mask:0xf
    buffer_load_dwordx4 v5, s[44:47], s71 offen lds
    v_mov_b32 v141, v140
    s_nop 1
    v_permlane16_swap_b32 v140, v141
    v_add_f32_e64 v140, v140, v141
    v_mul_f32 v140, 0x3acccccd, v140
    v_cvt_pk_bf16_f32 v44, v140, v140
    v_lshlrev_b32_e64 v44, 16, v44
    v_pk_add_f32 v[32:33], v[32:33], v[140:141] op_sel_hi:[1,0] neg_lo:[0,1] neg_hi:[0,1]
    v_pk_add_f32 v[34:35], v[34:35], v[140:141] op_sel_hi:[1,0] neg_lo:[0,1] neg_hi:[0,1]
    v_pk_add_f32 v[36:37], v[36:37], v[140:141] op_sel_hi:[1,0] neg_lo:[0,1] neg_hi:[0,1]
    v_pk_add_f32 v[38:39], v[38:39], v[140:141] op_sel_hi:[1,0] neg_lo:[0,1] neg_hi:[0,1]
    v_pk_add_f32 v[40:41], v[40:41], v[140:141] op_sel_hi:[1,0] neg_lo:[0,1] neg_hi:[0,1]
    s_add_u32 m0, s73, 27648
    v_pk_add_f32 v[42:43], v[42:43], v[140:141] op_sel_hi:[1,0] neg_lo:[0,1] neg_hi:[0,1]
    buffer_load_dwordx4 v6, s[48:51], s71 offen lds
    v_pk_add_f32 v[132:133], v[132:133], v[140:141] op_sel_hi:[1,0] neg_lo:[0,1] neg_hi:[0,1]
    v_pk_add_f32 v[134:135], v[134:135], v[140:141] op_sel_hi:[1,0] neg_lo:[0,1] neg_hi:[0,1]
    v_pk_add_f32 v[136:137], v[136:137], v[140:141] op_sel_hi:[1,0] neg_lo:[0,1] neg_hi:[0,1]
    v_pk_add_f32 v[138:139], v[138:139], v[140:141] op_sel_hi:[1,0] neg_lo:[0,1] neg_hi:[0,1]
    v_pk_mul_f32 v[140:141], v[32:33], v[32:33]
    v_pk_fma_f32 v[140:141], v[34:35], v[34:35], v[140:141]
    v_pk_fma_f32 v[140:141], v[36:37], v[36:37], v[140:141]
    v_pk_fma_f32 v[140:141], v[38:39], v[38:39], v[140:141]
    v_pk_fma_f32 v[140:141], v[40:41], v[40:41], v[140:141]
    v_pk_fma_f32 v[140:141], v[42:43], v[42:43], v[140:141]
    s_add_u32 m0, s73, 28672
    v_pk_fma_f32 v[140:141], v[132:133], v[132:133], v[140:141]
    buffer_load_dwordx4 v5, s[44:47], s72 offen lds
    v_pk_fma_f32 v[140:141], v[134:135], v[134:135], v[140:141]
    v_pk_fma_f32 v[140:141], v[136:137], v[136:137], v[140:141]
    v_pk_fma_f32 v[140:141], v[138:139], v[138:139], v[140:141]
    v_add_f32 v140, v140, v141
    s_nop 1
    v_add_f32_dpp v140, v140, v140 row_ror:8 row_mask:0xf bank_mask:0xf
    s_nop 1
    v_add_f32_dpp v140, v140, v140 row_ror:4 row_mask:0xf bank_mask:0xf
    s_nop 1
    v_add_f32_dpp v140, v140, v140 row_ror:2 row_mask:0xf bank_mask:0xf
    s_nop 1
    v_add_f32_dpp v140, v140, v140 row_ror:1 row_mask:0xf bank_mask:0xf
    v_mov_b32 v141, v140
    s_nop 1
    v_permlane16_swap_b32 v140, v141
    v_add_f32_e64 v140, v140, v141
    s_add_u32 m0, s73, 29696
    v_mul_f32 v140, 0x3acccccd, v140
    buffer_load_dwordx4 v6, s[48:51], s72 offen lds
    v_cvt_pk_bf16_f32 v140, v140, v140
    v_lshlrev_b32_e64 v140, 16, v140
    v_add_f32 v140, 0x3727c5ac, v140
    v_cvt_pk_bf16_f32 v140, v140, v140
    v_lshlrev_b32 v140, 16, v140
    v_sqrt_f32_e64 v140, v140
    s_nop 0
    v_cvt_pk_bf16_f32 v140, v140, v140
    v_lshlrev_b32 v140, 16, v140
    v_rcp_f32_e64 v45, v140
    s_nop 0
    buffer_store_dwordx2 v[44:45], v30, s[52:55], 0 offen sc1
    s_waitcnt vmcnt(11) lgkmcnt(0)
    s_barrier
    v_mfma_f32_16x16x32_bf16 v[156:159], a[232:235], a[248:251], 0
    ds_read_b128 a[136:139], v11 offset:10240
    v_mfma_f32_16x16x32_bf16 v[156:159], a[244:247], a[248:251], v[156:159]
    s_add_u32 s68, s68, 1
    s_cmp_ge_u32 s68, 10
    s_cselect_b32 s68, 0, s68
    v_mfma_f32_16x16x32_bf16 v[152:155], a[240:243], a[248:251], 0
    ds_read_b128 a[148:151], v12 offset:10240
    v_mfma_f32_16x16x32_bf16 v[152:155], a[228:231], a[248:251], v[152:155]
    ds_read_b128 a[140:143], v11 offset:12288
    v_mfma_f32_16x16x32_bf16 v[148:151], a[224:227], a[248:251], 0
    s_lshl_b32 s69, s68, 7
    ds_read_b128 a[152:155], v12 offset:12288
    v_mfma_f32_16x16x32_bf16 v[148:151], a[236:239], a[248:251], v[148:151]
    v_mfma_f32_16x16x32_bf16 v[208:211], a[236:239], a[196:199], 0
    ds_read_b128 a[144:147], v11 offset:14336
    v_mfma_f32_16x16x32_bf16 v[208:211], a[224:227], a[192:195], v[208:211]
    s_add_u32 s71, s69, 10240
    v_mfma_f32_16x16x32_bf16 v[212:215], a[228:231], a[192:195], 0
    ds_read_b128 a[156:159], v12 offset:14336
    v_mfma_f32_16x16x32_bf16 v[212:215], a[240:243], a[196:199], v[212:215]
    ds_read_b128 a[160:163], v7 offset:10240
    v_mfma_f32_16x16x32_bf16 v[216:219], a[244:247], a[196:199], 0
    v_mfma_f32_16x16x32_bf16 v[216:219], a[232:235], a[192:195], v[216:219]
    s_add_u32 s72, s69, 20480
    ds_read_b128 a[164:167], v9 offset:10240
    v_mfma_f32_16x16x32_bf16 v[228:231], a[232:235], a[200:203], 0
    ds_read_b128 a[168:171], v7 offset:12288
    v_mfma_f32_16x16x32_bf16 v[228:231], a[244:247], a[204:207], v[228:231]
    s_add_u32 m0, s73, 0
    v_mfma_f32_16x16x32_bf16 v[224:227], a[240:243], a[204:207], 0
    buffer_load_dwordx4 v3, s[40:43], s69 offen offset:0 lds
    v_mfma_f32_16x16x32_bf16 v[224:227], a[228:231], a[200:203], v[224:227]
    ds_read_b128 a[172:175], v9 offset:12288
    v_mfma_f32_16x16x32_bf16 v[220:223], a[224:227], a[200:203], 0
    ds_read_b128 a[176:179], v7 offset:51200
    s_add_u32 m0, s73, 1024
    v_mfma_f32_16x16x32_bf16 v[220:223], a[236:239], a[204:207], v[220:223]
    buffer_load_dwordx4 v4, s[40:43], s69 offen offset:0 lds
    v_mfma_f32_16x16x32_bf16 v[232:235], a[236:239], a[212:215], 0
    ds_read_b128 a[180:183], v9 offset:51200
    v_mfma_f32_16x16x32_bf16 v[232:235], a[224:227], a[208:211], v[232:235]
    ds_read_b128 a[184:187], v7 offset:53248
    s_add_u32 m0, s73, 768
    v_mfma_f32_16x16x32_bf16 v[236:239], a[228:231], a[208:211], 0
    buffer_load_dwordx4 v3, s[40:43], s69 offen offset:1280 lds
    v_mfma_f32_16x16x32_bf16 v[236:239], a[240:243], a[212:215], v[236:239]
    ds_read_b128 a[188:191], v9 offset:53248
    v_mfma_f32_16x16x32_bf16 v[240:243], a[244:247], a[212:215], 0
    s_add_u32 m0, s73, 1792
    v_mfma_f32_16x16x32_bf16 v[240:243], a[232:235], a[208:211], v[240:243]
    buffer_load_dwordx4 v4, s[40:43], s69 offen offset:1280 lds
    v_mfma_f32_16x16x32_bf16 v[252:255], a[232:235], a[216:219], 0
    v_mfma_f32_16x16x32_bf16 v[252:255], a[244:247], a[220:223], v[252:255]
    s_add_u32 m0, s73, 4096
    v_mfma_f32_16x16x32_bf16 v[248:251], a[240:243], a[220:223], 0
    buffer_load_dwordx4 v5, s[44:47], s69 offen lds
    v_mfma_f32_16x16x32_bf16 v[248:251], a[228:231], a[216:219], v[248:251]
    v_mfma_f32_16x16x32_bf16 v[244:247], a[224:227], a[216:219], 0
    v_mfma_f32_16x16x32_bf16 v[244:247], a[236:239], a[220:223], v[244:247]
    s_waitcnt lgkmcnt(0)
    v_mfma_f32_16x16x32_bf16 v[160:163], a[136:139], a[160:163], v[160:163]
    ds_read_b128 a[192:195], v8 offset:10240
    s_add_u32 m0, s73, 5120
    v_mfma_f32_16x16x32_bf16 v[160:163], a[148:151], a[164:167], v[160:163]
    buffer_load_dwordx4 v6, s[48:51], s69 offen lds
    v_mfma_f32_16x16x32_bf16 v[164:167], a[152:155], a[164:167], v[164:167]
    ds_read_b128 a[196:199], v10 offset:10240
    v_mfma_f32_16x16x32_bf16 v[164:167], a[140:143], a[160:163], v[164:167]
    ds_read_b128 a[200:203], v8 offset:12288
    v_mfma_f32_16x16x32_bf16 v[168:171], a[144:147], a[160:163], v[168:171]
    s_add_u32 m0, s73, 6144
    v_mfma_f32_16x16x32_bf16 v[168:171], a[156:159], a[164:167], v[168:171]
    buffer_load_dwordx4 v5, s[44:47], s71 offen lds
    v_mfma_f32_16x16x32_bf16 v[180:183], a[156:159], a[172:175], v[180:183]
    ds_read_b128 a[204:207], v10 offset:12288
    v_mfma_f32_16x16x32_bf16 v[180:183], a[144:147], a[168:171], v[180:183]
    ds_read_b128 a[208:211], v8 offset:51200
    v_mfma_f32_16x16x32_bf16 v[176:179], a[140:143], a[168:171], v[176:179]
    v_mfma_f32_16x16x32_bf16 v[176:179], a[152:155], a[172:175], v[176:179]
    ds_read_b128 a[212:215], v10 offset:51200
    s_add_u32 m0, s73, 7168
    v_mfma_f32_16x16x32_bf16 v[172:175], a[148:151], a[172:175], v[172:175]
    buffer_load_dwordx4 v6, s[48:51], s71 offen lds
    v_mfma_f32_16x16x32_bf16 v[172:175], a[136:139], a[168:171], v[172:175]
    ds_read_b128 a[216:219], v8 offset:53248
    v_mfma_f32_16x16x32_bf16 v[184:187], a[136:139], a[176:179], v[184:187]
    ds_read_b128 a[220:223], v10 offset:53248
    v_mfma_f32_16x16x32_bf16 v[184:187], a[148:151], a[180:183], v[184:187]
    s_add_u32 m0, s73, 8192
    v_mfma_f32_16x16x32_bf16 v[188:191], a[152:155], a[180:183], v[188:191]
    buffer_load_dwordx4 v5, s[44:47], s72 offen lds
    v_mfma_f32_16x16x32_bf16 v[188:191], a[140:143], a[176:179], v[188:191]
    v_mfma_f32_16x16x32_bf16 v[192:195], a[144:147], a[176:179], v[192:195]
    v_mfma_f32_16x16x32_bf16 v[192:195], a[156:159], a[180:183], v[192:195]
    v_mfma_f32_16x16x32_bf16 v[204:207], a[156:159], a[188:191], v[204:207]
    s_add_u32 m0, s73, 9216
    v_mfma_f32_16x16x32_bf16 v[204:207], a[144:147], a[184:187], v[204:207]
    buffer_load_dwordx4 v6, s[48:51], s72 offen lds
    v_mfma_f32_16x16x32_bf16 v[200:203], a[140:143], a[184:187], v[200:203]
    v_mfma_f32_16x16x32_bf16 v[200:203], a[152:155], a[188:191], v[200:203]
    v_mfma_f32_16x16x32_bf16 v[196:199], a[148:151], a[188:191], v[196:199]
    v_mfma_f32_16x16x32_bf16 v[196:199], a[136:139], a[184:187], v[196:199]
    s_waitcnt vmcnt(11) lgkmcnt(0)
    s_barrier
    v_mfma_f32_16x16x32_bf16 v[156:159], a[144:147], a[248:251], v[156:159]
    ds_read_b128 a[224:227], v11 offset:20480
    v_mfma_f32_16x16x32_bf16 v[156:159], a[156:159], a[248:251], v[156:159]
    s_add_u32 s68, s68, 1
    s_cmp_ge_u32 s68, 10
    s_cselect_b32 s68, 0, s68
    v_mfma_f32_16x16x32_bf16 v[152:155], a[152:155], a[248:251], v[152:155]
    ds_read_b128 a[236:239], v12 offset:20480
    v_mfma_f32_16x16x32_bf16 v[152:155], a[140:143], a[248:251], v[152:155]
    ds_read_b128 a[228:231], v11 offset:22528
    v_mfma_f32_16x16x32_bf16 v[148:151], a[136:139], a[248:251], v[148:151]
    s_lshl_b32 s69, s68, 7
    ds_read_b128 a[240:243], v12 offset:22528
    v_mfma_f32_16x16x32_bf16 v[148:151], a[148:151], a[248:251], v[148:151]
    v_mfma_f32_16x16x32_bf16 v[208:211], a[148:151], a[196:199], v[208:211]
    ds_read_b128 a[232:235], v11 offset:24576
    v_mfma_f32_16x16x32_bf16 v[208:211], a[136:139], a[192:195], v[208:211]
    s_add_u32 s71, s69, 10240
    v_mfma_f32_16x16x32_bf16 v[212:215], a[140:143], a[192:195], v[212:215]
    ds_read_b128 a[244:247], v12 offset:24576
    v_mfma_f32_16x16x32_bf16 v[212:215], a[152:155], a[196:199], v[212:215]
    ds_read_b128 a[160:163], v7 offset:20480
    v_mfma_f32_16x16x32_bf16 v[216:219], a[156:159], a[196:199], v[216:219]
    v_mfma_f32_16x16x32_bf16 v[216:219], a[144:147], a[192:195], v[216:219]
    s_add_u32 s72, s69, 20480
    ds_read_b128 a[164:167], v9 offset:20480
    v_mfma_f32_16x16x32_bf16 v[228:231], a[144:147], a[200:203], v[228:231]
    ds_read_b128 a[168:171], v7 offset:22528
    v_mfma_f32_16x16x32_bf16 v[228:231], a[156:159], a[204:207], v[228:231]
    s_add_u32 m0, s73, 10240
    v_mfma_f32_16x16x32_bf16 v[224:227], a[152:155], a[204:207], v[224:227]
    buffer_load_dwordx4 v3, s[40:43], s69 offen offset:0 lds
    v_mfma_f32_16x16x32_bf16 v[224:227], a[140:143], a[200:203], v[224:227]
    ds_read_b128 a[172:175], v9 offset:22528
    v_mfma_f32_16x16x32_bf16 v[220:223], a[136:139], a[200:203], v[220:223]
    ds_read_b128 a[176:179], v7 offset:61440
    s_add_u32 m0, s73, 11264
    v_mfma_f32_16x16x32_bf16 v[220:223], a[148:151], a[204:207], v[220:223]
    buffer_load_dwordx4 v4, s[40:43], s69 offen offset:0 lds
    v_mfma_f32_16x16x32_bf16 v[232:235], a[148:151], a[212:215], v[232:235]
    ds_read_b128 a[180:183], v9 offset:61440
    v_mfma_f32_16x16x32_bf16 v[232:235], a[136:139], a[208:211], v[232:235]
    ds_read_b128 a[184:187], v7 offset:63488
    s_add_u32 m0, s73, 11008
    v_mfma_f32_16x16x32_bf16 v[236:239], a[140:143], a[208:211], v[236:239]
    buffer_load_dwordx4 v3, s[40:43], s69 offen offset:1280 lds
    v_mfma_f32_16x16x32_bf16 v[236:239], a[152:155], a[212:215], v[236:239]
    ds_read_b128 a[188:191], v9 offset:63488
    v_mfma_f32_16x16x32_bf16 v[240:243], a[156:159], a[212:215], v[240:243]
    s_add_u32 m0, s73, 12032
    v_mfma_f32_16x16x32_bf16 v[240:243], a[144:147], a[208:211], v[240:243]
    buffer_load_dwordx4 v4, s[40:43], s69 offen offset:1280 lds
    v_mfma_f32_16x16x32_bf16 v[252:255], a[144:147], a[216:219], v[252:255]
    v_mfma_f32_16x16x32_bf16 v[252:255], a[156:159], a[220:223], v[252:255]
    s_add_u32 m0, s73, 14336
    v_mfma_f32_16x16x32_bf16 v[248:251], a[152:155], a[220:223], v[248:251]
    buffer_load_dwordx4 v5, s[44:47], s69 offen lds
    v_mfma_f32_16x16x32_bf16 v[248:251], a[140:143], a[216:219], v[248:251]
    v_mfma_f32_16x16x32_bf16 v[244:247], a[136:139], a[216:219], v[244:247]
    v_mfma_f32_16x16x32_bf16 v[244:247], a[148:151], a[220:223], v[244:247]
    s_waitcnt lgkmcnt(0)
    v_mfma_f32_16x16x32_bf16 v[160:163], a[224:227], a[160:163], v[160:163]
    ds_read_b128 a[192:195], v8 offset:20480
    s_add_u32 m0, s73, 15360
    v_mfma_f32_16x16x32_bf16 v[160:163], a[236:239], a[164:167], v[160:163]
    buffer_load_dwordx4 v6, s[48:51], s69 offen lds
    v_mfma_f32_16x16x32_bf16 v[164:167], a[240:243], a[164:167], v[164:167]
    ds_read_b128 a[196:199], v10 offset:20480
    v_mfma_f32_16x16x32_bf16 v[164:167], a[228:231], a[160:163], v[164:167]
    ds_read_b128 a[200:203], v8 offset:22528
    v_mfma_f32_16x16x32_bf16 v[168:171], a[232:235], a[160:163], v[168:171]
    s_add_u32 m0, s73, 16384
    v_mfma_f32_16x16x32_bf16 v[168:171], a[244:247], a[164:167], v[168:171]
    buffer_load_dwordx4 v5, s[44:47], s71 offen lds
    v_mfma_f32_16x16x32_bf16 v[180:183], a[244:247], a[172:175], v[180:183]
    ds_read_b128 a[204:207], v10 offset:22528
    v_mfma_f32_16x16x32_bf16 v[180:183], a[232:235], a[168:171], v[180:183]
    ds_read_b128 a[208:211], v8 offset:61440
    v_mfma_f32_16x16x32_bf16 v[176:179], a[228:231], a[168:171], v[176:179]
    v_mfma_f32_16x16x32_bf16 v[176:179], a[240:243], a[172:175], v[176:179]
    ds_read_b128 a[212:215], v10 offset:61440
    s_add_u32 m0, s73, 17408
    v_mfma_f32_16x16x32_bf16 v[172:175], a[236:239], a[172:175], v[172:175]
    buffer_load_dwordx4 v6, s[48:51], s71 offen lds
    v_mfma_f32_16x16x32_bf16 v[172:175], a[224:227], a[168:171], v[172:175]
    ds_read_b128 a[216:219], v8 offset:63488
    v_mfma_f32_16x16x32_bf16 v[184:187], a[224:227], a[176:179], v[184:187]
    ds_read_b128 a[220:223], v10 offset:63488
    v_mfma_f32_16x16x32_bf16 v[184:187], a[236:239], a[180:183], v[184:187]
    s_add_u32 m0, s73, 18432
    v_mfma_f32_16x16x32_bf16 v[188:191], a[240:243], a[180:183], v[188:191]
    buffer_load_dwordx4 v5, s[44:47], s72 offen lds
    v_mfma_f32_16x16x32_bf16 v[188:191], a[228:231], a[176:179], v[188:191]
    v_mfma_f32_16x16x32_bf16 v[192:195], a[232:235], a[176:179], v[192:195]
    v_mfma_f32_16x16x32_bf16 v[192:195], a[244:247], a[180:183], v[192:195]
    v_mfma_f32_16x16x32_bf16 v[204:207], a[244:247], a[188:191], v[204:207]
    s_add_u32 m0, s73, 19456
    v_mfma_f32_16x16x32_bf16 v[204:207], a[232:235], a[184:187], v[204:207]
    buffer_load_dwordx4 v6, s[48:51], s72 offen lds
    v_mfma_f32_16x16x32_bf16 v[200:203], a[228:231], a[184:187], v[200:203]
    v_mfma_f32_16x16x32_bf16 v[200:203], a[240:243], a[188:191], v[200:203]
    v_mfma_f32_16x16x32_bf16 v[196:199], a[236:239], a[188:191], v[196:199]
    v_mfma_f32_16x16x32_bf16 v[196:199], a[224:227], a[184:187], v[196:199]
    s_waitcnt vmcnt(10) lgkmcnt(0)
    s_barrier
    v_mfma_f32_16x16x32_bf16 v[156:159], a[232:235], a[248:251], v[156:159]
    ds_read_b128 a[136:139], v11 offset:0
    v_mfma_f32_16x16x32_bf16 v[156:159], a[244:247], a[248:251], v[156:159]
    s_add_u32 s68, s68, 1
    s_cmp_ge_u32 s68, 10
    s_cselect_b32 s68, 0, s68
    v_mfma_f32_16x16x32_bf16 v[152:155], a[240:243], a[248:251], v[152:155]
    ds_read_b128 a[148:151], v12 offset:0
    v_mfma_f32_16x16x32_bf16 v[152:155], a[228:231], a[248:251], v[152:155]
    ds_read_b128 a[140:143], v11 offset:2048
    v_mfma_f32_16x16x32_bf16 v[148:151], a[224:227], a[248:251], v[148:151]
    s_lshl_b32 s69, s68, 7
    ds_read_b128 a[152:155], v12 offset:2048
    v_mfma_f32_16x16x32_bf16 v[148:151], a[236:239], a[248:251], v[148:151]
    v_mfma_f32_16x16x32_bf16 v[208:211], a[236:239], a[196:199], v[208:211]
    ds_read_b128 a[144:147], v11 offset:4096
    v_mfma_f32_16x16x32_bf16 v[208:211], a[224:227], a[192:195], v[208:211]
    s_add_u32 s71, s69, 10240
    v_mfma_f32_16x16x32_bf16 v[212:215], a[228:231], a[192:195], v[212:215]
    ds_read_b128 a[156:159], v12 offset:4096
    v_mfma_f32_16x16x32_bf16 v[212:215], a[240:243], a[196:199], v[212:215]
    ds_read_b128 a[160:163], v7 offset:0
    v_mfma_f32_16x16x32_bf16 v[216:219], a[244:247], a[196:199], v[216:219]
    v_mfma_f32_16x16x32_bf16 v[216:219], a[232:235], a[192:195], v[216:219]
    s_add_u32 s72, s69, 20480
    ds_read_b128 a[164:167], v9 offset:0
    v_mfma_f32_16x16x32_bf16 v[228:231], a[232:235], a[200:203], v[228:231]
    ds_read_b128 a[168:171], v7 offset:2048
    v_mfma_f32_16x16x32_bf16 v[228:231], a[244:247], a[204:207], v[228:231]
    s_add_u32 m0, s73, 20480
    v_mfma_f32_16x16x32_bf16 v[224:227], a[240:243], a[204:207], v[224:227]
    buffer_load_dwordx4 v3, s[40:43], s69 offen offset:0 lds
    v_mfma_f32_16x16x32_bf16 v[224:227], a[228:231], a[200:203], v[224:227]
    ds_read_b128 a[172:175], v9 offset:2048
    v_mfma_f32_16x16x32_bf16 v[220:223], a[224:227], a[200:203], v[220:223]
    ds_read_b128 a[176:179], v7 offset:40960
    s_add_u32 m0, s73, 21504
    v_mfma_f32_16x16x32_bf16 v[220:223], a[236:239], a[204:207], v[220:223]
    buffer_load_dwordx4 v4, s[40:43], s69 offen offset:0 lds
    v_mfma_f32_16x16x32_bf16 v[232:235], a[236:239], a[212:215], v[232:235]
    ds_read_b128 a[180:183], v9 offset:40960
    v_mfma_f32_16x16x32_bf16 v[232:235], a[224:227], a[208:211], v[232:235]
    ds_read_b128 a[184:187], v7 offset:43008
    s_add_u32 m0, s73, 21248
    v_mfma_f32_16x16x32_bf16 v[236:239], a[228:231], a[208:211], v[236:239]
    buffer_load_dwordx4 v3, s[40:43], s69 offen offset:1280 lds
    v_mfma_f32_16x16x32_bf16 v[236:239], a[240:243], a[212:215], v[236:239]
    ds_read_b128 a[188:191], v9 offset:43008
    v_mfma_f32_16x16x32_bf16 v[240:243], a[244:247], a[212:215], v[240:243]
    s_add_u32 m0, s73, 22272
    v_mfma_f32_16x16x32_bf16 v[240:243], a[232:235], a[208:211], v[240:243]
    buffer_load_dwordx4 v4, s[40:43], s69 offen offset:1280 lds
    v_mfma_f32_16x16x32_bf16 v[252:255], a[232:235], a[216:219], v[252:255]
    v_mfma_f32_16x16x32_bf16 v[252:255], a[244:247], a[220:223], v[252:255]
    s_add_u32 m0, s73, 24576
    v_mfma_f32_16x16x32_bf16 v[248:251], a[240:243], a[220:223], v[248:251]
    buffer_load_dwordx4 v5, s[44:47], s69 offen lds
    v_mfma_f32_16x16x32_bf16 v[248:251], a[228:231], a[216:219], v[248:251]
    v_mfma_f32_16x16x32_bf16 v[244:247], a[224:227], a[216:219], v[244:247]
    v_mfma_f32_16x16x32_bf16 v[244:247], a[236:239], a[220:223], v[244:247]
    s_waitcnt lgkmcnt(0)
    v_mfma_f32_16x16x32_bf16 v[160:163], a[136:139], a[160:163], v[160:163]
    ds_read_b128 a[192:195], v8 offset:0
    s_add_u32 m0, s73, 25600
    v_mfma_f32_16x16x32_bf16 v[160:163], a[148:151], a[164:167], v[160:163]
    buffer_load_dwordx4 v6, s[48:51], s69 offen lds
    v_mfma_f32_16x16x32_bf16 v[164:167], a[152:155], a[164:167], v[164:167]
    ds_read_b128 a[196:199], v10 offset:0
    v_mfma_f32_16x16x32_bf16 v[164:167], a[140:143], a[160:163], v[164:167]
    ds_read_b128 a[200:203], v8 offset:2048
    v_mfma_f32_16x16x32_bf16 v[168:171], a[144:147], a[160:163], v[168:171]
    s_add_u32 m0, s73, 26624
    v_mfma_f32_16x16x32_bf16 v[168:171], a[156:159], a[164:167], v[168:171]
    buffer_load_dwordx4 v5, s[44:47], s71 offen lds
    v_mfma_f32_16x16x32_bf16 v[180:183], a[156:159], a[172:175], v[180:183]
    ds_read_b128 a[204:207], v10 offset:2048
    v_mfma_f32_16x16x32_bf16 v[180:183], a[144:147], a[168:171], v[180:183]
    ds_read_b128 a[208:211], v8 offset:40960
    v_mfma_f32_16x16x32_bf16 v[176:179], a[140:143], a[168:171], v[176:179]
    v_mfma_f32_16x16x32_bf16 v[176:179], a[152:155], a[172:175], v[176:179]
    ds_read_b128 a[212:215], v10 offset:40960
    s_add_u32 m0, s73, 27648
    v_mfma_f32_16x16x32_bf16 v[172:175], a[148:151], a[172:175], v[172:175]
    buffer_load_dwordx4 v6, s[48:51], s71 offen lds
    v_mfma_f32_16x16x32_bf16 v[172:175], a[136:139], a[168:171], v[172:175]
    ds_read_b128 a[216:219], v8 offset:43008
    v_mfma_f32_16x16x32_bf16 v[184:187], a[136:139], a[176:179], v[184:187]
    ds_read_b128 a[220:223], v10 offset:43008
    v_mfma_f32_16x16x32_bf16 v[184:187], a[148:151], a[180:183], v[184:187]
    s_add_u32 m0, s73, 28672
    v_mfma_f32_16x16x32_bf16 v[188:191], a[152:155], a[180:183], v[188:191]
    buffer_load_dwordx4 v5, s[44:47], s72 offen lds
    v_mfma_f32_16x16x32_bf16 v[188:191], a[140:143], a[176:179], v[188:191]
    v_mfma_f32_16x16x32_bf16 v[192:195], a[144:147], a[176:179], v[192:195]
    v_mfma_f32_16x16x32_bf16 v[192:195], a[156:159], a[180:183], v[192:195]
    v_mfma_f32_16x16x32_bf16 v[204:207], a[156:159], a[188:191], v[204:207]
    s_add_u32 m0, s73, 29696
    v_mfma_f32_16x16x32_bf16 v[204:207], a[144:147], a[184:187], v[204:207]
    buffer_load_dwordx4 v6, s[48:51], s72 offen lds
    v_mfma_f32_16x16x32_bf16 v[200:203], a[140:143], a[184:187], v[200:203]
    v_mfma_f32_16x16x32_bf16 v[200:203], a[152:155], a[188:191], v[200:203]
    v_mfma_f32_16x16x32_bf16 v[196:199], a[148:151], a[188:191], v[196:199]
    v_mfma_f32_16x16x32_bf16 v[196:199], a[136:139], a[184:187], v[196:199]
    s_waitcnt vmcnt(10) lgkmcnt(0)
    s_barrier
    v_mfma_f32_16x16x32_bf16 v[156:159], a[144:147], a[248:251], v[156:159]
    ds_read_b128 a[224:227], v11 offset:10240
    s_cmp_lg_u32 s64, 0
    s_cbranch_scc1 L_arrS
    s_lshl4_add_u32 s3, s65, s66
    s_lshl_b32 s3, s3, 7
    s_add_u32 s3, s3, 18415616
    s_mov_b64 exec, 0xff
    buffer_store_dwordx4 a[252:255], v21, s[52:55], s3 offen sc1
    s_mov_b64 exec, -1
L_arrS:
    v_mfma_f32_16x16x32_bf16 v[156:159], a[156:159], a[248:251], v[156:159]
    s_add_u32 s68, s68, 1
    s_cmp_ge_u32 s68, 10
    s_cselect_b32 s68, 0, s68
    v_mfma_f32_16x16x32_bf16 v[152:155], a[152:155], a[248:251], v[152:155]
    ds_read_b128 a[236:239], v12 offset:10240
    v_mfma_f32_16x16x32_bf16 v[152:155], a[140:143], a[248:251], v[152:155]
    ds_read_b128 a[228:231], v11 offset:12288
    v_mfma_f32_16x16x32_bf16 v[148:151], a[136:139], a[248:251], v[148:151]
    s_lshl_b32 s69, s68, 7
    ds_read_b128 a[240:243], v12 offset:12288
    v_mfma_f32_16x16x32_bf16 v[148:151], a[148:151], a[248:251], v[148:151]
    v_mfma_f32_16x16x32_bf16 v[208:211], a[148:151], a[196:199], v[208:211]
    ds_read_b128 a[232:235], v11 offset:14336
    v_mfma_f32_16x16x32_bf16 v[208:211], a[136:139], a[192:195], v[208:211]
    s_add_u32 s71, s69, 10240
    v_mfma_f32_16x16x32_bf16 v[212:215], a[140:143], a[192:195], v[212:215]
    ds_read_b128 a[244:247], v12 offset:14336
    v_mfma_f32_16x16x32_bf16 v[212:215], a[152:155], a[196:199], v[212:215]
    ds_read_b128 a[160:163], v7 offset:10240
    v_mfma_f32_16x16x32_bf16 v[216:219], a[156:159], a[196:199], v[216:219]
    v_mfma_f32_16x16x32_bf16 v[216:219], a[144:147], a[192:195], v[216:219]
    s_add_u32 s72, s69, 20480
    ds_read_b128 a[164:167], v9 offset:10240
    v_mfma_f32_16x16x32_bf16 v[228:231], a[144:147], a[200:203], v[228:231]
    ds_read_b128 a[168:171], v7 offset:12288
    v_mfma_f32_16x16x32_bf16 v[228:231], a[156:159], a[204:207], v[228:231]
    s_add_u32 m0, s73, 0
    v_mfma_f32_16x16x32_bf16 v[224:227], a[152:155], a[204:207], v[224:227]
    buffer_load_dwordx4 v3, s[40:43], s69 offen offset:0 lds
    v_mfma_f32_16x16x32_bf16 v[224:227], a[140:143], a[200:203], v[224:227]
    ds_read_b128 a[172:175], v9 offset:12288
    v_mfma_f32_16x16x32_bf16 v[220:223], a[136:139], a[200:203], v[220:223]
    ds_read_b128 a[176:179], v7 offset:51200
    s_add_u32 m0, s73, 1024
    v_mfma_f32_16x16x32_bf16 v[220:223], a[148:151], a[204:207], v[220:223]
    buffer_load_dwordx4 v4, s[40:43], s69 offen offset:0 lds
    v_mfma_f32_16x16x32_bf16 v[232:235], a[148:151], a[212:215], v[232:235]
    ds_read_b128 a[180:183], v9 offset:51200
    v_mfma_f32_16x16x32_bf16 v[232:235], a[136:139], a[208:211], v[232:235]
    ds_read_b128 a[184:187], v7 offset:53248
    s_add_u32 m0, s73, 768
    v_mfma_f32_16x16x32_bf16 v[236:239], a[140:143], a[208:211], v[236:239]
    buffer_load_dwordx4 v3, s[40:43], s69 offen offset:1280 lds
    v_mfma_f32_16x16x32_bf16 v[236:239], a[152:155], a[212:215], v[236:239]
    ds_read_b128 a[188:191], v9 offset:53248
    v_mfma_f32_16x16x32_bf16 v[240:243], a[156:159], a[212:215], v[240:243]
    s_add_u32 m0, s73, 1792
    v_mfma_f32_16x16x32_bf16 v[240:243], a[144:147], a[208:211], v[240:243]
    buffer_load_dwordx4 v4, s[40:43], s69 offen offset:1280 lds
    v_mfma_f32_16x16x32_bf16 v[252:255], a[144:147], a[216:219], v[252:255]
    v_mfma_f32_16x16x32_bf16 v[252:255], a[156:159], a[220:223], v[252:255]
    s_add_u32 m0, s73, 4096
    v_mfma_f32_16x16x32_bf16 v[248:251], a[152:155], a[220:223], v[248:251]
    buffer_load_dwordx4 v5, s[44:47], s69 offen lds
    v_mfma_f32_16x16x32_bf16 v[248:251], a[140:143], a[216:219], v[248:251]
    v_mfma_f32_16x16x32_bf16 v[244:247], a[136:139], a[216:219], v[244:247]
    v_mfma_f32_16x16x32_bf16 v[244:247], a[148:151], a[220:223], v[244:247]
    s_waitcnt lgkmcnt(0)
    v_mfma_f32_16x16x32_bf16 v[160:163], a[224:227], a[160:163], v[160:163]
    ds_read_b128 a[192:195], v8 offset:10240
    s_add_u32 m0, s73, 5120
    v_mfma_f32_16x16x32_bf16 v[160:163], a[236:239], a[164:167], v[160:163]
    buffer_load_dwordx4 v6, s[48:51], s69 offen lds
    v_mfma_f32_16x16x32_bf16 v[164:167], a[240:243], a[164:167], v[164:167]
    ds_read_b128 a[196:199], v10 offset:10240
    v_mfma_f32_16x16x32_bf16 v[164:167], a[228:231], a[160:163], v[164:167]
    ds_read_b128 a[200:203], v8 offset:12288
    v_mfma_f32_16x16x32_bf16 v[168:171], a[232:235], a[160:163], v[168:171]
    s_add_u32 m0, s73, 6144
    v_mfma_f32_16x16x32_bf16 v[168:171], a[244:247], a[164:167], v[168:171]
    buffer_load_dwordx4 v5, s[44:47], s71 offen lds
    v_mfma_f32_16x16x32_bf16 v[180:183], a[244:247], a[172:175], v[180:183]
    ds_read_b128 a[204:207], v10 offset:12288
    v_mfma_f32_16x16x32_bf16 v[180:183], a[232:235], a[168:171], v[180:183]
    ds_read_b128 a[208:211], v8 offset:51200
    v_mfma_f32_16x16x32_bf16 v[176:179], a[228:231], a[168:171], v[176:179]
    v_mfma_f32_16x16x32_bf16 v[176:179], a[240:243], a[172:175], v[176:179]
    ds_read_b128 a[212:215], v10 offset:51200
    s_add_u32 m0, s73, 7168
    v_mfma_f32_16x16x32_bf16 v[172:175], a[236:239], a[172:175], v[172:175]
    buffer_load_dwordx4 v6, s[48:51], s71 offen lds
    v_mfma_f32_16x16x32_bf16 v[172:175], a[224:227], a[168:171], v[172:175]
    ds_read_b128 a[216:219], v8 offset:53248
    v_mfma_f32_16x16x32_bf16 v[184:187], a[224:227], a[176:179], v[184:187]
    ds_read_b128 a[220:223], v10 offset:53248
    v_mfma_f32_16x16x32_bf16 v[184:187], a[236:239], a[180:183], v[184:187]
    s_add_u32 m0, s73, 8192
    v_mfma_f32_16x16x32_bf16 v[188:191], a[240:243], a[180:183], v[188:191]
    buffer_load_dwordx4 v5, s[44:47], s72 offen lds
    v_mfma_f32_16x16x32_bf16 v[188:191], a[228:231], a[176:179], v[188:191]
    v_mfma_f32_16x16x32_bf16 v[192:195], a[232:235], a[176:179], v[192:195]
    v_mfma_f32_16x16x32_bf16 v[192:195], a[244:247], a[180:183], v[192:195]
    v_mfma_f32_16x16x32_bf16 v[204:207], a[244:247], a[188:191], v[204:207]
    s_add_u32 m0, s73, 9216
    v_mfma_f32_16x16x32_bf16 v[204:207], a[232:235], a[184:187], v[204:207]
    buffer_load_dwordx4 v6, s[48:51], s72 offen lds
    v_mfma_f32_16x16x32_bf16 v[200:203], a[228:231], a[184:187], v[200:203]
    v_mfma_f32_16x16x32_bf16 v[200:203], a[240:243], a[188:191], v[200:203]
    v_mfma_f32_16x16x32_bf16 v[196:199], a[236:239], a[188:191], v[196:199]
    v_mfma_f32_16x16x32_bf16 v[196:199], a[224:227], a[184:187], v[196:199]
    s_waitcnt vmcnt(10) lgkmcnt(0)
    s_barrier
    v_mfma_f32_16x16x32_bf16 v[156:159], a[232:235], a[248:251], v[156:159]
    ds_read_b128 a[136:139], v11 offset:20480
    v_mfma_f32_16x16x32_bf16 v[156:159], a[244:247], a[248:251], v[156:159]
    s_add_u32 s68, s68, 1
    s_cmp_ge_u32 s68, 10
    s_cselect_b32 s68, 0, s68
    v_mfma_f32_16x16x32_bf16 v[152:155], a[240:243], a[248:251], v[152:155]
    ds_read_b128 a[148:151], v12 offset:20480
    v_mfma_f32_16x16x32_bf16 v[152:155], a[228:231], a[248:251], v[152:155]
    ds_read_b128 a[140:143], v11 offset:22528
    v_mfma_f32_16x16x32_bf16 v[148:151], a[224:227], a[248:251], v[148:151]
    s_lshl_b32 s69, s68, 7
    ds_read_b128 a[152:155], v12 offset:22528
    v_mfma_f32_16x16x32_bf16 v[148:151], a[236:239], a[248:251], v[148:151]
    v_mfma_f32_16x16x32_bf16 v[208:211], a[236:239], a[196:199], v[208:211]
    ds_read_b128 a[144:147], v11 offset:24576
    v_mfma_f32_16x16x32_bf16 v[208:211], a[224:227], a[192:195], v[208:211]
    s_add_u32 s71, s69, 10240
    v_mfma_f32_16x16x32_bf16 v[212:215], a[228:231], a[192:195], v[212:215]
    ds_read_b128 a[156:159], v12 offset:24576
    v_mfma_f32_16x16x32_bf16 v[212:215], a[240:243], a[196:199], v[212:215]
    ds_read_b128 a[160:163], v7 offset:20480
    v_mfma_f32_16x16x32_bf16 v[216:219], a[244:247], a[196:199], v[216:219]
    v_mfma_f32_16x16x32_bf16 v[216:219], a[232:235], a[192:195], v[216:219]
    s_add_u32 s72, s69, 20480
    ds_read_b128 a[164:167], v9 offset:20480
    v_mfma_f32_16x16x32_bf16 v[228:231], a[232:235], a[200:203], v[228:231]
    ds_read_b128 a[168:171], v7 offset:22528
    v_mfma_f32_16x16x32_bf16 v[228:231], a[244:247], a[204:207], v[228:231]
    s_add_u32 m0, s73, 10240
    v_mfma_f32_16x16x32_bf16 v[224:227], a[240:243], a[204:207], v[224:227]
    buffer_load_dwordx4 v3, s[40:43], s69 offen offset:0 lds
    v_mfma_f32_16x16x32_bf16 v[224:227], a[228:231], a[200:203], v[224:227]
    ds_read_b128 a[172:175], v9 offset:22528
    v_mfma_f32_16x16x32_bf16 v[220:223], a[224:227], a[200:203], v[220:223]
    ds_read_b128 a[176:179], v7 offset:61440
    s_add_u32 m0, s73, 11264
    v_mfma_f32_16x16x32_bf16 v[220:223], a[236:239], a[204:207], v[220:223]
    buffer_load_dwordx4 v4, s[40:43], s69 offen offset:0 lds
    v_mfma_f32_16x16x32_bf16 v[232:235], a[236:239], a[212:215], v[232:235]
    ds_read_b128 a[180:183], v9 offset:61440
    v_accvgpr_read_b32 v42, a124
    v_mfma_f32_16x16x32_bf16 v[232:235], a[224:227], a[208:211], v[232:235]
    ds_read_b128 a[184:187], v7 offset:63488
    s_add_u32 m0, s73, 11008
    v_mfma_f32_16x16x32_bf16 v[236:239], a[228:231], a[208:211], v[236:239]
    buffer_load_dwordx4 v3, s[40:43], s69 offen offset:1280 lds
    v_mfma_f32_16x16x32_bf16 v[236:239], a[240:243], a[212:215], v[236:239]
    ds_read_b128 a[188:191], v9 offset:63488
    v_accvgpr_read_b32 v43, a125
    v_mfma_f32_16x16x32_bf16 v[240:243], a[244:247], a[212:215], v[240:243]
    s_add_u32 m0, s73, 12032
    v_mfma_f32_16x16x32_bf16 v[240:243], a[232:235], a[208:211], v[240:243]
    buffer_load_dwordx4 v4, s[40:43], s69 offen offset:1280 lds
    v_mfma_f32_16x16x32_bf16 v[252:255], a[232:235], a[216:219], v[252:255]
    v_accvgpr_read_b32 v30, a126
    v_mfma_f32_16x16x32_bf16 v[252:255], a[244:247], a[220:223], v[252:255]
    s_add_u32 m0, s73, 14336
    v_mfma_f32_16x16x32_bf16 v[248:251], a[240:243], a[220:223], v[248:251]
    buffer_load_dwordx4 v5, s[44:47], s69 offen lds
    v_mfma_f32_16x16x32_bf16 v[248:251], a[228:231], a[216:219], v[248:251]
    v_mfma_f32_16x16x32_bf16 v[244:247], a[224:227], a[216:219], v[244:247]
    v_mfma_f32_16x16x32_bf16 v[244:247], a[236:239], a[220:223], v[244:247]
    s_waitcnt lgkmcnt(0)
    v_mfma_f32_16x16x32_bf16 v[160:163], a[136:139], a[160:163], v[160:163]
    ds_read_b128 a[192:195], v8 offset:20480
    s_add_u32 m0, s23, 0
    v_mfma_f32_16x16x32_bf16 v[160:163], a[148:151], a[164:167], v[160:163]
    buffer_load_dwordx4 v42, s[56:59], s76 offen lds
    v_mfma_f32_16x16x32_bf16 v[164:167], a[152:155], a[164:167], v[164:167]
    ds_read_b128 a[196:199], v10 offset:20480
    v_mfma_f32_16x16x32_bf16 v[164:167], a[140:143], a[160:163], v[164:167]
    ds_read_b128 a[200:203], v8 offset:22528
    v_mfma_f32_16x16x32_bf16 v[168:171], a[144:147], a[160:163], v[168:171]
    s_add_u32 m0, s73, 15360
    v_mfma_f32_16x16x32_bf16 v[168:171], a[156:159], a[164:167], v[168:171]
    buffer_load_dwordx4 v6, s[48:51], s69 offen lds
    v_mfma_f32_16x16x32_bf16 v[180:183], a[156:159], a[172:175], v[180:183]
    ds_read_b128 a[204:207], v10 offset:22528
    v_mfma_f32_16x16x32_bf16 v[180:183], a[144:147], a[168:171], v[180:183]
    ds_read_b128 a[208:211], v8 offset:61440
    s_add_u32 m0, s73, 16384
    v_mfma_f32_16x16x32_bf16 v[176:179], a[140:143], a[168:171], v[176:179]
    buffer_load_dwordx4 v5, s[44:47], s71 offen lds
    v_mfma_f32_16x16x32_bf16 v[176:179], a[152:155], a[172:175], v[176:179]
    ds_read_b128 a[212:215], v10 offset:61440
    v_mfma_f32_16x16x32_bf16 v[172:175], a[148:151], a[172:175], v[172:175]
    ds_read_b128 a[216:219], v8 offset:63488
    v_mfma_f32_16x16x32_bf16 v[172:175], a[136:139], a[168:171], v[172:175]
    s_add_u32 m0, s73, 17408
    v_mfma_f32_16x16x32_bf16 v[184:187], a[136:139], a[176:179], v[184:187]
    buffer_load_dwordx4 v6, s[48:51], s71 offen lds
    v_mfma_f32_16x16x32_bf16 v[184:187], a[148:151], a[180:183], v[184:187]
    ds_read_b128 a[220:223], v10 offset:63488
    v_mfma_f32_16x16x32_bf16 v[188:191], a[152:155], a[180:183], v[188:191]
    v_mfma_f32_16x16x32_bf16 v[188:191], a[140:143], a[176:179], v[188:191]
    s_add_u32 m0, s73, 18432
    v_mfma_f32_16x16x32_bf16 v[192:195], a[144:147], a[176:179], v[192:195]
    buffer_load_dwordx4 v5, s[44:47], s72 offen lds
    v_mfma_f32_16x16x32_bf16 v[192:195], a[156:159], a[180:183], v[192:195]
    v_mfma_f32_16x16x32_bf16 v[204:207], a[156:159], a[188:191], v[204:207]
    v_mfma_f32_16x16x32_bf16 v[204:207], a[144:147], a[184:187], v[204:207]
    s_add_u32 m0, s73, 19456
    v_mfma_f32_16x16x32_bf16 v[200:203], a[140:143], a[184:187], v[200:203]
    buffer_load_dwordx4 v6, s[48:51], s72 offen lds
    v_mfma_f32_16x16x32_bf16 v[200:203], a[152:155], a[188:191], v[200:203]
    v_mfma_f32_16x16x32_bf16 v[196:199], a[148:151], a[188:191], v[196:199]
    v_mfma_f32_16x16x32_bf16 v[196:199], a[136:139], a[184:187], v[196:199]
    s_waitcnt vmcnt(11) lgkmcnt(0)
    s_barrier
    v_mfma_f32_16x16x32_bf16 v[156:159], a[144:147], a[248:251], v[156:159]
    ds_read_b128 a[224:227], v11 offset:0
    s_add_u32 m0, s23, 1024
    v_mfma_f32_16x16x32_bf16 v[156:159], a[156:159], a[248:251], v[156:159]
    buffer_load_dwordx4 v43, s[56:59], s76 offen lds
    v_mfma_f32_16x16x32_bf16 v[152:155], a[152:155], a[248:251], v[152:155]
    ds_read_b128 a[236:239], v12 offset:0
    v_mfma_f32_16x16x32_bf16 v[152:155], a[140:143], a[248:251], v[152:155]
    ds_read_b128 a[228:231], v11 offset:2048
    v_mfma_f32_16x16x32_bf16 v[148:151], a[136:139], a[248:251], v[148:151]
    s_add_u32 s68, s68, 1
    s_cmp_ge_u32 s68, 10
    s_cselect_b32 s68, 0, s68
    v_mfma_f32_16x16x32_bf16 v[148:151], a[148:151], a[248:251], v[148:151]
    ds_read_b128 a[240:243], v12 offset:2048
    v_mfma_f32_16x16x32_bf16 v[208:211], a[148:151], a[196:199], v[208:211]
    ds_read_b128 a[232:235], v11 offset:4096
    v_mfma_f32_16x16x32_bf16 v[208:211], a[136:139], a[192:195], v[208:211]
    s_lshl_b32 s69, s68, 7
    v_mfma_f32_16x16x32_bf16 v[212:215], a[140:143], a[192:195], v[212:215]
    ds_read_b128 a[244:247], v12 offset:4096
    v_mfma_f32_16x16x32_bf16 v[212:215], a[152:155], a[196:199], v[212:215]
    ds_read_b128 a[160:163], v7 offset:0
    v_mfma_f32_16x16x32_bf16 v[216:219], a[156:159], a[196:199], v[216:219]
    s_add_u32 s71, s69, 10240
    v_mfma_f32_16x16x32_bf16 v[216:219], a[144:147], a[192:195], v[216:219]
    ds_read_b128 a[164:167], v9 offset:0
    v_mfma_f32_16x16x32_bf16 v[228:231], a[144:147], a[200:203], v[228:231]
    s_add_u32 s72, s69, 20480
    ds_read_b128 a[168:171], v7 offset:2048
    v_mfma_f32_16x16x32_bf16 v[228:231], a[156:159], a[204:207], v[228:231]
    v_mfma_f32_16x16x32_bf16 v[224:227], a[152:155], a[204:207], v[224:227]
    ds_read_b128 a[172:175], v9 offset:2048
    s_add_u32 m0, s73, 20480
    v_mfma_f32_16x16x32_bf16 v[224:227], a[140:143], a[200:203], v[224:227]
    buffer_load_dwordx4 v3, s[40:43], s69 offen offset:0 lds
    v_mfma_f32_16x16x32_bf16 v[220:223], a[136:139], a[200:203], v[220:223]
    ds_read_b128 a[176:179], v7 offset:40960
    v_mfma_f32_16x16x32_bf16 v[220:223], a[148:151], a[204:207], v[220:223]
    ds_read_b128 a[180:183], v9 offset:40960
    s_add_u32 m0, s73, 21504
    v_mfma_f32_16x16x32_bf16 v[232:235], a[148:151], a[212:215], v[232:235]
    buffer_load_dwordx4 v4, s[40:43], s69 offen offset:0 lds
    v_mfma_f32_16x16x32_bf16 v[232:235], a[136:139], a[208:211], v[232:235]
    ds_read_b128 a[184:187], v7 offset:43008
    v_mfma_f32_16x16x32_bf16 v[236:239], a[140:143], a[208:211], v[236:239]
    ds_read_b128 a[188:191], v9 offset:43008
    s_add_u32 m0, s73, 21248
    v_mfma_f32_16x16x32_bf16 v[236:239], a[152:155], a[212:215], v[236:239]
    buffer_load_dwordx4 v3, s[40:43], s69 offen offset:1280 lds
    v_mfma_f32_16x16x32_bf16 v[240:243], a[156:159], a[212:215], v[240:243]
    v_mfma_f32_16x16x32_bf16 v[240:243], a[144:147], a[208:211], v[240:243]
    s_add_u32 m0, s73, 22272
    v_mfma_f32_16x16x32_bf16 v[252:255], a[144:147], a[216:219], v[252:255]
    buffer_load_dwordx4 v4, s[40:43], s69 offen offset:1280 lds
    v_mfma_f32_16x16x32_bf16 v[252:255], a[156:159], a[220:223], v[252:255]
    v_mfma_f32_16x16x32_bf16 v[248:251], a[152:155], a[220:223], v[248:251]
    s_add_u32 m0, s73, 24576
    v_mfma_f32_16x16x32_bf16 v[248:251], a[140:143], a[216:219], v[248:251]
    buffer_load_dwordx4 v5, s[44:47], s69 offen lds
    v_mfma_f32_16x16x32_bf16 v[244:247], a[136:139], a[216:219], v[244:247]
    v_mfma_f32_16x16x32_bf16 v[244:247], a[148:151], a[220:223], v[244:247]
    s_waitcnt lgkmcnt(0)
    v_mfma_f32_16x16x32_bf16 v[160:163], a[224:227], a[160:163], v[160:163]
    ds_read_b128 a[192:195], v8 offset:0
    s_add_u32 m0, s23, 2048
    v_mfma_f32_16x16x32_bf16 v[160:163], a[236:239], a[164:167], v[160:163]
    buffer_load_dwordx4 v42, s[56:59], s77 offen lds
    v_mfma_f32_16x16x32_bf16 v[164:167], a[240:243], a[164:167], v[164:167]
    ds_read_b128 a[196:199], v10 offset:0
    v_mfma_f32_16x16x32_bf16 v[164:167], a[228:231], a[160:163], v[164:167]
    ds_read_b128 a[200:203], v8 offset:2048
    v_mfma_f32_16x16x32_bf16 v[168:171], a[232:235], a[160:163], v[168:171]
    s_add_u32 m0, s73, 25600
    v_mfma_f32_16x16x32_bf16 v[168:171], a[244:247], a[164:167], v[168:171]
    buffer_load_dwordx4 v6, s[48:51], s69 offen lds
    v_mfma_f32_16x16x32_bf16 v[180:183], a[244:247], a[172:175], v[180:183]
    ds_read_b128 a[204:207], v10 offset:2048
    v_mfma_f32_16x16x32_bf16 v[180:183], a[232:235], a[168:171], v[180:183]
    ds_read_b128 a[208:211], v8 offset:40960
    s_add_u32 m0, s73, 26624
    v_mfma_f32_16x16x32_bf16 v[176:179], a[228:231], a[168:171], v[176:179]
    buffer_load_dwordx4 v5, s[44:47], s71 offen lds
    v_mfma_f32_16x16x32_bf16 v[176:179], a[240:243], a[172:175], v[176:179]
    ds_read_b128 a[212:215], v10 offset:40960
    v_mfma_f32_16x16x32_bf16 v[172:175], a[236:239], a[172:175], v[172:175]
    ds_read_b128 a[216:219], v8 offset:43008
    v_mfma_f32_16x16x32_bf16 v[172:175], a[224:227], a[168:171], v[172:175]
    s_add_u32 m0, s73, 27648
    v_mfma_f32_16x16x32_bf16 v[184:187], a[224:227], a[176:179], v[184:187]
    buffer_load_dwordx4 v6, s[48:51], s71 offen lds
    v_mfma_f32_16x16x32_bf16 v[184:187], a[236:239], a[180:183], v[184:187]
    ds_read_b128 a[220:223], v10 offset:43008
    v_mfma_f32_16x16x32_bf16 v[188:191], a[240:243], a[180:183], v[188:191]
    v_mfma_f32_16x16x32_bf16 v[188:191], a[228:231], a[176:179], v[188:191]
    s_add_u32 m0, s73, 28672
    v_mfma_f32_16x16x32_bf16 v[192:195], a[232:235], a[176:179], v[192:195]
    buffer_load_dwordx4 v5, s[44:47], s72 offen lds
    v_mfma_f32_16x16x32_bf16 v[192:195], a[244:247], a[180:183], v[192:195]
    v_mfma_f32_16x16x32_bf16 v[204:207], a[244:247], a[188:191], v[204:207]
    v_mfma_f32_16x16x32_bf16 v[204:207], a[232:235], a[184:187], v[204:207]
    s_add_u32 m0, s73, 29696
    v_mfma_f32_16x16x32_bf16 v[200:203], a[228:231], a[184:187], v[200:203]
    buffer_load_dwordx4 v6, s[48:51], s72 offen lds
    v_mfma_f32_16x16x32_bf16 v[200:203], a[240:243], a[188:191], v[200:203]
    v_mfma_f32_16x16x32_bf16 v[196:199], a[236:239], a[188:191], v[196:199]
    v_mfma_f32_16x16x32_bf16 v[196:199], a[224:227], a[184:187], v[196:199]
    s_waitcnt vmcnt(12) lgkmcnt(0)
    s_barrier
    v_mfma_f32_16x16x32_bf16 v[156:159], a[232:235], a[248:251], v[156:159]
    ds_read_b128 a[136:139], v11 offset:10240
    buffer_load_dword v28, v29, s[52:55], 0 offen sc1
    s_add_u32 m0, s23, 3072
    v_mfma_f32_16x16x32_bf16 v[156:159], a[244:247], a[248:251], v[156:159]
    buffer_load_dwordx4 v43, s[56:59], s77 offen lds
    v_mfma_f32_16x16x32_bf16 v[152:155], a[240:243], a[248:251], v[152:155]
    ds_read_b128 a[148:151], v12 offset:10240
    v_mfma_f32_16x16x32_bf16 v[152:155], a[228:231], a[248:251], v[152:155]
    ds_read_b128 a[140:143], v11 offset:12288
    v_mfma_f32_16x16x32_bf16 v[148:151], a[224:227], a[248:251], v[148:151]
    s_add_u32 s68, s68, 1
    s_cmp_ge_u32 s68, 10
    s_cselect_b32 s68, 0, s68
    v_mfma_f32_16x16x32_bf16 v[148:151], a[236:239], a[248:251], v[148:151]
    ds_read_b128 a[152:155], v12 offset:12288
    v_mfma_f32_16x16x32_bf16 v[208:211], a[236:239], a[196:199], v[208:211]
    ds_read_b128 a[144:147], v11 offset:14336
    v_mfma_f32_16x16x32_bf16 v[208:211], a[224:227], a[192:195], v[208:211]
    s_lshl_b32 s69, s68, 7
    v_mfma_f32_16x16x32_bf16 v[212:215], a[228:231], a[192:195], v[212:215]
    ds_read_b128 a[156:159], v12 offset:14336
    v_mfma_f32_16x16x32_bf16 v[212:215], a[240:243], a[196:199], v[212:215]
    ds_read_b128 a[160:163], v7 offset:10240
    v_mfma_f32_16x16x32_bf16 v[216:219], a[244:247], a[196:199], v[216:219]
    s_add_u32 s71, s69, 10240
    v_mfma_f32_16x16x32_bf16 v[216:219], a[232:235], a[192:195], v[216:219]
    ds_read_b128 a[164:167], v9 offset:10240
    v_mfma_f32_16x16x32_bf16 v[228:231], a[232:235], a[200:203], v[228:231]
    s_add_u32 s72, s69, 20480
    ds_read_b128 a[168:171], v7 offset:12288
    v_mfma_f32_16x16x32_bf16 v[228:231], a[244:247], a[204:207], v[228:231]
    v_mfma_f32_16x16x32_bf16 v[224:227], a[240:243], a[204:207], v[224:227]
    ds_read_b128 a[172:175], v9 offset:12288
    s_add_u32 m0, s73, 0
    v_mfma_f32_16x16x32_bf16 v[224:227], a[228:231], a[200:203], v[224:227]
    buffer_load_dwordx4 v3, s[40:43], s69 offen offset:0 lds
    v_mfma_f32_16x16x32_bf16 v[220:223], a[224:227], a[200:203], v[220:223]
    ds_read_b128 a[176:179], v7 offset:51200
    v_mfma_f32_16x16x32_bf16 v[220:223], a[236:239], a[204:207], v[220:223]
    ds_read_b128 a[180:183], v9 offset:51200
    s_add_u32 m0, s73, 1024
    v_mfma_f32_16x16x32_bf16 v[232:235], a[236:239], a[212:215], v[232:235]
    buffer_load_dwordx4 v4, s[40:43], s69 offen offset:0 lds
    v_mfma_f32_16x16x32_bf16 v[232:235], a[224:227], a[208:211], v[232:235]
    ds_read_b128 a[184:187], v7 offset:53248
    v_mfma_f32_16x16x32_bf16 v[236:239], a[228:231], a[208:211], v[236:239]
    ds_read_b128 a[188:191], v9 offset:53248
    s_add_u32 m0, s73, 768
    v_mfma_f32_16x16x32_bf16 v[236:239], a[240:243], a[212:215], v[236:239]
    buffer_load_dwordx4 v3, s[40:43], s69 offen offset:1280 lds
    v_mfma_f32_16x16x32_bf16 v[240:243], a[244:247], a[212:215], v[240:243]
    v_mfma_f32_16x16x32_bf16 v[240:243], a[232:235], a[208:211], v[240:243]
    s_add_u32 m0, s73, 1792
    v_mfma_f32_16x16x32_bf16 v[252:255], a[232:235], a[216:219], v[252:255]
    buffer_load_dwordx4 v4, s[40:43], s69 offen offset:1280 lds
    v_mfma_f32_16x16x32_bf16 v[252:255], a[244:247], a[220:223], v[252:255]
    v_mfma_f32_16x16x32_bf16 v[248:251], a[240:243], a[220:223], v[248:251]
    s_add_u32 m0, s73, 4096
    v_mfma_f32_16x16x32_bf16 v[248:251], a[228:231], a[216:219], v[248:251]
    buffer_load_dwordx4 v5, s[44:47], s69 offen lds
    v_mfma_f32_16x16x32_bf16 v[244:247], a[224:227], a[216:219], v[244:247]
    v_mfma_f32_16x16x32_bf16 v[244:247], a[236:239], a[220:223], v[244:247]
    s_waitcnt lgkmcnt(0)
    v_mfma_f32_16x16x32_bf16 v[160:163], a[136:139], a[160:163], v[160:163]
    ds_read_b128 a[192:195], v8 offset:10240
    s_add_u32 m0, s23, 4096
    v_mfma_f32_16x16x32_bf16 v[160:163], a[148:151], a[164:167], v[160:163]
    buffer_load_dwordx4 v42, s[56:59], s78 offen lds
    v_mfma_f32_16x16x32_bf16 v[164:167], a[152:155], a[164:167], v[164:167]
    ds_read_b128 a[196:199], v10 offset:10240
    v_mfma_f32_16x16x32_bf16 v[164:167], a[140:143], a[160:163], v[164:167]
    ds_read_b128 a[200:203], v8 offset:12288
    v_mfma_f32_16x16x32_bf16 v[168:171], a[144:147], a[160:163], v[168:171]
    s_add_u32 m0, s73, 5120
    v_mfma_f32_16x16x32_bf16 v[168:171], a[156:159], a[164:167], v[168:171]
    buffer_load_dwordx4 v6, s[48:51], s69 offen lds
    v_mfma_f32_16x16x32_bf16 v[180:183], a[156:159], a[172:175], v[180:183]
    ds_read_b128 a[204:207], v10 offset:12288
    v_mfma_f32_16x16x32_bf16 v[180:183], a[144:147], a[168:171], v[180:183]
    ds_read_b128 a[208:211], v8 offset:51200
    s_add_u32 m0, s73, 6144
    v_mfma_f32_16x16x32_bf16 v[176:179], a[140:143], a[168:171], v[176:179]
    buffer_load_dwordx4 v5, s[44:47], s71 offen lds
    v_mfma_f32_16x16x32_bf16 v[176:179], a[152:155], a[172:175], v[176:179]
    ds_read_b128 a[212:215], v10 offset:51200
    v_mfma_f32_16x16x32_bf16 v[172:175], a[148:151], a[172:175], v[172:175]
    ds_read_b128 a[216:219], v8 offset:53248
    v_mfma_f32_16x16x32_bf16 v[172:175], a[136:139], a[168:171], v[172:175]
    s_add_u32 m0, s73, 7168
    v_mfma_f32_16x16x32_bf16 v[184:187], a[136:139], a[176:179], v[184:187]
    buffer_load_dwordx4 v6, s[48:51], s71 offen lds
    v_mfma_f32_16x16x32_bf16 v[184:187], a[148:151], a[180:183], v[184:187]
    ds_read_b128 a[220:223], v10 offset:53248
    v_mfma_f32_16x16x32_bf16 v[188:191], a[152:155], a[180:183], v[188:191]
    v_mfma_f32_16x16x32_bf16 v[188:191], a[140:143], a[176:179], v[188:191]
    s_add_u32 m0, s73, 8192
    v_mfma_f32_16x16x32_bf16 v[192:195], a[144:147], a[176:179], v[192:195]
    buffer_load_dwordx4 v5, s[44:47], s72 offen lds
    v_mfma_f32_16x16x32_bf16 v[192:195], a[156:159], a[180:183], v[192:195]
    s_waitcnt vmcnt(11)
    v_cmp_ne_u32 vcc, s34, v28
    v_mfma_f32_16x16x32_bf16 v[204:207], a[156:159], a[188:191], v[204:207]
    v_mfma_f32_16x16x32_bf16 v[204:207], a[144:147], a[184:187], v[204:207]
    s_add_u32 m0, s73, 9216
    v_mfma_f32_16x16x32_bf16 v[200:203], a[140:143], a[184:187], v[200:203]
    buffer_load_dwordx4 v6, s[48:51], s72 offen lds
    v_mfma_f32_16x16x32_bf16 v[200:203], a[152:155], a[188:191], v[200:203]
    v_mfma_f32_16x16x32_bf16 v[196:199], a[148:151], a[188:191], v[196:199]
    v_mfma_f32_16x16x32_bf16 v[196:199], a[136:139], a[184:187], v[196:199]
    s_waitcnt lgkmcnt(0)
    s_cbranch_vccnz L_paS
L_paSd:
    s_barrier
    v_mfma_f32_16x16x32_bf16 v[156:159], a[144:147], a[248:251], v[156:159]
    ds_read_b128 a[224:227], v11 offset:20480
    s_add_u32 m0, s23, 40960
    v_mfma_f32_16x16x32_bf16 v[156:159], a[156:159], a[248:251], v[156:159]
    buffer_load_dwordx4 v21, s[52:55], s18 offen sc1 lds
    v_mfma_f32_16x16x32_bf16 v[152:155], a[152:155], a[248:251], v[152:155]
    ds_read_b128 a[236:239], v12 offset:20480
    v_mfma_f32_16x16x32_bf16 v[152:155], a[140:143], a[248:251], v[152:155]
    ds_read_b128 a[228:231], v11 offset:22528
    v_mfma_f32_16x16x32_bf16 v[148:151], a[136:139], a[248:251], v[148:151]
    ds_read_b128 a[240:243], v12 offset:22528
    v_mfma_f32_16x16x32_bf16 v[148:151], a[148:151], a[248:251], v[148:151]
    s_add_u32 m0, s73, 10240
    v_mfma_f32_16x16x32_bf16 v[208:211], a[148:151], a[196:199], v[208:211]
    buffer_load_dwordx4 v17, s[56:59], s76 offen lds
    v_mfma_f32_16x16x32_bf16 v[208:211], a[136:139], a[192:195], v[208:211]
    ds_read_b128 a[232:235], v11 offset:24576
    v_mfma_f32_16x16x32_bf16 v[212:215], a[140:143], a[192:195], v[212:215]
    ds_read_b128 a[244:247], v12 offset:24576
    v_mfma_f32_16x16x32_bf16 v[212:215], a[152:155], a[196:199], v[212:215]
    ds_read_b128 a[160:163], v7 offset:20480
    v_mfma_f32_16x16x32_bf16 v[216:219], a[156:159], a[196:199], v[216:219]
    s_add_u32 m0, s73, 11264
    v_mfma_f32_16x16x32_bf16 v[216:219], a[144:147], a[192:195], v[216:219]
    buffer_load_dwordx4 v18, s[56:59], s76 offen lds
    v_mfma_f32_16x16x32_bf16 v[228:231], a[144:147], a[200:203], v[228:231]
    ds_read_b128 a[164:167], v9 offset:20480
    ds_read_b128 a[168:171], v7 offset:22528
    v_mfma_f32_16x16x32_bf16 v[228:231], a[156:159], a[204:207], v[228:231]
    v_mfma_f32_16x16x32_bf16 v[224:227], a[152:155], a[204:207], v[224:227]
    ds_read_b128 a[172:175], v9 offset:22528
    s_add_u32 m0, s73, 12288
    v_mfma_f32_16x16x32_bf16 v[224:227], a[140:143], a[200:203], v[224:227]
    buffer_load_dwordx4 v17, s[56:59], s77 offen lds
    v_mfma_f32_16x16x32_bf16 v[220:223], a[136:139], a[200:203], v[220:223]
    ds_read_b128 a[176:179], v7 offset:61440
    v_mfma_f32_16x16x32_bf16 v[220:223], a[148:151], a[204:207], v[220:223]
    ds_read_b128 a[180:183], v9 offset:61440
    v_mfma_f32_16x16x32_bf16 v[232:235], a[148:151], a[212:215], v[232:235]
    v_mfma_f32_16x16x32_bf16 v[232:235], a[136:139], a[208:211], v[232:235]
    ds_read_b128 a[184:187], v7 offset:63488
    s_add_u32 m0, s73, 13312
    v_mfma_f32_16x16x32_bf16 v[236:239], a[140:143], a[208:211], v[236:239]
    buffer_load_dwordx4 v18, s[56:59], s77 offen lds
    v_mfma_f32_16x16x32_bf16 v[236:239], a[152:155], a[212:215], v[236:239]
    ds_read_b128 a[188:191], v9 offset:63488
    v_mfma_f32_16x16x32_bf16 v[240:243], a[156:159], a[212:215], v[240:243]
    v_mfma_f32_16x16x32_bf16 v[240:243], a[144:147], a[208:211], v[240:243]
    v_mfma_f32_16x16x32_bf16 v[252:255], a[144:147], a[216:219], v[252:255]
    s_add_u32 m0, s73, 14336
    v_mfma_f32_16x16x32_bf16 v[252:255], a[156:159], a[220:223], v[252:255]
    buffer_load_dwordx4 v17, s[56:59], s78 offen lds
    v_mfma_f32_16x16x32_bf16 v[248:251], a[152:155], a[220:223], v[248:251]
    v_mfma_f32_16x16x32_bf16 v[248:251], a[140:143], a[216:219], v[248:251]
    v_mfma_f32_16x16x32_bf16 v[244:247], a[136:139], a[216:219], v[244:247]
    v_mfma_f32_16x16x32_bf16 v[244:247], a[148:151], a[220:223], v[244:247]
    s_waitcnt lgkmcnt(0)
    v_mfma_f32_16x16x32_bf16 v[160:163], a[224:227], a[160:163], v[160:163]
    ds_read_b128 a[192:195], v8 offset:20480
    s_add_u32 m0, s73, 15360
    v_mfma_f32_16x16x32_bf16 v[160:163], a[236:239], a[164:167], v[160:163]
    buffer_load_dwordx4 v18, s[56:59], s78 offen lds
    v_mfma_f32_16x16x32_bf16 v[164:167], a[240:243], a[164:167], v[164:167]
    ds_read_b128 a[196:199], v10 offset:20480
    v_mfma_f32_16x16x32_bf16 v[164:167], a[228:231], a[160:163], v[164:167]
    ds_read_b128 a[200:203], v8 offset:22528
    v_mfma_f32_16x16x32_bf16 v[168:171], a[232:235], a[160:163], v[168:171]
    s_add_u32 m0, s73, 16384
    v_mfma_f32_16x16x32_bf16 v[168:171], a[244:247], a[164:167], v[168:171]
    buffer_load_dwordx4 v17, s[56:59], s79 offen lds
    v_mfma_f32_16x16x32_bf16 v[180:183], a[244:247], a[172:175], v[180:183]
    ds_read_b128 a[204:207], v10 offset:22528
    v_mfma_f32_16x16x32_bf16 v[180:183], a[232:235], a[168:171], v[180:183]
    ds_read_b128 a[208:211], v8 offset:61440
    s_add_u32 m0, s73, 17408
    v_mfma_f32_16x16x32_bf16 v[176:179], a[228:231], a[168:171], v[176:179]
    buffer_load_dwordx4 v18, s[56:59], s79 offen lds
    v_mfma_f32_16x16x32_bf16 v[176:179], a[240:243], a[172:175], v[176:179]
    ds_read_b128 a[212:215], v10 offset:61440
    v_mfma_f32_16x16x32_bf16 v[172:175], a[236:239], a[172:175], v[172:175]
    ds_read_b128 a[216:219], v8 offset:63488
    v_mfma_f32_16x16x32_bf16 v[172:175], a[224:227], a[168:171], v[172:175]
    s_add_u32 m0, s73, 18432
    v_mfma_f32_16x16x32_bf16 v[184:187], a[224:227], a[176:179], v[184:187]
    buffer_load_dwordx4 v17, s[56:59], s80 offen lds
    v_mfma_f32_16x16x32_bf16 v[184:187], a[236:239], a[180:183], v[184:187]
    ds_read_b128 a[220:223], v10 offset:63488
    v_mfma_f32_16x16x32_bf16 v[188:191], a[240:243], a[180:183], v[188:191]
    v_mfma_f32_16x16x32_bf16 v[188:191], a[228:231], a[176:179], v[188:191]
    s_add_u32 m0, s73, 19456
    v_mfma_f32_16x16x32_bf16 v[192:195], a[232:235], a[176:179], v[192:195]
    buffer_load_dwordx4 v18, s[56:59], s80 offen lds
    v_mfma_f32_16x16x32_bf16 v[192:195], a[244:247], a[180:183], v[192:195]
    v_mfma_f32_16x16x32_bf16 v[204:207], a[244:247], a[188:191], v[204:207]
    v_mfma_f32_16x16x32_bf16 v[204:207], a[232:235], a[184:187], v[204:207]
    v_mfma_f32_16x16x32_bf16 v[200:203], a[228:231], a[184:187], v[200:203]
    v_add_u32 v17, 128, v17
    v_add_u32 v18, 128, v18
    v_mfma_f32_16x16x32_bf16 v[200:203], a[240:243], a[188:191], v[200:203]
    v_mfma_f32_16x16x32_bf16 v[196:199], a[236:239], a[188:191], v[196:199]
    v_mfma_f32_16x16x32_bf16 v[196:199], a[224:227], a[184:187], v[196:199]
    s_waitcnt vmcnt(10) lgkmcnt(0)
    s_barrier
    v_mfma_f32_16x16x32_bf16 v[156:159], a[232:235], a[248:251], v[156:159]
    ds_read_b128 a[136:139], v11 offset:0
    buffer_load_dword v28, v31, s[52:55], 0 offen sc1
    s_add_u32 m0, s73, 20480
    v_mfma_f32_16x16x32_bf16 v[156:159], a[244:247], a[248:251], v[156:159]
    buffer_load_dwordx4 v17, s[56:59], s76 offen lds
    v_mfma_f32_16x16x32_bf16 v[152:155], a[240:243], a[248:251], v[152:155]
    ds_read_b128 a[148:151], v12 offset:0
    v_lshl_add_u32 v13, v1, 6, s23
    v_mfma_f32_16x16x32_bf16 v[152:155], a[228:231], a[248:251], v[152:155]
    ds_read_b128 a[140:143], v11 offset:2048
    v_mfma_f32_16x16x32_bf16 v[148:151], a[224:227], a[248:251], v[148:151]
    ds_read_b128 a[152:155], v12 offset:2048
    v_mfma_f32_16x16x32_bf16 v[148:151], a[236:239], a[248:251], v[148:151]
    v_mfma_f32_16x16x32_bf16 v[208:211], a[236:239], a[196:199], v[208:211]
    ds_read_b128 a[144:147], v11 offset:4096
    s_add_u32 m0, s73, 21504
    v_mfma_f32_16x16x32_bf16 v[208:211], a[224:227], a[192:195], v[208:211]
    buffer_load_dwordx4 v18, s[56:59], s76 offen lds
    v_mfma_f32_16x16x32_bf16 v[212:215], a[228:231], a[192:195], v[212:215]
    ds_read_b128 a[156:159], v12 offset:4096
    ds_read_b128 v[132:135], v13 offset:40960
    v_mfma_f32_16x16x32_bf16 v[212:215], a[240:243], a[196:199], v[212:215]
    ds_read_b128 a[160:163], v7 offset:0
    v_mfma_f32_16x16x32_bf16 v[216:219], a[244:247], a[196:199], v[216:219]
    v_mfma_f32_16x16x32_bf16 v[216:219], a[232:235], a[192:195], v[216:219]
    ds_read_b128 a[164:167], v9 offset:0
    s_add_u32 m0, s73, 22528
    v_mfma_f32_16x16x32_bf16 v[228:231], a[232:235], a[200:203], v[228:231]
    buffer_load_dwordx4 v17, s[56:59], s77 offen lds
    v_mfma_f32_16x16x32_bf16 v[228:231], a[244:247], a[204:207], v[228:231]
    ds_read_b128 a[168:171], v7 offset:2048
    ds_read_b128 v[136:139], v13 offset:40976
    v_mfma_f32_16x16x32_bf16 v[224:227], a[240:243], a[204:207], v[224:227]
    ds_read_b128 a[172:175], v9 offset:2048
    v_mfma_f32_16x16x32_bf16 v[224:227], a[228:231], a[200:203], v[224:227]
    v_mfma_f32_16x16x32_bf16 v[220:223], a[224:227], a[200:203], v[220:223]
    ds_read_b128 a[176:179], v7 offset:40960
    ds_read_b128 a[0:3], v30 offset:0
    v_mfma_f32_16x16x32_bf16 v[220:223], a[236:239], a[204:207], v[220:223]
    ds_read_b128 a[180:183], v9 offset:40960
    s_add_u32 m0, s73, 23552
    v_mfma_f32_16x16x32_bf16 v[232:235], a[236:239], a[212:215], v[232:235]
    buffer_load_dwordx4 v18, s[56:59], s77 offen lds
    v_mfma_f32_16x16x32_bf16 v[232:235], a[224:227], a[208:211], v[232:235]
    ds_read_b128 a[184:187], v7 offset:43008
    ds_read_b128 a[4:7], v30 offset:2048
    v_mfma_f32_16x16x32_bf16 v[236:239], a[228:231], a[208:211], v[236:239]
    ds_read_b128 a[188:191], v9 offset:43008
    ds_read_b128 v[140:143], v13 offset:40992
    v_mfma_f32_16x16x32_bf16 v[236:239], a[240:243], a[212:215], v[236:239]
    ds_read_b128 a[8:11], v30 offset:4096
    v_mfma_f32_16x16x32_bf16 v[240:243], a[244:247], a[212:215], v[240:243]
    v_mfma_f32_16x16x32_bf16 v[240:243], a[232:235], a[208:211], v[240:243]
    ds_read_b128 a[12:15], v30 offset:6144
    s_add_u32 m0, s73, 24576
    v_mfma_f32_16x16x32_bf16 v[252:255], a[232:235], a[216:219], v[252:255]
    buffer_load_dwordx4 v17, s[56:59], s78 offen lds
    v_mfma_f32_16x16x32_bf16 v[252:255], a[244:247], a[220:223], v[252:255]
    ds_read_b128 v[144:147], v13 offset:41008
    v_mfma_f32_16x16x32_bf16 v[248:251], a[240:243], a[220:223], v[248:251]
    ds_read_b128 a[16:19], v30 offset:8192
    v_mfma_f32_16x16x32_bf16 v[248:251], a[228:231], a[216:219], v[248:251]
    v_mfma_f32_16x16x32_bf16 v[244:247], a[224:227], a[216:219], v[244:247]
    v_mfma_f32_16x16x32_bf16 v[244:247], a[236:239], a[220:223], v[244:247]
    s_waitcnt lgkmcnt(0)
    v_mfma_f32_16x16x32_bf16 v[160:163], a[136:139], a[160:163], v[160:163]
    ds_read_b128 a[192:195], v8 offset:0
    s_add_u32 m0, s73, 25600
    v_mfma_f32_16x16x32_bf16 v[160:163], a[148:151], a[164:167], v[160:163]
    buffer_load_dwordx4 v18, s[56:59], s78 offen lds
    v_mfma_f32_16x16x32_bf16 v[164:167], a[152:155], a[164:167], v[164:167]
    ds_read_b128 a[196:199], v10 offset:0
    v_mfma_f32_16x16x32_bf16 v[164:167], a[140:143], a[160:163], v[164:167]
    ds_read_b128 a[200:203], v8 offset:2048
    v_mfma_f32_16x16x32_bf16 v[168:171], a[144:147], a[160:163], v[168:171]
    s_add_u32 m0, s73, 26624
    v_mfma_f32_16x16x32_bf16 v[168:171], a[156:159], a[164:167], v[168:171]
    buffer_load_dwordx4 v17, s[56:59], s79 offen lds
    v_mfma_f32_16x16x32_bf16 v[180:183], a[156:159], a[172:175], v[180:183]
    ds_read_b128 a[204:207], v10 offset:2048
    v_mfma_f32_16x16x32_bf16 v[180:183], a[144:147], a[168:171], v[180:183]
    ds_read_b128 a[208:211], v8 offset:40960
    v_mfma_f32_16x16x32_bf16 v[176:179], a[140:143], a[168:171], v[176:179]
    v_mfma_f32_16x16x32_bf16 v[176:179], a[152:155], a[172:175], v[176:179]
    ds_read_b128 a[212:215], v10 offset:40960
    s_add_u32 m0, s73, 27648
    v_mfma_f32_16x16x32_bf16 v[172:175], a[148:151], a[172:175], v[172:175]
    buffer_load_dwordx4 v18, s[56:59], s79 offen lds
    v_mfma_f32_16x16x32_bf16 v[172:175], a[136:139], a[168:171], v[172:175]
    ds_read_b128 a[216:219], v8 offset:43008
    v_mfma_f32_16x16x32_bf16 v[184:187], a[136:139], a[176:179], v[184:187]
    ds_read_b128 a[220:223], v10 offset:43008
    v_mfma_f32_16x16x32_bf16 v[184:187], a[148:151], a[180:183], v[184:187]
    s_add_u32 m0, s73, 28672
    v_mfma_f32_16x16x32_bf16 v[188:191], a[152:155], a[180:183], v[188:191]
    buffer_load_dwordx4 v17, s[56:59], s80 offen lds
    v_mfma_f32_16x16x32_bf16 v[188:191], a[140:143], a[176:179], v[188:191]
    v_mfma_f32_16x16x32_bf16 v[192:195], a[144:147], a[176:179], v[192:195]
    v_mfma_f32_16x16x32_bf16 v[192:195], a[156:159], a[180:183], v[192:195]
    s_waitcnt vmcnt(9)
    v_cmp_ne_u32 vcc, s34, v28
    v_mfma_f32_16x16x32_bf16 v[204:207], a[156:159], a[188:191], v[204:207]
    s_add_u32 m0, s73, 29696
    v_mfma_f32_16x16x32_bf16 v[204:207], a[144:147], a[184:187], v[204:207]
    buffer_load_dwordx4 v18, s[56:59], s80 offen lds
    v_mfma_f32_16x16x32_bf16 v[200:203], a[140:143], a[184:187], v[200:203]
    v_mfma_f32_16x16x32_bf16 v[200:203], a[152:155], a[188:191], v[200:203]
    v_mfma_f32_16x16x32_bf16 v[196:199], a[148:151], a[188:191], v[196:199]
    v_mfma_f32_16x16x32_bf16 v[196:199], a[136:139], a[184:187], v[196:199]
    s_waitcnt lgkmcnt(0)
    s_cbranch_vccnz L_prS
L_prSd:
    s_barrier
    v_mfma_f32_16x16x32_bf16 v[156:159], a[144:147], a[248:251], v[156:159]
    ds_read_b128 a[20:23], v19 offset:10240
    s_add_u32 m0, s73, 30720
    v_mfma_f32_16x16x32_bf16 v[156:159], a[156:159], a[248:251], v[156:159]
    buffer_load_dwordx4 v21, s[52:55], s85 offen offset:0 sc1 lds
    v_mfma_f32_16x16x32_bf16 v[152:155], a[152:155], a[248:251], v[152:155]
    ds_read_b128 a[24:27], v19 offset:12288
    s_add_u32 m0, s73, 30720
    v_mfma_f32_16x16x32_bf16 v[152:155], a[140:143], a[248:251], v[152:155]
    buffer_load_dwordx4 v21, s[52:55], s85 offen offset:1024 sc1 lds
    v_mfma_f32_16x16x32_bf16 v[148:151], a[136:139], a[248:251], v[148:151]
    ds_read_b128 a[28:31], v19 offset:14336
    v_mfma_f32_16x16x32_bf16 v[148:151], a[148:151], a[248:251], v[148:151]
    s_add_u32 m0, s73, 30720
    v_mfma_f32_16x16x32_bf16 v[208:211], a[148:151], a[196:199], v[208:211]
    buffer_load_dwordx4 v21, s[52:55], s85 offen offset:2048 sc1 lds
    v_mfma_f32_16x16x32_bf16 v[208:211], a[136:139], a[192:195], v[208:211]
    ds_read_b128 a[32:35], v19 offset:16384
    s_add_u32 m0, s73, 30720
    v_mfma_f32_16x16x32_bf16 v[212:215], a[140:143], a[192:195], v[212:215]
    buffer_load_dwordx4 v21, s[52:55], s85 offen offset:3072 sc1 lds
    v_mfma_f32_16x16x32_bf16 v[212:215], a[152:155], a[196:199], v[212:215]
    ds_read_b128 a[36:39], v19 offset:18432
    v_mfma_f32_16x16x32_bf16 v[216:219], a[156:159], a[196:199], v[216:219]
    s_add_u32 m0, s73, 34816
    v_mfma_f32_16x16x32_bf16 v[216:219], a[144:147], a[192:195], v[216:219]
    buffer_load_dwordx4 v22, s[52:55], s85 offen offset:0 sc1 lds
    v_mfma_f32_16x16x32_bf16 v[228:231], a[144:147], a[200:203], v[228:231]
    ds_read_b128 a[40:43], v20 offset:10240
    v_mfma_f32_16x16x32_bf16 v[228:231], a[156:159], a[204:207], v[228:231]
    s_add_u32 s85, s85, 5120
    ds_read_b128 a[44:47], v20 offset:12288
    v_mfma_f32_16x16x32_bf16 v[224:227], a[152:155], a[204:207], v[224:227]
    s_add_u32 m0, s73, 35840
    v_mfma_f32_16x16x32_bf16 v[224:227], a[140:143], a[200:203], v[224:227]
    buffer_load_dwordx4 v21, s[52:55], s85 offen offset:0 sc1 lds
    v_mfma_f32_16x16x32_bf16 v[220:223], a[136:139], a[200:203], v[220:223]
    ds_read_b128 a[48:51], v20 offset:14336
    v_mfma_f32_16x16x32_bf16 v[220:223], a[148:151], a[204:207], v[220:223]
    s_add_u32 m0, s73, 35840
    v_mfma_f32_16x16x32_bf16 v[232:235], a[148:151], a[212:215], v[232:235]
    buffer_load_dwordx4 v21, s[52:55], s85 offen offset:1024 sc1 lds
    v_mfma_f32_16x16x32_bf16 v[232:235], a[136:139], a[208:211], v[232:235]
    ds_read_b128 a[52:55], v20 offset:16384
    s_add_u32 m0, s73, 35840
    v_mfma_f32_16x16x32_bf16 v[236:239], a[140:143], a[208:211], v[236:239]
    buffer_load_dwordx4 v21, s[52:55], s85 offen offset:2048 sc1 lds
    v_mfma_f32_16x16x32_bf16 v[236:239], a[152:155], a[212:215], v[236:239]
    ds_read_b128 a[56:59], v20 offset:18432
    s_add_u32 m0, s73, 35840
    v_mfma_f32_16x16x32_bf16 v[240:243], a[156:159], a[212:215], v[240:243]
    buffer_load_dwordx4 v21, s[52:55], s85 offen offset:3072 sc1 lds
    v_mfma_f32_16x16x32_bf16 v[240:243], a[144:147], a[208:211], v[240:243]
    v_mfma_f32_16x16x32_bf16 v[252:255], a[144:147], a[216:219], v[252:255]
    s_add_u32 m0, s73, 39936
    v_mfma_f32_16x16x32_bf16 v[252:255], a[156:159], a[220:223], v[252:255]
    buffer_load_dwordx4 v22, s[52:55], s85 offen offset:0 sc1 lds
    v_mfma_f32_16x16x32_bf16 v[248:251], a[152:155], a[220:223], v[248:251]
    v_mfma_f32_16x16x32_bf16 v[248:251], a[140:143], a[216:219], v[248:251]
    s_add_u32 s85, s85, 5120
    v_mfma_f32_16x16x32_bf16 v[244:247], a[136:139], a[216:219], v[244:247]
    v_mfma_f32_16x16x32_bf16 v[244:247], a[148:151], a[220:223], v[244:247]
    s_waitcnt lgkmcnt(0)
    s_add_u32 m0, s73, 0
    v_pk_fma_f32 v[160:161], v[132:133], v[148:149], v[160:161] op_sel_hi:[0,1,1] neg_lo:[1,0,0] neg_hi:[1,0,0]
    buffer_load_dwordx4 v21, s[52:55], s85 offen offset:0 sc1 lds
    v_pk_fma_f32 v[162:163], v[132:133], v[150:151], v[162:163] op_sel_hi:[0,1,1] neg_lo:[1,0,0] neg_hi:[1,0,0]
    v_pk_fma_f32 v[164:165], v[132:133], v[152:153], v[164:165] op_sel_hi:[0,1,1] neg_lo:[1,0,0] neg_hi:[1,0,0]
    v_pk_fma_f32 v[166:167], v[132:133], v[154:155], v[166:167] op_sel_hi:[0,1,1] neg_lo:[1,0,0] neg_hi:[1,0,0]
    v_pk_fma_f32 v[168:169], v[132:133], v[156:157], v[168:169] op_sel_hi:[0,1,1] neg_lo:[1,0,0] neg_hi:[1,0,0]
    v_pk_fma_f32 v[170:171], v[132:133], v[158:159], v[170:171] op_sel_hi:[0,1,1] neg_lo:[1,0,0] neg_hi:[1,0,0]
    v_pk_mul_f32 v[160:161], v[132:133], v[160:161] op_sel:[1,0] op_sel_hi:[1,1]
    v_pk_mul_f32 v[162:163], v[132:133], v[162:163] op_sel:[1,0] op_sel_hi:[1,1]
    v_pk_mul_f32 v[164:165], v[132:133], v[164:165] op_sel:[1,0] op_sel_hi:[1,1]
    v_pk_mul_f32 v[166:167], v[132:133], v[166:167] op_sel:[1,0] op_sel_hi:[1,1]
    v_pk_mul_f32 v[168:169], v[132:133], v[168:169] op_sel:[1,0] op_sel_hi:[1,1]
    v_pk_mul_f32 v[170:171], v[132:133], v[170:171] op_sel:[1,0] op_sel_hi:[1,1]
    v_pk_fma_f32 v[172:173], v[134:135], v[148:149], v[172:173] op_sel_hi:[0,1,1] neg_lo:[1,0,0] neg_hi:[1,0,0]
    v_pk_fma_f32 v[174:175], v[134:135], v[150:151], v[174:175] op_sel_hi:[0,1,1] neg_lo:[1,0,0] neg_hi:[1,0,0]
    v_pk_fma_f32 v[176:177], v[134:135], v[152:153], v[176:177] op_sel_hi:[0,1,1] neg_lo:[1,0,0] neg_hi:[1,0,0]
    s_add_u32 m0, s73, 0
    v_pk_fma_f32 v[178:179], v[134:135], v[154:155], v[178:179] op_sel_hi:[0,1,1] neg_lo:[1,0,0] neg_hi:[1,0,0]
    buffer_load_dwordx4 v21, s[52:55], s85 offen offset:1024 sc1 lds
    s_nop 0
    v_pk_fma_f32 v[180:181], v[134:135], v[156:157], v[180:181] op_sel_hi:[0,1,1] neg_lo:[1,0,0] neg_hi:[1,0,0]
    v_pk_fma_f32 v[182:183], v[134:135], v[158:159], v[182:183] op_sel_hi:[0,1,1] neg_lo:[1,0,0] neg_hi:[1,0,0]
    v_pk_mul_f32 v[172:173], v[134:135], v[172:173] op_sel:[1,0] op_sel_hi:[1,1]
    v_pk_mul_f32 v[174:175], v[134:135], v[174:175] op_sel:[1,0] op_sel_hi:[1,1]
    v_pk_mul_f32 v[176:177], v[134:135], v[176:177] op_sel:[1,0] op_sel_hi:[1,1]
    v_pk_mul_f32 v[178:179], v[134:135], v[178:179] op_sel:[1,0] op_sel_hi:[1,1]
    v_pk_mul_f32 v[180:181], v[134:135], v[180:181] op_sel:[1,0] op_sel_hi:[1,1]
    v_pk_mul_f32 v[182:183], v[134:135], v[182:183] op_sel:[1,0] op_sel_hi:[1,1]
    v_pk_fma_f32 v[184:185], v[136:137], v[148:149], v[184:185] op_sel_hi:[0,1,1] neg_lo:[1,0,0] neg_hi:[1,0,0]
    v_pk_fma_f32 v[186:187], v[136:137], v[150:151], v[186:187] op_sel_hi:[0,1,1] neg_lo:[1,0,0] neg_hi:[1,0,0]
    v_pk_fma_f32 v[188:189], v[136:137], v[152:153], v[188:189] op_sel_hi:[0,1,1] neg_lo:[1,0,0] neg_hi:[1,0,0]
    v_pk_fma_f32 v[190:191], v[136:137], v[154:155], v[190:191] op_sel_hi:[0,1,1] neg_lo:[1,0,0] neg_hi:[1,0,0]
    v_pk_fma_f32 v[192:193], v[136:137], v[156:157], v[192:193] op_sel_hi:[0,1,1] neg_lo:[1,0,0] neg_hi:[1,0,0]
    v_pk_fma_f32 v[194:195], v[136:137], v[158:159], v[194:195] op_sel_hi:[0,1,1] neg_lo:[1,0,0] neg_hi:[1,0,0]
    v_pk_mul_f32 v[184:185], v[136:137], v[184:185] op_sel:[1,0] op_sel_hi:[1,1]
    s_add_u32 m0, s73, 0
    v_pk_mul_f32 v[186:187], v[136:137], v[186:187] op_sel:[1,0] op_sel_hi:[1,1]
    buffer_load_dwordx4 v21, s[52:55], s85 offen offset:2048 sc1 lds
    s_nop 0
    v_pk_mul_f32 v[188:189], v[136:137], v[188:189] op_sel:[1,0] op_sel_hi:[1,1]
    v_pk_mul_f32 v[190:191], v[136:137], v[190:191] op_sel:[1,0] op_sel_hi:[1,1]
    v_pk_mul_f32 v[192:193], v[136:137], v[192:193] op_sel:[1,0] op_sel_hi:[1,1]
    v_pk_mul_f32 v[194:195], v[136:137], v[194:195] op_sel:[1,0] op_sel_hi:[1,1]
    v_pk_fma_f32 v[196:197], v[138:139], v[148:149], v[196:197] op_sel_hi:[0,1,1] neg_lo:[1,0,0] neg_hi:[1,0,0]
    v_pk_fma_f32 v[198:199], v[138:139], v[150:151], v[198:199] op_sel_hi:[0,1,1] neg_lo:[1,0,0] neg_hi:[1,0,0]
    v_pk_fma_f32 v[200:201], v[138:139], v[152:153], v[200:201] op_sel_hi:[0,1,1] neg_lo:[1,0,0] neg_hi:[1,0,0]
    v_pk_fma_f32 v[202:203], v[138:139], v[154:155], v[202:203] op_sel_hi:[0,1,1] neg_lo:[1,0,0] neg_hi:[1,0,0]
    v_pk_fma_f32 v[204:205], v[138:139], v[156:157], v[204:205] op_sel_hi:[0,1,1] neg_lo:[1,0,0] neg_hi:[1,0,0]
    v_pk_fma_f32 v[206:207], v[138:139], v[158:159], v[206:207] op_sel_hi:[0,1,1] neg_lo:[1,0,0] neg_hi:[1,0,0]
    v_pk_mul_f32 v[196:197], v[138:139], v[196:197] op_sel:[1,0] op_sel_hi:[1,1]
    v_pk_mul_f32 v[198:199], v[138:139], v[198:199] op_sel:[1,0] op_sel_hi:[1,1]
    v_pk_mul_f32 v[200:201], v[138:139], v[200:201] op_sel:[1,0] op_sel_hi:[1,1]
    v_pk_mul_f32 v[202:203], v[138:139], v[202:203] op_sel:[1,0] op_sel_hi:[1,1]
    v_pk_mul_f32 v[204:205], v[138:139], v[204:205] op_sel:[1,0] op_sel_hi:[1,1]
    s_add_u32 m0, s73, 0
    v_pk_mul_f32 v[206:207], v[138:139], v[206:207] op_sel:[1,0] op_sel_hi:[1,1]
    buffer_load_dwordx4 v21, s[52:55], s85 offen offset:3072 sc1 lds
    s_nop 0
    v_pk_fma_f32 v[208:209], v[140:141], v[148:149], v[208:209] op_sel_hi:[0,1,1] neg_lo:[1,0,0] neg_hi:[1,0,0]
    v_pk_fma_f32 v[210:211], v[140:141], v[150:151], v[210:211] op_sel_hi:[0,1,1] neg_lo:[1,0,0] neg_hi:[1,0,0]
    v_pk_fma_f32 v[212:213], v[140:141], v[152:153], v[212:213] op_sel_hi:[0,1,1] neg_lo:[1,0,0] neg_hi:[1,0,0]
    v_pk_fma_f32 v[214:215], v[140:141], v[154:155], v[214:215] op_sel_hi:[0,1,1] neg_lo:[1,0,0] neg_hi:[1,0,0]
    v_pk_fma_f32 v[216:217], v[140:141], v[156:157], v[216:217] op_sel_hi:[0,1,1] neg_lo:[1,0,0] neg_hi:[1,0,0]
    v_pk_fma_f32 v[218:219], v[140:141], v[158:159], v[218:219] op_sel_hi:[0,1,1] neg_lo:[1,0,0] neg_hi:[1,0,0]
    v_pk_mul_f32 v[208:209], v[140:141], v[208:209] op_sel:[1,0] op_sel_hi:[1,1]
    v_pk_mul_f32 v[210:211], v[140:141], v[210:211] op_sel:[1,0] op_sel_hi:[1,1]
    v_pk_mul_f32 v[212:213], v[140:141], v[212:213] op_sel:[1,0] op_sel_hi:[1,1]
    v_pk_mul_f32 v[214:215], v[140:141], v[214:215] op_sel:[1,0] op_sel_hi:[1,1]
    v_pk_mul_f32 v[216:217], v[140:141], v[216:217] op_sel:[1,0] op_sel_hi:[1,1]
    v_pk_mul_f32 v[218:219], v[140:141], v[218:219] op_sel:[1,0] op_sel_hi:[1,1]
    v_pk_fma_f32 v[220:221], v[142:143], v[148:149], v[220:221] op_sel_hi:[0,1,1] neg_lo:[1,0,0] neg_hi:[1,0,0]
    v_pk_fma_f32 v[222:223], v[142:143], v[150:151], v[222:223] op_sel_hi:[0,1,1] neg_lo:[1,0,0] neg_hi:[1,0,0]
    v_pk_fma_f32 v[224:225], v[142:143], v[152:153], v[224:225] op_sel_hi:[0,1,1] neg_lo:[1,0,0] neg_hi:[1,0,0]
    s_add_u32 m0, s73, 4096
    v_pk_fma_f32 v[226:227], v[142:143], v[154:155], v[226:227] op_sel_hi:[0,1,1] neg_lo:[1,0,0] neg_hi:[1,0,0]
    buffer_load_dwordx4 v22, s[52:55], s85 offen offset:0 sc1 lds
    v_pk_fma_f32 v[228:229], v[142:143], v[156:157], v[228:229] op_sel_hi:[0,1,1] neg_lo:[1,0,0] neg_hi:[1,0,0]
    v_pk_fma_f32 v[230:231], v[142:143], v[158:159], v[230:231] op_sel_hi:[0,1,1] neg_lo:[1,0,0] neg_hi:[1,0,0]
    v_pk_mul_f32 v[220:221], v[142:143], v[220:221] op_sel:[1,0] op_sel_hi:[1,1]
    v_pk_mul_f32 v[222:223], v[142:143], v[222:223] op_sel:[1,0] op_sel_hi:[1,1]
    v_pk_mul_f32 v[224:225], v[142:143], v[224:225] op_sel:[1,0] op_sel_hi:[1,1]
    v_pk_mul_f32 v[226:227], v[142:143], v[226:227] op_sel:[1,0] op_sel_hi:[1,1]
    v_pk_mul_f32 v[228:229], v[142:143], v[228:229] op_sel:[1,0] op_sel_hi:[1,1]
    v_pk_mul_f32 v[230:231], v[142:143], v[230:231] op_sel:[1,0] op_sel_hi:[1,1]
    v_pk_fma_f32 v[232:233], v[144:145], v[148:149], v[232:233] op_sel_hi:[0,1,1] neg_lo:[1,0,0] neg_hi:[1,0,0]
    v_pk_fma_f32 v[234:235], v[144:145], v[150:151], v[234:235] op_sel_hi:[0,1,1] neg_lo:[1,0,0] neg_hi:[1,0,0]
    v_pk_fma_f32 v[236:237], v[144:145], v[152:153], v[236:237] op_sel_hi:[0,1,1] neg_lo:[1,0,0] neg_hi:[1,0,0]
    v_pk_fma_f32 v[238:239], v[144:145], v[154:155], v[238:239] op_sel_hi:[0,1,1] neg_lo:[1,0,0] neg_hi:[1,0,0]
    v_pk_fma_f32 v[240:241], v[144:145], v[156:157], v[240:241] op_sel_hi:[0,1,1] neg_lo:[1,0,0] neg_hi:[1,0,0]
    v_pk_fma_f32 v[242:243], v[144:145], v[158:159], v[242:243] op_sel_hi:[0,1,1] neg_lo:[1,0,0] neg_hi:[1,0,0]
    v_pk_mul_f32 v[232:233], v[144:145], v[232:233] op_sel:[1,0] op_sel_hi:[1,1]
    s_add_u32 s85, s85, 5120
    v_pk_mul_f32 v[234:235], v[144:145], v[234:235] op_sel:[1,0] op_sel_hi:[1,1]
    v_pk_mul_f32 v[236:237], v[144:145], v[236:237] op_sel:[1,0] op_sel_hi:[1,1]
    v_pk_mul_f32 v[238:239], v[144:145], v[238:239] op_sel:[1,0] op_sel_hi:[1,1]
    v_pk_mul_f32 v[240:241], v[144:145], v[240:241] op_sel:[1,0] op_sel_hi:[1,1]
    v_pk_mul_f32 v[242:243], v[144:145], v[242:243] op_sel:[1,0] op_sel_hi:[1,1]
    v_pk_fma_f32 v[244:245], v[146:147], v[148:149], v[244:245] op_sel_hi:[0,1,1] neg_lo:[1,0,0] neg_hi:[1,0,0]
    v_pk_fma_f32 v[246:247], v[146:147], v[150:151], v[246:247] op_sel_hi:[0,1,1] neg_lo:[1,0,0] neg_hi:[1,0,0]
    v_pk_fma_f32 v[248:249], v[146:147], v[152:153], v[248:249] op_sel_hi:[0,1,1] neg_lo:[1,0,0] neg_hi:[1,0,0]
    v_pk_fma_f32 v[250:251], v[146:147], v[154:155], v[250:251] op_sel_hi:[0,1,1] neg_lo:[1,0,0] neg_hi:[1,0,0]
    v_pk_fma_f32 v[252:253], v[146:147], v[156:157], v[252:253] op_sel_hi:[0,1,1] neg_lo:[1,0,0] neg_hi:[1,0,0]
    v_pk_fma_f32 v[254:255], v[146:147], v[158:159], v[254:255] op_sel_hi:[0,1,1] neg_lo:[1,0,0] neg_hi:[1,0,0]
    v_pk_mul_f32 v[244:245], v[146:147], v[244:245] op_sel:[1,0] op_sel_hi:[1,1]
    v_pk_mul_f32 v[246:247], v[146:147], v[246:247] op_sel:[1,0] op_sel_hi:[1,1]
    v_pk_mul_f32 v[248:249], v[146:147], v[248:249] op_sel:[1,0] op_sel_hi:[1,1]
    v_pk_mul_f32 v[250:251], v[146:147], v[250:251] op_sel:[1,0] op_sel_hi:[1,1]
    s_add_u32 m0, s73, 5120
    v_pk_mul_f32 v[252:253], v[146:147], v[252:253] op_sel:[1,0] op_sel_hi:[1,1]
    buffer_load_dwordx4 v21, s[52:55], s85 offen offset:0 sc1 lds
    v_pk_mul_f32 v[254:255], v[146:147], v[254:255] op_sel:[1,0] op_sel_hi:[1,1]
    v_pk_fma_f32 v[148:149], v[48:49], v[160:161], v[172:173] op_sel_hi:[0,1,1]
    v_pk_fma_f32 v[150:151], v[50:51], v[162:163], v[174:175] op_sel_hi:[0,1,1]
    v_pk_fma_f32 v[152:153], v[52:53], v[164:165], v[176:177] op_sel_hi:[0,1,1]
    v_pk_fma_f32 v[154:155], v[54:55], v[166:167], v[178:179] op_sel_hi:[0,1,1]
    v_pk_fma_f32 v[156:157], v[56:57], v[168:169], v[180:181] op_sel_hi:[0,1,1]
    v_pk_fma_f32 v[158:159], v[58:59], v[170:171], v[182:183] op_sel_hi:[0,1,1]
    v_pk_fma_f32 v[148:149], v[48:49], v[160:161], v[148:149] op_sel:[1,1,0] op_sel_hi:[1,0,1] neg_lo:[1,0,0]
    v_pk_fma_f32 v[150:151], v[50:51], v[162:163], v[150:151] op_sel:[1,1,0] op_sel_hi:[1,0,1] neg_lo:[1,0,0]
    v_pk_fma_f32 v[152:153], v[52:53], v[164:165], v[152:153] op_sel:[1,1,0] op_sel_hi:[1,0,1] neg_lo:[1,0,0]
    v_pk_fma_f32 v[154:155], v[54:55], v[166:167], v[154:155] op_sel:[1,1,0] op_sel_hi:[1,0,1] neg_lo:[1,0,0]
    v_pk_fma_f32 v[156:157], v[56:57], v[168:169], v[156:157] op_sel:[1,1,0] op_sel_hi:[1,0,1] neg_lo:[1,0,0]
    v_pk_fma_f32 v[158:159], v[58:59], v[170:171], v[158:159] op_sel:[1,1,0] op_sel_hi:[1,0,1] neg_lo:[1,0,0]
    v_pk_fma_f32 v[32:33], v[48:49], v[148:149], v[184:185] op_sel_hi:[0,1,1]
    v_pk_fma_f32 v[34:35], v[50:51], v[150:151], v[186:187] op_sel_hi:[0,1,1]
    s_add_u32 m0, s73, 5120
    v_pk_fma_f32 v[36:37], v[52:53], v[152:153], v[188:189] op_sel_hi:[0,1,1]
    buffer_load_dwordx4 v21, s[52:55], s85 offen offset:1024 sc1 lds
    v_pk_fma_f32 v[38:39], v[54:55], v[154:155], v[190:191] op_sel_hi:[0,1,1]
    v_pk_fma_f32 v[40:41], v[56:57], v[156:157], v[192:193] op_sel_hi:[0,1,1]
    v_pk_fma_f32 v[42:43], v[58:59], v[158:159], v[194:195] op_sel_hi:[0,1,1]
    v_pk_fma_f32 v[32:33], v[48:49], v[148:149], v[32:33] op_sel:[1,1,0] op_sel_hi:[1,0,1] neg_lo:[1,0,0]
    v_pk_fma_f32 v[34:35], v[50:51], v[150:151], v[34:35] op_sel:[1,1,0] op_sel_hi:[1,0,1] neg_lo:[1,0,0]
    v_pk_fma_f32 v[36:37], v[52:53], v[152:153], v[36:37] op_sel:[1,1,0] op_sel_hi:[1,0,1] neg_lo:[1,0,0]
    v_pk_fma_f32 v[38:39], v[54:55], v[154:155], v[38:39] op_sel:[1,1,0] op_sel_hi:[1,0,1] neg_lo:[1,0,0]
    v_pk_fma_f32 v[40:41], v[56:57], v[156:157], v[40:41] op_sel:[1,1,0] op_sel_hi:[1,0,1] neg_lo:[1,0,0]
    v_pk_fma_f32 v[42:43], v[58:59], v[158:159], v[42:43] op_sel:[1,1,0] op_sel_hi:[1,0,1] neg_lo:[1,0,0]
    v_pk_fma_f32 v[148:149], v[48:49], v[32:33], v[196:197] op_sel_hi:[0,1,1]
    v_pk_fma_f32 v[150:151], v[50:51], v[34:35], v[198:199] op_sel_hi:[0,1,1]
    v_pk_fma_f32 v[152:153], v[52:53], v[36:37], v[200:201] op_sel_hi:[0,1,1]
    v_pk_fma_f32 v[154:155], v[54:55], v[38:39], v[202:203] op_sel_hi:[0,1,1]
    v_pk_fma_f32 v[156:157], v[56:57], v[40:41], v[204:205] op_sel_hi:[0,1,1]
    v_pk_fma_f32 v[158:159], v[58:59], v[42:43], v[206:207] op_sel_hi:[0,1,1]
    s_add_u32 m0, s73, 5120
    v_pk_fma_f32 v[148:149], v[48:49], v[32:33], v[148:149] op_sel:[1,1,0] op_sel_hi:[1,0,1] neg_lo:[1,0,0]
    buffer_load_dwordx4 v21, s[52:55], s85 offen offset:2048 sc1 lds
    v_pk_fma_f32 v[150:151], v[50:51], v[34:35], v[150:151] op_sel:[1,1,0] op_sel_hi:[1,0,1] neg_lo:[1,0,0]
    v_pk_fma_f32 v[152:153], v[52:53], v[36:37], v[152:153] op_sel:[1,1,0] op_sel_hi:[1,0,1] neg_lo:[1,0,0]
    v_pk_fma_f32 v[154:155], v[54:55], v[38:39], v[154:155] op_sel:[1,1,0] op_sel_hi:[1,0,1] neg_lo:[1,0,0]
    v_pk_fma_f32 v[156:157], v[56:57], v[40:41], v[156:157] op_sel:[1,1,0] op_sel_hi:[1,0,1] neg_lo:[1,0,0]
    v_pk_fma_f32 v[158:159], v[58:59], v[42:43], v[158:159] op_sel:[1,1,0] op_sel_hi:[1,0,1] neg_lo:[1,0,0]
    v_pk_fma_f32 v[32:33], v[48:49], v[148:149], v[208:209] op_sel_hi:[0,1,1]
    v_pk_fma_f32 v[34:35], v[50:51], v[150:151], v[210:211] op_sel_hi:[0,1,1]
    v_pk_fma_f32 v[36:37], v[52:53], v[152:153], v[212:213] op_sel_hi:[0,1,1]
    v_pk_fma_f32 v[38:39], v[54:55], v[154:155], v[214:215] op_sel_hi:[0,1,1]
    v_pk_fma_f32 v[40:41], v[56:57], v[156:157], v[216:217] op_sel_hi:[0,1,1]
    v_pk_fma_f32 v[42:43], v[58:59], v[158:159], v[218:219] op_sel_hi:[0,1,1]
    v_pk_fma_f32 v[32:33], v[48:49], v[148:149], v[32:33] op_sel:[1,1,0] op_sel_hi:[1,0,1] neg_lo:[1,0,0]
    v_pk_fma_f32 v[34:35], v[50:51], v[150:151], v[34:35] op_sel:[1,1,0] op_sel_hi:[1,0,1] neg_lo:[1,0,0]
    v_pk_fma_f32 v[36:37], v[52:53], v[152:153], v[36:37] op_sel:[1,1,0] op_sel_hi:[1,0,1] neg_lo:[1,0,0]
    s_add_u32 m0, s73, 5120
    v_pk_fma_f32 v[38:39], v[54:55], v[154:155], v[38:39] op_sel:[1,1,0] op_sel_hi:[1,0,1] neg_lo:[1,0,0]
    buffer_load_dwordx4 v21, s[52:55], s85 offen offset:3072 sc1 lds
    v_pk_fma_f32 v[40:41], v[56:57], v[156:157], v[40:41] op_sel:[1,1,0] op_sel_hi:[1,0,1] neg_lo:[1,0,0]
    v_pk_fma_f32 v[42:43], v[58:59], v[158:159], v[42:43] op_sel:[1,1,0] op_sel_hi:[1,0,1] neg_lo:[1,0,0]
    v_pk_fma_f32 v[148:149], v[48:49], v[32:33], v[220:221] op_sel_hi:[0,1,1]
    v_pk_fma_f32 v[150:151], v[50:51], v[34:35], v[222:223] op_sel_hi:[0,1,1]
    v_pk_fma_f32 v[152:153], v[52:53], v[36:37], v[224:225] op_sel_hi:[0,1,1]
    v_pk_fma_f32 v[154:155], v[54:55], v[38:39], v[226:227] op_sel_hi:[0,1,1]
    v_pk_fma_f32 v[156:157], v[56:57], v[40:41], v[228:229] op_sel_hi:[0,1,1]
    v_pk_fma_f32 v[158:159], v[58:59], v[42:43], v[230:231] op_sel_hi:[0,1,1]
    v_pk_fma_f32 v[148:149], v[48:49], v[32:33], v[148:149] op_sel:[1,1,0] op_sel_hi:[1,0,1] neg_lo:[1,0,0]
    v_pk_fma_f32 v[150:151], v[50:51], v[34:35], v[150:151] op_sel:[1,1,0] op_sel_hi:[1,0,1] neg_lo:[1,0,0]
    v_pk_fma_f32 v[152:153], v[52:53], v[36:37], v[152:153] op_sel:[1,1,0] op_sel_hi:[1,0,1] neg_lo:[1,0,0]
    v_pk_fma_f32 v[154:155], v[54:55], v[38:39], v[154:155] op_sel:[1,1,0] op_sel_hi:[1,0,1] neg_lo:[1,0,0]
    v_pk_fma_f32 v[156:157], v[56:57], v[40:41], v[156:157] op_sel:[1,1,0] op_sel_hi:[1,0,1] neg_lo:[1,0,0]
    v_pk_fma_f32 v[158:159], v[58:59], v[42:43], v[158:159] op_sel:[1,1,0] op_sel_hi:[1,0,1] neg_lo:[1,0,0]
    v_pk_fma_f32 v[32:33], v[48:49], v[148:149], v[232:233] op_sel_hi:[0,1,1]
    s_add_u32 m0, s73, 9216
    v_pk_fma_f32 v[34:35], v[50:51], v[150:151], v[234:235] op_sel_hi:[0,1,1]
    buffer_load_dwordx4 v22, s[52:55], s85 offen offset:0 sc1 lds
    v_pk_fma_f32 v[36:37], v[52:53], v[152:153], v[236:237] op_sel_hi:[0,1,1]
    v_pk_fma_f32 v[38:39], v[54:55], v[154:155], v[238:239] op_sel_hi:[0,1,1]
    v_pk_fma_f32 v[40:41], v[56:57], v[156:157], v[240:241] op_sel_hi:[0,1,1]
    v_pk_fma_f32 v[42:43], v[58:59], v[158:159], v[242:243] op_sel_hi:[0,1,1]
    v_pk_fma_f32 v[32:33], v[48:49], v[148:149], v[32:33] op_sel:[1,1,0] op_sel_hi:[1,0,1] neg_lo:[1,0,0]
    v_pk_fma_f32 v[34:35], v[50:51], v[150:151], v[34:35] op_sel:[1,1,0] op_sel_hi:[1,0,1] neg_lo:[1,0,0]
    v_pk_fma_f32 v[36:37], v[52:53], v[152:153], v[36:37] op_sel:[1,1,0] op_sel_hi:[1,0,1] neg_lo:[1,0,0]
    v_pk_fma_f32 v[38:39], v[54:55], v[154:155], v[38:39] op_sel:[1,1,0] op_sel_hi:[1,0,1] neg_lo:[1,0,0]
    v_pk_fma_f32 v[40:41], v[56:57], v[156:157], v[40:41] op_sel:[1,1,0] op_sel_hi:[1,0,1] neg_lo:[1,0,0]
    v_pk_fma_f32 v[42:43], v[58:59], v[158:159], v[42:43] op_sel:[1,1,0] op_sel_hi:[1,0,1] neg_lo:[1,0,0]
    v_pk_fma_f32 v[148:149], v[48:49], v[32:33], v[244:245] op_sel_hi:[0,1,1]
    v_pk_fma_f32 v[150:151], v[50:51], v[34:35], v[246:247] op_sel_hi:[0,1,1]
    v_pk_fma_f32 v[152:153], v[52:53], v[36:37], v[248:249] op_sel_hi:[0,1,1]
    v_pk_fma_f32 v[154:155], v[54:55], v[38:39], v[250:251] op_sel_hi:[0,1,1]
    v_pk_fma_f32 v[156:157], v[56:57], v[40:41], v[252:253] op_sel_hi:[0,1,1]
    v_pk_fma_f32 v[158:159], v[58:59], v[42:43], v[254:255] op_sel_hi:[0,1,1]
    s_add_u32 s85, s85, 5120
    v_pk_fma_f32 v[148:149], v[48:49], v[32:33], v[148:149] op_sel:[1,1,0] op_sel_hi:[1,0,1] neg_lo:[1,0,0]
    v_pk_fma_f32 v[150:151], v[50:51], v[34:35], v[150:151] op_sel:[1,1,0] op_sel_hi:[1,0,1] neg_lo:[1,0,0]
    v_pk_fma_f32 v[152:153], v[52:53], v[36:37], v[152:153] op_sel:[1,1,0] op_sel_hi:[1,0,1] neg_lo:[1,0,0]
    v_pk_fma_f32 v[154:155], v[54:55], v[38:39], v[154:155] op_sel:[1,1,0] op_sel_hi:[1,0,1] neg_lo:[1,0,0]
    v_pk_fma_f32 v[156:157], v[56:57], v[40:41], v[156:157] op_sel:[1,1,0] op_sel_hi:[1,0,1] neg_lo:[1,0,0]
    v_pk_fma_f32 v[158:159], v[58:59], v[42:43], v[158:159] op_sel:[1,1,0] op_sel_hi:[1,0,1] neg_lo:[1,0,0]
    v_mov_b32_dpp v32, v148 row_shr:1 row_mask:0xf bank_mask:0xf bound_ctrl:1
    v_mov_b32_dpp v33, v149 row_shr:1 row_mask:0xf bank_mask:0xf bound_ctrl:1
    v_mov_b32_dpp v34, v150 row_shr:1 row_mask:0xf bank_mask:0xf bound_ctrl:1
    v_mov_b32_dpp v35, v151 row_shr:1 row_mask:0xf bank_mask:0xf bound_ctrl:1
    v_mov_b32_dpp v36, v152 row_shr:1 row_mask:0xf bank_mask:0xf bound_ctrl:1
    v_mov_b32_dpp v37, v153 row_shr:1 row_mask:0xf bank_mask:0xf bound_ctrl:1
    v_mov_b32_dpp v38, v154 row_shr:1 row_mask:0xf bank_mask:0xf bound_ctrl:1
    v_mov_b32_dpp v39, v155 row_shr:1 row_mask:0xf bank_mask:0xf bound_ctrl:1
    v_mov_b32_dpp v40, v156 row_shr:1 row_mask:0xf bank_mask:0xf bound_ctrl:1
    s_add_u32 m0, s73, 10240
    v_mov_b32_dpp v41, v157 row_shr:1 row_mask:0xf bank_mask:0xf bound_ctrl:1
    buffer_load_dwordx4 v21, s[52:55], s85 offen offset:0 sc1 lds
    v_mov_b32_dpp v42, v158 row_shr:1 row_mask:0xf bank_mask:0xf bound_ctrl:1
    v_mov_b32_dpp v43, v159 row_shr:1 row_mask:0xf bank_mask:0xf bound_ctrl:1
    v_pk_fma_f32 v[148:149], v[60:61], v[32:33], v[148:149] op_sel_hi:[0,1,1]
    v_pk_fma_f32 v[150:151], v[62:63], v[34:35], v[150:151] op_sel_hi:[0,1,1]
    v_pk_fma_f32 v[152:153], v[64:65], v[36:37], v[152:153] op_sel_hi:[0,1,1]
    v_pk_fma_f32 v[154:155], v[66:67], v[38:39], v[154:155] op_sel_hi:[0,1,1]
    v_pk_fma_f32 v[156:157], v[68:69], v[40:41], v[156:157] op_sel_hi:[0,1,1]
    v_pk_fma_f32 v[158:159], v[70:71], v[42:43], v[158:159] op_sel_hi:[0,1,1]
    v_pk_fma_f32 v[148:149], v[60:61], v[32:33], v[148:149] op_sel:[1,1,0] op_sel_hi:[1,0,1] neg_lo:[1,0,0]
    v_pk_fma_f32 v[150:151], v[62:63], v[34:35], v[150:151] op_sel:[1,1,0] op_sel_hi:[1,0,1] neg_lo:[1,0,0]
    v_pk_fma_f32 v[152:153], v[64:65], v[36:37], v[152:153] op_sel:[1,1,0] op_sel_hi:[1,0,1] neg_lo:[1,0,0]
    v_pk_fma_f32 v[154:155], v[66:67], v[38:39], v[154:155] op_sel:[1,1,0] op_sel_hi:[1,0,1] neg_lo:[1,0,0]
    v_pk_fma_f32 v[156:157], v[68:69], v[40:41], v[156:157] op_sel:[1,1,0] op_sel_hi:[1,0,1] neg_lo:[1,0,0]
    v_pk_fma_f32 v[158:159], v[70:71], v[42:43], v[158:159] op_sel:[1,1,0] op_sel_hi:[1,0,1] neg_lo:[1,0,0]
    v_mov_b32_dpp v32, v148 row_shr:2 row_mask:0xf bank_mask:0xf bound_ctrl:1
    s_add_u32 m0, s73, 10240
    v_mov_b32_dpp v33, v149 row_shr:2 row_mask:0xf bank_mask:0xf bound_ctrl:1
    buffer_load_dwordx4 v21, s[52:55], s85 offen offset:1024 sc1 lds
    v_mov_b32_dpp v34, v150 row_shr:2 row_mask:0xf bank_mask:0xf bound_ctrl:1
    v_mov_b32_dpp v35, v151 row_shr:2 row_mask:0xf bank_mask:0xf bound_ctrl:1
    v_mov_b32_dpp v36, v152 row_shr:2 row_mask:0xf bank_mask:0xf bound_ctrl:1
    v_mov_b32_dpp v37, v153 row_shr:2 row_mask:0xf bank_mask:0xf bound_ctrl:1
    v_mov_b32_dpp v38, v154 row_shr:2 row_mask:0xf bank_mask:0xf bound_ctrl:1
    v_mov_b32_dpp v39, v155 row_shr:2 row_mask:0xf bank_mask:0xf bound_ctrl:1
    v_mov_b32_dpp v40, v156 row_shr:2 row_mask:0xf bank_mask:0xf bound_ctrl:1
    v_mov_b32_dpp v41, v157 row_shr:2 row_mask:0xf bank_mask:0xf bound_ctrl:1
    v_mov_b32_dpp v42, v158 row_shr:2 row_mask:0xf bank_mask:0xf bound_ctrl:1
    v_mov_b32_dpp v43, v159 row_shr:2 row_mask:0xf bank_mask:0xf bound_ctrl:1
    v_pk_fma_f32 v[148:149], v[72:73], v[32:33], v[148:149] op_sel_hi:[0,1,1]
    v_pk_fma_f32 v[150:151], v[74:75], v[34:35], v[150:151] op_sel_hi:[0,1,1]
    v_pk_fma_f32 v[152:153], v[76:77], v[36:37], v[152:153] op_sel_hi:[0,1,1]
    v_pk_fma_f32 v[154:155], v[78:79], v[38:39], v[154:155] op_sel_hi:[0,1,1]
    v_pk_fma_f32 v[156:157], v[80:81], v[40:41], v[156:157] op_sel_hi:[0,1,1]
    v_pk_fma_f32 v[158:159], v[82:83], v[42:43], v[158:159] op_sel_hi:[0,1,1]
    v_pk_fma_f32 v[148:149], v[72:73], v[32:33], v[148:149] op_sel:[1,1,0] op_sel_hi:[1,0,1] neg_lo:[1,0,0]
    v_pk_fma_f32 v[150:151], v[74:75], v[34:35], v[150:151] op_sel:[1,1,0] op_sel_hi:[1,0,1] neg_lo:[1,0,0]
    v_pk_fma_f32 v[152:153], v[76:77], v[36:37], v[152:153] op_sel:[1,1,0] op_sel_hi:[1,0,1] neg_lo:[1,0,0]
    v_pk_fma_f32 v[154:155], v[78:79], v[38:39], v[154:155] op_sel:[1,1,0] op_sel_hi:[1,0,1] neg_lo:[1,0,0]
    v_pk_fma_f32 v[156:157], v[80:81], v[40:41], v[156:157] op_sel:[1,1,0] op_sel_hi:[1,0,1] neg_lo:[1,0,0]
    v_pk_fma_f32 v[158:159], v[82:83], v[42:43], v[158:159] op_sel:[1,1,0] op_sel_hi:[1,0,1] neg_lo:[1,0,0]
    v_mov_b32_dpp v32, v148 row_shr:4 row_mask:0xf bank_mask:0xf bound_ctrl:1
    v_mov_b32_dpp v33, v149 row_shr:4 row_mask:0xf bank_mask:0xf bound_ctrl:1
    v_mov_b32_dpp v34, v150 row_shr:4 row_mask:0xf bank_mask:0xf bound_ctrl:1
    v_mov_b32_dpp v35, v151 row_shr:4 row_mask:0xf bank_mask:0xf bound_ctrl:1
    v_mov_b32_dpp v36, v152 row_shr:4 row_mask:0xf bank_mask:0xf bound_ctrl:1
    v_mov_b32_dpp v37, v153 row_shr:4 row_mask:0xf bank_mask:0xf bound_ctrl:1
    v_mov_b32_dpp v38, v154 row_shr:4 row_mask:0xf bank_mask:0xf bound_ctrl:1
    v_mov_b32_dpp v39, v155 row_shr:4 row_mask:0xf bank_mask:0xf bound_ctrl:1
    v_mov_b32_dpp v40, v156 row_shr:4 row_mask:0xf bank_mask:0xf bound_ctrl:1
    v_mov_b32_dpp v41, v157 row_shr:4 row_mask:0xf bank_mask:0xf bound_ctrl:1
    v_mov_b32_dpp v42, v158 row_shr:4 row_mask:0xf bank_mask:0xf bound_ctrl:1
    v_mov_b32_dpp v43, v159 row_shr:4 row_mask:0xf bank_mask:0xf bound_ctrl:1
    v_pk_fma_f32 v[148:149], v[84:85], v[32:33], v[148:149] op_sel_hi:[0,1,1]
    v_pk_fma_f32 v[150:151], v[86:87], v[34:35], v[150:151] op_sel_hi:[0,1,1]
    v_pk_fma_f32 v[152:153], v[88:89], v[36:37], v[152:153] op_sel_hi:[0,1,1]
    v_pk_fma_f32 v[154:155], v[90:91], v[38:39], v[154:155] op_sel_hi:[0,1,1]
    v_pk_fma_f32 v[156:157], v[92:93], v[40:41], v[156:157] op_sel_hi:[0,1,1]
    v_pk_fma_f32 v[158:159], v[94:95], v[42:43], v[158:159] op_sel_hi:[0,1,1]
    v_pk_fma_f32 v[148:149], v[84:85], v[32:33], v[148:149] op_sel:[1,1,0] op_sel_hi:[1,0,1] neg_lo:[1,0,0]
    v_pk_fma_f32 v[150:151], v[86:87], v[34:35], v[150:151] op_sel:[1,1,0] op_sel_hi:[1,0,1] neg_lo:[1,0,0]
    v_pk_fma_f32 v[152:153], v[88:89], v[36:37], v[152:153] op_sel:[1,1,0] op_sel_hi:[1,0,1] neg_lo:[1,0,0]
    v_pk_fma_f32 v[154:155], v[90:91], v[38:39], v[154:155] op_sel:[1,1,0] op_sel_hi:[1,0,1] neg_lo:[1,0,0]
    v_pk_fma_f32 v[156:157], v[92:93], v[40:41], v[156:157] op_sel:[1,1,0] op_sel_hi:[1,0,1] neg_lo:[1,0,0]
    v_pk_fma_f32 v[158:159], v[94:95], v[42:43], v[158:159] op_sel:[1,1,0] op_sel_hi:[1,0,1] neg_lo:[1,0,0]
    v_mov_b32_dpp v32, v148 row_shr:8 row_mask:0xf bank_mask:0xf bound_ctrl:1
    v_mov_b32_dpp v33, v149 row_shr:8 row_mask:0xf bank_mask:0xf bound_ctrl:1
    v_mov_b32_dpp v34, v150 row_shr:8 row_mask:0xf bank_mask:0xf bound_ctrl:1
    v_mov_b32_dpp v35, v151 row_shr:8 row_mask:0xf bank_mask:0xf bound_ctrl:1
    v_mov_b32_dpp v36, v152 row_shr:8 row_mask:0xf bank_mask:0xf bound_ctrl:1
    v_mov_b32_dpp v37, v153 row_shr:8 row_mask:0xf bank_mask:0xf bound_ctrl:1
    v_mov_b32_dpp v38, v154 row_shr:8 row_mask:0xf bank_mask:0xf bound_ctrl:1
    v_mov_b32_dpp v39, v155 row_shr:8 row_mask:0xf bank_mask:0xf bound_ctrl:1
    v_mov_b32_dpp v40, v156 row_shr:8 row_mask:0xf bank_mask:0xf bound_ctrl:1
    v_mov_b32_dpp v41, v157 row_shr:8 row_mask:0xf bank_mask:0xf bound_ctrl:1
    v_mov_b32_dpp v42, v158 row_shr:8 row_mask:0xf bank_mask:0xf bound_ctrl:1
    v_mov_b32_dpp v43, v159 row_shr:8 row_mask:0xf bank_mask:0xf bound_ctrl:1
    v_pk_fma_f32 v[148:149], v[96:97], v[32:33], v[148:149] op_sel_hi:[0,1,1]
    v_pk_fma_f32 v[150:151], v[98:99], v[34:35], v[150:151] op_sel_hi:[0,1,1]
    v_pk_fma_f32 v[152:153], v[100:101], v[36:37], v[152:153] op_sel_hi:[0,1,1]
    v_pk_fma_f32 v[154:155], v[102:103], v[38:39], v[154:155] op_sel_hi:[0,1,1]
    v_pk_fma_f32 v[156:157], v[104:105], v[40:41], v[156:157] op_sel_hi:[0,1,1]
    v_pk_fma_f32 v[158:159], v[106:107], v[42:43], v[158:159] op_sel_hi:[0,1,1]
    v_pk_fma_f32 v[148:149], v[96:97], v[32:33], v[148:149] op_sel:[1,1,0] op_sel_hi:[1,0,1] neg_lo:[1,0,0]
    v_pk_fma_f32 v[150:151], v[98:99], v[34:35], v[150:151] op_sel:[1,1,0] op_sel_hi:[1,0,1] neg_lo:[1,0,0]
    v_pk_fma_f32 v[152:153], v[100:101], v[36:37], v[152:153] op_sel:[1,1,0] op_sel_hi:[1,0,1] neg_lo:[1,0,0]
    v_pk_fma_f32 v[154:155], v[102:103], v[38:39], v[154:155] op_sel:[1,1,0] op_sel_hi:[1,0,1] neg_lo:[1,0,0]
    v_pk_fma_f32 v[156:157], v[104:105], v[40:41], v[156:157] op_sel:[1,1,0] op_sel_hi:[1,0,1] neg_lo:[1,0,0]
    v_pk_fma_f32 v[158:159], v[106:107], v[42:43], v[158:159] op_sel:[1,1,0] op_sel_hi:[1,0,1] neg_lo:[1,0,0]
    buffer_store_dwordx4 v[148:151], v26, s[52:55], 0 offen offset:0 sc1
    buffer_store_dwordx4 v[152:155], v26, s[52:55], 0 offen offset:64 sc1
    buffer_store_dwordx4 v[156:159], v26, s[52:55], 0 offen offset:128 sc1
    s_waitcnt vmcnt(25)
    s_add_u32 m0, s73, 10240
    v_mov_b32_dpp v84, v148 row_shr:1 row_mask:0xf bank_mask:0xf bound_ctrl:1
    ds_read_b128 a[60:63], v19 offset:20480
    buffer_load_dwordx4 v21, s[52:55], s85 offen offset:2048 sc1 lds
    v_mov_b32_dpp v85, v149 row_shr:1 row_mask:0xf bank_mask:0xf bound_ctrl:1
    ds_read_b128 a[64:67], v19 offset:22528
    v_mov_b32_dpp v86, v150 row_shr:1 row_mask:0xf bank_mask:0xf bound_ctrl:1
    v_mov_b32_dpp v87, v151 row_shr:1 row_mask:0xf bank_mask:0xf bound_ctrl:1
    ds_read_b128 a[68:71], v19 offset:24576
    v_mov_b32_dpp v88, v152 row_shr:1 row_mask:0xf bank_mask:0xf bound_ctrl:1
    ds_read_b128 a[72:75], v19 offset:26624
    v_mov_b32_dpp v89, v153 row_shr:1 row_mask:0xf bank_mask:0xf bound_ctrl:1
    v_mov_b32_dpp v90, v154 row_shr:1 row_mask:0xf bank_mask:0xf bound_ctrl:1
    ds_read_b128 a[76:79], v19 offset:28672
    v_mov_b32_dpp v91, v155 row_shr:1 row_mask:0xf bank_mask:0xf bound_ctrl:1
    ds_read_b128 a[80:83], v20 offset:20480
    v_mov_b32_dpp v92, v156 row_shr:1 row_mask:0xf bank_mask:0xf bound_ctrl:1
    v_mov_b32_dpp v93, v157 row_shr:1 row_mask:0xf bank_mask:0xf bound_ctrl:1
    ds_read_b128 a[84:87], v20 offset:22528
    v_mov_b32_dpp v94, v158 row_shr:1 row_mask:0xf bank_mask:0xf bound_ctrl:1
    ds_read_b128 a[88:91], v20 offset:24576
    v_mov_b32_dpp v95, v159 row_shr:1 row_mask:0xf bank_mask:0xf bound_ctrl:1
    s_add_u32 m0, s73, 10240
    v_pk_mul_f32 v[32:33], v[108:109], v[84:85] op_sel_hi:[0,1]
    ds_read_b128 a[92:95], v20 offset:26624
    buffer_load_dwordx4 v21, s[52:55], s85 offen offset:3072 sc1 lds
    v_pk_mul_f32 v[34:35], v[110:111], v[86:87] op_sel_hi:[0,1]
    ds_read_b128 a[96:99], v20 offset:28672
    s_nop 0
    v_pk_mul_f32 v[36:37], v[112:113], v[88:89] op_sel_hi:[0,1]
    v_pk_mul_f32 v[38:39], v[114:115], v[90:91] op_sel_hi:[0,1]
    v_pk_mul_f32 v[40:41], v[116:117], v[92:93] op_sel_hi:[0,1]
    v_pk_mul_f32 v[42:43], v[118:119], v[94:95] op_sel_hi:[0,1]
    v_pk_fma_f32 v[32:33], v[108:109], v[84:85], v[32:33] op_sel:[1,1,0] op_sel_hi:[1,0,1] neg_lo:[1,0,0]
    v_pk_fma_f32 v[34:35], v[110:111], v[86:87], v[34:35] op_sel:[1,1,0] op_sel_hi:[1,0,1] neg_lo:[1,0,0]
    v_pk_fma_f32 v[36:37], v[112:113], v[88:89], v[36:37] op_sel:[1,1,0] op_sel_hi:[1,0,1] neg_lo:[1,0,0]
    v_pk_fma_f32 v[38:39], v[114:115], v[90:91], v[38:39] op_sel:[1,1,0] op_sel_hi:[1,0,1] neg_lo:[1,0,0]
    v_pk_fma_f32 v[40:41], v[116:117], v[92:93], v[40:41] op_sel:[1,1,0] op_sel_hi:[1,0,1] neg_lo:[1,0,0]
    v_pk_fma_f32 v[42:43], v[118:119], v[94:95], v[42:43] op_sel:[1,1,0] op_sel_hi:[1,0,1] neg_lo:[1,0,0]
    s_add_u32 m0, s73, 14336
    v_lshlrev_b32_e64 v144, 3, v1
    buffer_load_dwordx4 v22, s[52:55], s85 offen offset:0 sc1 lds
    v_cvt_f32_u32 v144, v144
    s_sub_u32 s3, s65, 1
    v_sub_u32 v146, s3, v1
    v_max_i32 v146, 0, v146
    v_lshlrev_b32 v146, 7, v146
    v_cvt_f32_u32 v146, v146
    v_pk_mul_f32 v[84:85], v[120:121], v[144:145] op_sel_hi:[1,0]
    v_pk_mul_f32 v[86:87], v[122:123], v[144:145] op_sel_hi:[1,0]
    v_pk_mul_f32 v[88:89], v[124:125], v[144:145] op_sel_hi:[1,0]
    v_pk_mul_f32 v[90:91], v[126:127], v[144:145] op_sel_hi:[1,0]
    v_pk_mul_f32 v[92:93], v[128:129], v[144:145] op_sel_hi:[1,0]
    v_pk_mul_f32 v[94:95], v[130:131], v[144:145] op_sel_hi:[1,0]
    v_exp_f32 v84, v84
    v_exp_f32 v86, v86
    s_add_u32 s85, s85, 5120
    v_exp_f32 v88, v88
    v_exp_f32 v90, v90
    v_exp_f32 v92, v92
    v_exp_f32 v94, v94
    v_fract_f32 v85, v85
    v_fract_f32 v87, v87
    v_fract_f32 v89, v89
    v_fract_f32 v91, v91
    v_fract_f32 v93, v93
    v_fract_f32 v95, v95
    v_cos_f32_e64 v96, v85
    s_add_u32 m0, s73, 15360
    v_cos_f32_e64 v98, v87
    buffer_load_dwordx4 v21, s[52:55], s85 offen offset:0 sc1 lds
    v_cos_f32 v100, v89
    v_cos_f32 v102, v91
    v_cos_f32 v104, v93
    v_cos_f32 v106, v95
    v_sin_f32 v97, v85
    v_sin_f32 v99, v87
    v_sin_f32 v101, v89
    v_sin_f32 v103, v91
    v_sin_f32 v105, v93
    v_sin_f32 v107, v95
    v_pk_mul_f32 v[96:97], v[96:97], v[84:85] op_sel_hi:[1,0]
    v_pk_mul_f32 v[98:99], v[98:99], v[86:87] op_sel_hi:[1,0]
    s_add_u32 m0, s73, 15360
    v_pk_mul_f32 v[100:101], v[100:101], v[88:89] op_sel_hi:[1,0]
    buffer_load_dwordx4 v21, s[52:55], s85 offen offset:1024 sc1 lds
    v_pk_mul_f32 v[102:103], v[102:103], v[90:91] op_sel_hi:[1,0]
    v_pk_mul_f32 v[104:105], v[104:105], v[92:93] op_sel_hi:[1,0]
    v_pk_mul_f32 v[106:107], v[106:107], v[94:95] op_sel_hi:[1,0]
    v_pk_mul_f32 v[60:61], v[108:109], v[96:97] op_sel_hi:[0,1]
    v_pk_mul_f32 v[62:63], v[110:111], v[98:99] op_sel_hi:[0,1]
    v_pk_mul_f32 v[64:65], v[112:113], v[100:101] op_sel_hi:[0,1]
    v_pk_mul_f32 v[66:67], v[114:115], v[102:103] op_sel_hi:[0,1]
    v_pk_mul_f32 v[68:69], v[116:117], v[104:105] op_sel_hi:[0,1]
    v_pk_mul_f32 v[70:71], v[118:119], v[106:107] op_sel_hi:[0,1]
    v_pk_fma_f32 v[60:61], v[108:109], v[96:97], v[60:61] op_sel:[1,1,0] op_sel_hi:[1,0,1] neg_lo:[1,0,0]
    v_pk_fma_f32 v[62:63], v[110:111], v[98:99], v[62:63] op_sel:[1,1,0] op_sel_hi:[1,0,1] neg_lo:[1,0,0]
    s_add_u32 m0, s73, 15360
    v_pk_fma_f32 v[64:65], v[112:113], v[100:101], v[64:65] op_sel:[1,1,0] op_sel_hi:[1,0,1] neg_lo:[1,0,0]
    buffer_load_dwordx4 v21, s[52:55], s85 offen offset:2048 sc1 lds
    v_pk_fma_f32 v[66:67], v[114:115], v[102:103], v[66:67] op_sel:[1,1,0] op_sel_hi:[1,0,1] neg_lo:[1,0,0]
    v_pk_fma_f32 v[68:69], v[116:117], v[104:105], v[68:69] op_sel:[1,1,0] op_sel_hi:[1,0,1] neg_lo:[1,0,0]
    v_pk_fma_f32 v[70:71], v[118:119], v[106:107], v[70:71] op_sel:[1,1,0] op_sel_hi:[1,0,1] neg_lo:[1,0,0]
    v_pk_mul_f32 v[84:85], v[120:121], v[146:147] op_sel_hi:[1,0]
    v_pk_mul_f32 v[86:87], v[122:123], v[146:147] op_sel_hi:[1,0]
    v_pk_mul_f32 v[88:89], v[124:125], v[146:147] op_sel_hi:[1,0]
    v_pk_mul_f32 v[90:91], v[126:127], v[146:147] op_sel_hi:[1,0]
    v_pk_mul_f32 v[92:93], v[128:129], v[146:147] op_sel_hi:[1,0]
    v_pk_mul_f32 v[94:95], v[130:131], v[146:147] op_sel_hi:[1,0]
    v_exp_f32 v84, v84
    v_exp_f32 v86, v86
    s_add_u32 m0, s73, 15360
    v_exp_f32_e64 v88, v88
    buffer_load_dwordx4 v21, s[52:55], s85 offen offset:3072 sc1 lds
    v_exp_f32 v90, v90
    v_exp_f32 v92, v92
    v_exp_f32 v94, v94
    v_fract_f32 v85, v85
    v_fract_f32 v87, v87
    v_fract_f32 v89, v89
    v_fract_f32 v91, v91
    v_fract_f32 v93, v93
    v_fract_f32 v95, v95
    v_cos_f32 v72, v85
    v_cos_f32 v74, v87
    v_cos_f32 v76, v89
    s_add_u32 m0, s73, 19456
    v_cos_f32_e64 v78, v91
    buffer_load_dwordx4 v22, s[52:55], s85 offen offset:0 sc1 lds
    v_cos_f32 v80, v93
    v_cos_f32 v82, v95
    v_sin_f32 v73, v85
    v_sin_f32 v75, v87
    v_sin_f32 v77, v89
    v_sin_f32 v79, v91
    v_sin_f32 v81, v93
    v_sin_f32 v83, v95
    v_pk_mul_f32 v[72:73], v[72:73], v[84:85] op_sel_hi:[1,0]
    v_pk_mul_f32 v[74:75], v[74:75], v[86:87] op_sel_hi:[1,0]
    v_pk_mul_f32 v[76:77], v[76:77], v[88:89] op_sel_hi:[1,0]
    v_pk_mul_f32 v[78:79], v[78:79], v[90:91] op_sel_hi:[1,0]
    s_add_u32 s85, s85, 5120
    v_pk_mul_f32 v[80:81], v[80:81], v[92:93] op_sel_hi:[1,0]
    v_pk_mul_f32 v[82:83], v[82:83], v[94:95] op_sel_hi:[1,0]
    v_pk_mul_f32 v[84:85], v[108:109], v[160:161] op_sel_hi:[0,1]
    v_pk_mul_f32 v[86:87], v[110:111], v[162:163] op_sel_hi:[0,1]
    v_pk_mul_f32 v[88:89], v[112:113], v[164:165] op_sel_hi:[0,1]
    v_pk_mul_f32 v[90:91], v[114:115], v[166:167] op_sel_hi:[0,1]
    v_pk_mul_f32 v[92:93], v[116:117], v[168:169] op_sel_hi:[0,1]
    v_pk_mul_f32 v[94:95], v[118:119], v[170:171] op_sel_hi:[0,1]
    v_pk_fma_f32 v[160:161], v[108:109], v[160:161], v[84:85] op_sel:[1,1,0] op_sel_hi:[1,0,1] neg_lo:[1,0,0]
    v_pk_fma_f32 v[162:163], v[110:111], v[162:163], v[86:87] op_sel:[1,1,0] op_sel_hi:[1,0,1] neg_lo:[1,0,0]
    v_pk_fma_f32 v[164:165], v[112:113], v[164:165], v[88:89] op_sel:[1,1,0] op_sel_hi:[1,0,1] neg_lo:[1,0,0]
    v_pk_fma_f32 v[166:167], v[114:115], v[166:167], v[90:91] op_sel:[1,1,0] op_sel_hi:[1,0,1] neg_lo:[1,0,0]
    v_pk_fma_f32 v[168:169], v[116:117], v[168:169], v[92:93] op_sel:[1,1,0] op_sel_hi:[1,0,1] neg_lo:[1,0,0]
    v_pk_fma_f32 v[170:171], v[118:119], v[170:171], v[94:95] op_sel:[1,1,0] op_sel_hi:[1,0,1] neg_lo:[1,0,0]
    v_pk_mul_f32 v[84:85], v[108:109], v[172:173] op_sel_hi:[0,1]
    v_pk_mul_f32 v[86:87], v[110:111], v[174:175] op_sel_hi:[0,1]
    v_pk_mul_f32 v[88:89], v[112:113], v[176:177] op_sel_hi:[0,1]
    v_pk_mul_f32 v[90:91], v[114:115], v[178:179] op_sel_hi:[0,1]
    v_pk_mul_f32 v[92:93], v[116:117], v[180:181] op_sel_hi:[0,1]
    v_pk_mul_f32 v[94:95], v[118:119], v[182:183] op_sel_hi:[0,1]
    v_pk_fma_f32 v[172:173], v[108:109], v[172:173], v[84:85] op_sel:[1,1,0] op_sel_hi:[1,0,1] neg_lo:[1,0,0]
    v_pk_fma_f32 v[174:175], v[110:111], v[174:175], v[86:87] op_sel:[1,1,0] op_sel_hi:[1,0,1] neg_lo:[1,0,0]
    v_pk_fma_f32 v[176:177], v[112:113], v[176:177], v[88:89] op_sel:[1,1,0] op_sel_hi:[1,0,1] neg_lo:[1,0,0]
    v_pk_fma_f32 v[178:179], v[114:115], v[178:179], v[90:91] op_sel:[1,1,0] op_sel_hi:[1,0,1] neg_lo:[1,0,0]
    v_pk_fma_f32 v[180:181], v[116:117], v[180:181], v[92:93] op_sel:[1,1,0] op_sel_hi:[1,0,1] neg_lo:[1,0,0]
    v_pk_fma_f32 v[182:183], v[118:119], v[182:183], v[94:95] op_sel:[1,1,0] op_sel_hi:[1,0,1] neg_lo:[1,0,0]
    v_pk_mul_f32 v[84:85], v[108:109], v[184:185] op_sel_hi:[0,1]
    v_pk_mul_f32 v[86:87], v[110:111], v[186:187] op_sel_hi:[0,1]
    v_pk_mul_f32 v[88:89], v[112:113], v[188:189] op_sel_hi:[0,1]
    v_pk_mul_f32 v[90:91], v[114:115], v[190:191] op_sel_hi:[0,1]
    v_pk_mul_f32 v[92:93], v[116:117], v[192:193] op_sel_hi:[0,1]
    v_pk_mul_f32 v[94:95], v[118:119], v[194:195] op_sel_hi:[0,1]
    v_pk_fma_f32 v[184:185], v[108:109], v[184:185], v[84:85] op_sel:[1,1,0] op_sel_hi:[1,0,1] neg_lo:[1,0,0]
    v_pk_fma_f32 v[186:187], v[110:111], v[186:187], v[86:87] op_sel:[1,1,0] op_sel_hi:[1,0,1] neg_lo:[1,0,0]
    v_pk_fma_f32 v[188:189], v[112:113], v[188:189], v[88:89] op_sel:[1,1,0] op_sel_hi:[1,0,1] neg_lo:[1,0,0]
    v_pk_fma_f32 v[190:191], v[114:115], v[190:191], v[90:91] op_sel:[1,1,0] op_sel_hi:[1,0,1] neg_lo:[1,0,0]
    v_pk_fma_f32 v[192:193], v[116:117], v[192:193], v[92:93] op_sel:[1,1,0] op_sel_hi:[1,0,1] neg_lo:[1,0,0]
    v_pk_fma_f32 v[194:195], v[118:119], v[194:195], v[94:95] op_sel:[1,1,0] op_sel_hi:[1,0,1] neg_lo:[1,0,0]
    v_pk_mul_f32 v[84:85], v[108:109], v[196:197] op_sel_hi:[0,1]
    v_pk_mul_f32 v[86:87], v[110:111], v[198:199] op_sel_hi:[0,1]
    v_pk_mul_f32 v[88:89], v[112:113], v[200:201] op_sel_hi:[0,1]
    v_pk_mul_f32 v[90:91], v[114:115], v[202:203] op_sel_hi:[0,1]
    v_pk_mul_f32 v[92:93], v[116:117], v[204:205] op_sel_hi:[0,1]
    buffer_load_dwordx4 v[132:135], v27, s[52:55], 0 offen offset:0 sc1
    buffer_load_dwordx4 v[136:139], v27, s[52:55], 0 offen offset:64 sc1
    buffer_load_dwordx4 v[140:143], v27, s[52:55], 0 offen offset:128 sc1
    v_pk_mul_f32 v[94:95], v[118:119], v[206:207] op_sel_hi:[0,1]
    v_pk_fma_f32 v[196:197], v[108:109], v[196:197], v[84:85] op_sel:[1,1,0] op_sel_hi:[1,0,1] neg_lo:[1,0,0]
    v_pk_fma_f32 v[198:199], v[110:111], v[198:199], v[86:87] op_sel:[1,1,0] op_sel_hi:[1,0,1] neg_lo:[1,0,0]
    v_pk_fma_f32 v[200:201], v[112:113], v[200:201], v[88:89] op_sel:[1,1,0] op_sel_hi:[1,0,1] neg_lo:[1,0,0]
    v_pk_fma_f32 v[202:203], v[114:115], v[202:203], v[90:91] op_sel:[1,1,0] op_sel_hi:[1,0,1] neg_lo:[1,0,0]
    v_pk_fma_f32 v[204:205], v[116:117], v[204:205], v[92:93] op_sel:[1,1,0] op_sel_hi:[1,0,1] neg_lo:[1,0,0]
    v_pk_fma_f32 v[206:207], v[118:119], v[206:207], v[94:95] op_sel:[1,1,0] op_sel_hi:[1,0,1] neg_lo:[1,0,0]
    v_pk_mul_f32 v[84:85], v[108:109], v[208:209] op_sel_hi:[0,1]
    v_pk_mul_f32 v[86:87], v[110:111], v[210:211] op_sel_hi:[0,1]
    v_pk_mul_f32 v[88:89], v[112:113], v[212:213] op_sel_hi:[0,1]
    v_pk_mul_f32 v[90:91], v[114:115], v[214:215] op_sel_hi:[0,1]
    v_pk_mul_f32 v[92:93], v[116:117], v[216:217] op_sel_hi:[0,1]
    v_pk_mul_f32 v[94:95], v[118:119], v[218:219] op_sel_hi:[0,1]
    v_pk_fma_f32 v[208:209], v[108:109], v[208:209], v[84:85] op_sel:[1,1,0] op_sel_hi:[1,0,1] neg_lo:[1,0,0]
    v_pk_fma_f32 v[210:211], v[110:111], v[210:211], v[86:87] op_sel:[1,1,0] op_sel_hi:[1,0,1] neg_lo:[1,0,0]
    v_pk_fma_f32 v[212:213], v[112:113], v[212:213], v[88:89] op_sel:[1,1,0] op_sel_hi:[1,0,1] neg_lo:[1,0,0]
    v_pk_fma_f32 v[214:215], v[114:115], v[214:215], v[90:91] op_sel:[1,1,0] op_sel_hi:[1,0,1] neg_lo:[1,0,0]
    v_pk_fma_f32 v[216:217], v[116:117], v[216:217], v[92:93] op_sel:[1,1,0] op_sel_hi:[1,0,1] neg_lo:[1,0,0]
    v_pk_fma_f32 v[218:219], v[118:119], v[218:219], v[94:95] op_sel:[1,1,0] op_sel_hi:[1,0,1] neg_lo:[1,0,0]
    v_pk_mul_f32 v[84:85], v[108:109], v[220:221] op_sel_hi:[0,1]
    v_pk_mul_f32 v[86:87], v[110:111], v[222:223] op_sel_hi:[0,1]
    v_pk_mul_f32 v[88:89], v[112:113], v[224:225] op_sel_hi:[0,1]
    v_pk_mul_f32 v[90:91], v[114:115], v[226:227] op_sel_hi:[0,1]
    v_pk_mul_f32 v[92:93], v[116:117], v[228:229] op_sel_hi:[0,1]
    v_pk_mul_f32 v[94:95], v[118:119], v[230:231] op_sel_hi:[0,1]
    v_pk_fma_f32 v[220:221], v[108:109], v[220:221], v[84:85] op_sel:[1,1,0] op_sel_hi:[1,0,1] neg_lo:[1,0,0]
    v_pk_fma_f32 v[222:223], v[110:111], v[222:223], v[86:87] op_sel:[1,1,0] op_sel_hi:[1,0,1] neg_lo:[1,0,0]
    v_pk_fma_f32 v[224:225], v[112:113], v[224:225], v[88:89] op_sel:[1,1,0] op_sel_hi:[1,0,1] neg_lo:[1,0,0]
    v_pk_fma_f32 v[226:227], v[114:115], v[226:227], v[90:91] op_sel:[1,1,0] op_sel_hi:[1,0,1] neg_lo:[1,0,0]
    v_pk_fma_f32 v[228:229], v[116:117], v[228:229], v[92:93] op_sel:[1,1,0] op_sel_hi:[1,0,1] neg_lo:[1,0,0]
    v_pk_fma_f32 v[230:231], v[118:119], v[230:231], v[94:95] op_sel:[1,1,0] op_sel_hi:[1,0,1] neg_lo:[1,0,0]
    v_pk_mul_f32 v[84:85], v[108:109], v[232:233] op_sel_hi:[0,1]
    v_pk_mul_f32 v[86:87], v[110:111], v[234:235] op_sel_hi:[0,1]
    v_pk_mul_f32 v[88:89], v[112:113], v[236:237] op_sel_hi:[0,1]
    v_pk_mul_f32 v[90:91], v[114:115], v[238:239] op_sel_hi:[0,1]
    v_pk_mul_f32 v[92:93], v[116:117], v[240:241] op_sel_hi:[0,1]
    v_pk_mul_f32 v[94:95], v[118:119], v[242:243] op_sel_hi:[0,1]
    v_pk_fma_f32 v[232:233], v[108:109], v[232:233], v[84:85] op_sel:[1,1,0] op_sel_hi:[1,0,1] neg_lo:[1,0,0]
    v_pk_fma_f32 v[234:235], v[110:111], v[234:235], v[86:87] op_sel:[1,1,0] op_sel_hi:[1,0,1] neg_lo:[1,0,0]
    v_pk_fma_f32 v[236:237], v[112:113], v[236:237], v[88:89] op_sel:[1,1,0] op_sel_hi:[1,0,1] neg_lo:[1,0,0]
    v_pk_fma_f32 v[238:239], v[114:115], v[238:239], v[90:91] op_sel:[1,1,0] op_sel_hi:[1,0,1] neg_lo:[1,0,0]
    v_pk_fma_f32 v[240:241], v[116:117], v[240:241], v[92:93] op_sel:[1,1,0] op_sel_hi:[1,0,1] neg_lo:[1,0,0]
    v_pk_fma_f32 v[242:243], v[118:119], v[242:243], v[94:95] op_sel:[1,1,0] op_sel_hi:[1,0,1] neg_lo:[1,0,0]
    v_pk_mul_f32 v[84:85], v[108:109], v[244:245] op_sel_hi:[0,1]
    v_pk_mul_f32 v[86:87], v[110:111], v[246:247] op_sel_hi:[0,1]
    v_pk_mul_f32 v[88:89], v[112:113], v[248:249] op_sel_hi:[0,1]
    v_pk_mul_f32 v[90:91], v[114:115], v[250:251] op_sel_hi:[0,1]
    v_pk_mul_f32 v[92:93], v[116:117], v[252:253] op_sel_hi:[0,1]
    v_pk_mul_f32 v[94:95], v[118:119], v[254:255] op_sel_hi:[0,1]
    v_pk_fma_f32 v[244:245], v[108:109], v[244:245], v[84:85] op_sel:[1,1,0] op_sel_hi:[1,0,1] neg_lo:[1,0,0]
    v_pk_fma_f32 v[246:247], v[110:111], v[246:247], v[86:87] op_sel:[1,1,0] op_sel_hi:[1,0,1] neg_lo:[1,0,0]
    v_pk_fma_f32 v[248:249], v[112:113], v[248:249], v[88:89] op_sel:[1,1,0] op_sel_hi:[1,0,1] neg_lo:[1,0,0]
    v_pk_fma_f32 v[250:251], v[114:115], v[250:251], v[90:91] op_sel:[1,1,0] op_sel_hi:[1,0,1] neg_lo:[1,0,0]
    v_pk_fma_f32 v[252:253], v[116:117], v[252:253], v[92:93] op_sel:[1,1,0] op_sel_hi:[1,0,1] neg_lo:[1,0,0]
    v_pk_fma_f32 v[254:255], v[118:119], v[254:255], v[94:95] op_sel:[1,1,0] op_sel_hi:[1,0,1] neg_lo:[1,0,0]
    v_accvgpr_read_b32 v3, a108
    v_accvgpr_read_b32 v4, a109
    v_accvgpr_read_b32 v13, a110
    v_accvgpr_read_b32 v5, a111
    v_accvgpr_read_b32 v148, a112
    v_accvgpr_read_b32 v149, a113
    v_accvgpr_read_b32 v150, a114
    v_accvgpr_read_b32 v151, a115
    v_accvgpr_read_b32 v6, a116
    v_accvgpr_read_b32 v152, a117
    v_add_u32 v12, 4096, v3
    s_cmp_eq_u32 s64, 3
    s_cselect_b32 s3, 134217728, 0
    v_add_u32_e64 v7, s3, v12
    s_waitcnt lgkmcnt(0)
    s_add_u32 m0, s73, 25600
    s_nop 0
    buffer_load_dwordx4 v148, s[40:43], s5 offen lds
    s_add_u32 m0, s73, 26624
    s_nop 0
    buffer_load_dwordx4 v149, s[40:43], s5 offen lds
    s_add_u32 m0, s73, 27648
    s_nop 0
    buffer_load_dwordx4 v150, s[40:43], s5 offen lds
    s_waitcnt vmcnt(3)
    v_max3_u32 v84, v132, v133, v134
    v_max3_u32 v85, v135, v136, v137
    v_max3_u32 v86, v138, v139, v140
    v_max3_u32 v87, v141, v142, v143
    v_max3_u32 v84, v84, v85, v86
    v_max_u32 v84, v84, v87
    v_cmp_eq_u32 vcc, -1, v84
    s_cbranch_vccz L_aggd
    s_mov_b32 s3, 0
L_aggl:
    buffer_load_dwordx4 v[132:135], v27, s[52:55], 0 offen offset:0 sc1
    buffer_load_dwordx4 v[136:139], v27, s[52:55], 0 offen offset:64 sc1
    buffer_load_dwordx4 v[140:143], v27, s[52:55], 0 offen offset:128 sc1
    s_waitcnt vmcnt(0)
    v_max3_u32 v84, v132, v133, v134
    v_max3_u32 v85, v135, v136, v137
    v_max3_u32 v86, v138, v139, v140
    v_max3_u32 v87, v141, v142, v143
    v_max3_u32 v84, v84, v85, v86
    v_max_u32 v84, v84, v87
    v_cmp_eq_u32 vcc, -1, v84
    s_add_u32 s3, s3, 1
    s_cmp_ge_u32 s3, 400000
    s_cbranch_scc1 L_aggd
    s_cbranch_vccnz L_aggl
L_aggd:
    s_add_u32 m0, s73, 28672
    v_pk_mul_f32 v[84:85], v[72:73], v[132:133] op_sel_hi:[0,1]
    global_load_lds_dwordx4 v151, s[20:21]
    v_pk_mul_f32 v[86:87], v[74:75], v[134:135] op_sel_hi:[0,1]
    v_pk_mul_f32 v[88:89], v[76:77], v[136:137] op_sel_hi:[0,1]
    v_pk_mul_f32 v[90:91], v[78:79], v[138:139] op_sel_hi:[0,1]
    v_pk_mul_f32 v[92:93], v[80:81], v[140:141] op_sel_hi:[0,1]
    v_pk_mul_f32 v[94:95], v[82:83], v[142:143] op_sel_hi:[0,1]
    v_pk_fma_f32 v[84:85], v[72:73], v[132:133], v[84:85] op_sel:[1,1,0] op_sel_hi:[1,0,1] neg_lo:[1,0,0]
    v_pk_fma_f32 v[86:87], v[74:75], v[134:135], v[86:87] op_sel:[1,1,0] op_sel_hi:[1,0,1] neg_lo:[1,0,0]
    v_pk_fma_f32 v[88:89], v[76:77], v[136:137], v[88:89] op_sel:[1,1,0] op_sel_hi:[1,0,1] neg_lo:[1,0,0]
    v_pk_fma_f32 v[90:91], v[78:79], v[138:139], v[90:91] op_sel:[1,1,0] op_sel_hi:[1,0,1] neg_lo:[1,0,0]
    v_pk_fma_f32 v[92:93], v[80:81], v[140:141], v[92:93] op_sel:[1,1,0] op_sel_hi:[1,0,1] neg_lo:[1,0,0]
    v_pk_fma_f32 v[94:95], v[82:83], v[142:143], v[94:95] op_sel:[1,1,0] op_sel_hi:[1,0,1] neg_lo:[1,0,0]
    v_add_f32_dpp v84, v84, v84 row_ror:8 row_mask:0xf bank_mask:0xf
    v_add_f32_dpp v85, v85, v85 row_ror:8 row_mask:0xf bank_mask:0xf
    v_add_f32_dpp v86, v86, v86 row_ror:8 row_mask:0xf bank_mask:0xf
    v_add_f32_dpp v87, v87, v87 row_ror:8 row_mask:0xf bank_mask:0xf
    v_add_f32_dpp v88, v88, v88 row_ror:8 row_mask:0xf bank_mask:0xf
    v_add_f32_dpp v89, v89, v89 row_ror:8 row_mask:0xf bank_mask:0xf
    v_add_f32_dpp v90, v90, v90 row_ror:8 row_mask:0xf bank_mask:0xf
    v_add_f32_dpp v91, v91, v91 row_ror:8 row_mask:0xf bank_mask:0xf
    v_add_f32_dpp v92, v92, v92 row_ror:8 row_mask:0xf bank_mask:0xf
    s_add_u32 m0, s73, 29696
    v_add_f32_dpp v93, v93, v93 row_ror:8 row_mask:0xf bank_mask:0xf
    global_load_lds_dwordx4 v151, s[30:31]
    v_add_f32_dpp v94, v94, v94 row_ror:8 row_mask:0xf bank_mask:0xf
    v_add_f32_dpp v95, v95, v95 row_ror:8 row_mask:0xf bank_mask:0xf
    v_add_f32_dpp v84, v84, v84 row_ror:4 row_mask:0xf bank_mask:0xf
    v_add_f32_dpp v85, v85, v85 row_ror:4 row_mask:0xf bank_mask:0xf
    v_add_f32_dpp v86, v86, v86 row_ror:4 row_mask:0xf bank_mask:0xf
    v_add_f32_dpp v87, v87, v87 row_ror:4 row_mask:0xf bank_mask:0xf
    v_add_f32_dpp v88, v88, v88 row_ror:4 row_mask:0xf bank_mask:0xf
    v_add_f32_dpp v89, v89, v89 row_ror:4 row_mask:0xf bank_mask:0xf
    v_add_f32_dpp v90, v90, v90 row_ror:4 row_mask:0xf bank_mask:0xf
    v_add_f32_dpp v91, v91, v91 row_ror:4 row_mask:0xf bank_mask:0xf
    v_add_f32_dpp v92, v92, v92 row_ror:4 row_mask:0xf bank_mask:0xf
    v_add_f32_dpp v93, v93, v93 row_ror:4 row_mask:0xf bank_mask:0xf
    v_add_f32_dpp v94, v94, v94 row_ror:4 row_mask:0xf bank_mask:0xf
    v_add_f32_dpp v95, v95, v95 row_ror:4 row_mask:0xf bank_mask:0xf
    v_add_f32_dpp v84, v84, v84 row_ror:2 row_mask:0xf bank_mask:0xf
    v_add_f32_dpp v85, v85, v85 row_ror:2 row_mask:0xf bank_mask:0xf
    v_add_f32_dpp v86, v86, v86 row_ror:2 row_mask:0xf bank_mask:0xf
    v_add_f32_dpp v87, v87, v87 row_ror:2 row_mask:0xf bank_mask:0xf
    v_add_f32_dpp v88, v88, v88 row_ror:2 row_mask:0xf bank_mask:0xf
    v_add_f32_dpp v89, v89, v89 row_ror:2 row_mask:0xf bank_mask:0xf
    v_add_f32_dpp v90, v90, v90 row_ror:2 row_mask:0xf bank_mask:0xf
    v_add_f32_dpp v91, v91, v91 row_ror:2 row_mask:0xf bank_mask:0xf
    buffer_load_dwordx2 a[244:245], v152, s[52:55], 0 offen sc1
    v_add_f32_dpp v92, v92, v92 row_ror:2 row_mask:0xf bank_mask:0xf
    v_add_f32_dpp v93, v93, v93 row_ror:2 row_mask:0xf bank_mask:0xf
    v_add_f32_dpp v94, v94, v94 row_ror:2 row_mask:0xf bank_mask:0xf
    v_add_f32_dpp v95, v95, v95 row_ror:2 row_mask:0xf bank_mask:0xf
    v_add_f32_dpp v84, v84, v84 row_ror:1 row_mask:0xf bank_mask:0xf
    v_add_f32_dpp v85, v85, v85 row_ror:1 row_mask:0xf bank_mask:0xf
    v_add_f32_dpp v86, v86, v86 row_ror:1 row_mask:0xf bank_mask:0xf
    v_add_f32_dpp v87, v87, v87 row_ror:1 row_mask:0xf bank_mask:0xf
    v_add_f32_dpp v88, v88, v88 row_ror:1 row_mask:0xf bank_mask:0xf
    v_add_f32_dpp v89, v89, v89 row_ror:1 row_mask:0xf bank_mask:0xf
    v_add_f32_dpp v90, v90, v90 row_ror:1 row_mask:0xf bank_mask:0xf
    v_add_f32_dpp v91, v91, v91 row_ror:1 row_mask:0xf bank_mask:0xf
    v_add_f32_dpp v92, v92, v92 row_ror:1 row_mask:0xf bank_mask:0xf
    v_add_f32_dpp v93, v93, v93 row_ror:1 row_mask:0xf bank_mask:0xf
    v_add_f32_dpp v94, v94, v94 row_ror:1 row_mask:0xf bank_mask:0xf
    v_add_f32_dpp v95, v95, v95 row_ror:1 row_mask:0xf bank_mask:0xf
    v_pk_fma_f32 v[32:33], v[60:61], v[84:85], v[32:33] op_sel_hi:[0,1,1]
    v_pk_fma_f32 v[34:35], v[62:63], v[86:87], v[34:35] op_sel_hi:[0,1,1]
    v_pk_fma_f32 v[36:37], v[64:65], v[88:89], v[36:37] op_sel_hi:[0,1,1]
    v_pk_fma_f32 v[38:39], v[66:67], v[90:91], v[38:39] op_sel_hi:[0,1,1]
    v_pk_fma_f32 v[40:41], v[68:69], v[92:93], v[40:41] op_sel_hi:[0,1,1]
    v_pk_fma_f32 v[42:43], v[70:71], v[94:95], v[42:43] op_sel_hi:[0,1,1]
    s_cmp_eq_u32 s64, 3
    s_cselect_b32 s3, 134217728, 0
    v_add_u32 v47, s3, v21
    v_add_u32_e64 v22, s3, v22
    v_pk_fma_f32 v[32:33], v[60:61], v[84:85], v[32:33] op_sel:[1,1,0] op_sel_hi:[1,0,1] neg_lo:[1,0,0]
    v_pk_fma_f32 v[34:35], v[62:63], v[86:87], v[34:35] op_sel:[1,1,0] op_sel_hi:[1,0,1] neg_lo:[1,0,0]
    v_pk_fma_f32 v[36:37], v[64:65], v[88:89], v[36:37] op_sel:[1,1,0] op_sel_hi:[1,0,1] neg_lo:[1,0,0]
    v_pk_fma_f32 v[38:39], v[66:67], v[90:91], v[38:39] op_sel:[1,1,0] op_sel_hi:[1,0,1] neg_lo:[1,0,0]
    v_pk_fma_f32 v[40:41], v[68:69], v[92:93], v[40:41] op_sel:[1,1,0] op_sel_hi:[1,0,1] neg_lo:[1,0,0]
    v_pk_fma_f32 v[42:43], v[70:71], v[94:95], v[42:43] op_sel:[1,1,0] op_sel_hi:[1,0,1] neg_lo:[1,0,0]
    v_pk_fma_f32 v[160:161], v[48:49], v[32:33], v[160:161] op_sel_hi:[0,1,1]
    v_pk_fma_f32 v[162:163], v[50:51], v[34:35], v[162:163] op_sel_hi:[0,1,1]
    v_pk_fma_f32 v[164:165], v[52:53], v[36:37], v[164:165] op_sel_hi:[0,1,1]
    v_pk_fma_f32 v[166:167], v[54:55], v[38:39], v[166:167] op_sel_hi:[0,1,1]
    v_pk_fma_f32 v[168:169], v[56:57], v[40:41], v[168:169] op_sel_hi:[0,1,1]
    v_pk_fma_f32 v[170:171], v[58:59], v[42:43], v[170:171] op_sel_hi:[0,1,1]
    v_pk_fma_f32 v[160:161], v[48:49], v[32:33], v[160:161] op_sel:[1,1,0] op_sel_hi:[1,0,1] neg_lo:[1,0,0]
    v_pk_fma_f32 v[162:163], v[50:51], v[34:35], v[162:163] op_sel:[1,1,0] op_sel_hi:[1,0,1] neg_lo:[1,0,0]
    v_pk_fma_f32 v[164:165], v[52:53], v[36:37], v[164:165] op_sel:[1,1,0] op_sel_hi:[1,0,1] neg_lo:[1,0,0]
    v_pk_fma_f32 v[166:167], v[54:55], v[38:39], v[166:167] op_sel:[1,1,0] op_sel_hi:[1,0,1] neg_lo:[1,0,0]
    v_pk_fma_f32 v[168:169], v[56:57], v[40:41], v[168:169] op_sel:[1,1,0] op_sel_hi:[1,0,1] neg_lo:[1,0,0]
    v_pk_fma_f32 v[170:171], v[58:59], v[42:43], v[170:171] op_sel:[1,1,0] op_sel_hi:[1,0,1] neg_lo:[1,0,0]
    v_pk_fma_f32 v[172:173], v[48:49], v[160:161], v[172:173] op_sel_hi:[0,1,1]
    v_pk_fma_f32 v[174:175], v[50:51], v[162:163], v[174:175] op_sel_hi:[0,1,1]
    v_pk_fma_f32 v[176:177], v[52:53], v[164:165], v[176:177] op_sel_hi:[0,1,1]
    s_add_u32 m0, s73, 20480
    v_pk_fma_f32 v[178:179], v[54:55], v[166:167], v[178:179] op_sel_hi:[0,1,1]
    buffer_load_dwordx4 v47, s[52:55], s85 offen offset:0 sc1 lds
    v_pk_fma_f32 v[180:181], v[56:57], v[168:169], v[180:181] op_sel_hi:[0,1,1]
    v_pk_fma_f32 v[182:183], v[58:59], v[170:171], v[182:183] op_sel_hi:[0,1,1]
    v_pk_fma_f32 v[172:173], v[48:49], v[160:161], v[172:173] op_sel:[1,1,0] op_sel_hi:[1,0,1] neg_lo:[1,0,0]
    v_pk_fma_f32 v[174:175], v[50:51], v[162:163], v[174:175] op_sel:[1,1,0] op_sel_hi:[1,0,1] neg_lo:[1,0,0]
    v_pk_fma_f32 v[176:177], v[52:53], v[164:165], v[176:177] op_sel:[1,1,0] op_sel_hi:[1,0,1] neg_lo:[1,0,0]
    v_pk_fma_f32 v[178:179], v[54:55], v[166:167], v[178:179] op_sel:[1,1,0] op_sel_hi:[1,0,1] neg_lo:[1,0,0]
    v_pk_fma_f32 v[180:181], v[56:57], v[168:169], v[180:181] op_sel:[1,1,0] op_sel_hi:[1,0,1] neg_lo:[1,0,0]
    v_pk_fma_f32 v[182:183], v[58:59], v[170:171], v[182:183] op_sel:[1,1,0] op_sel_hi:[1,0,1] neg_lo:[1,0,0]
    s_mov_b32 s38, 0
    s_nop 0
    v_cvt_pk_bf16_f32 v84, v160, v162
    v_cvt_pk_bf16_f32 v85, -v161, -v163
    v_cvt_pk_bf16_f32 v86, v172, v174
    v_cvt_pk_bf16_f32 v87, -v173, -v175
    v_cvt_pk_bf16_f32 v88, v164, v166
    v_cvt_pk_bf16_f32 v89, -v165, -v167
    v_cvt_pk_bf16_f32 v90, v176, v178
    v_cvt_pk_bf16_f32 v91, -v177, -v179
    v_cvt_pk_bf16_f32 v92, v168, v170
    v_cvt_pk_bf16_f32 v93, -v169, -v171
    v_cvt_pk_bf16_f32 v94, v180, v182
    s_add_u32 m0, s73, 20480
    v_cvt_pk_bf16_f32 v95, -v181, -v183
    buffer_load_dwordx4 v47, s[52:55], s85 offen offset:1024 sc1 lds
    v_permlane16_swap_b32 v84, v85
    v_permlane16_swap_b32 v86, v87
    v_permlane16_swap_b32 v88, v89
    v_permlane16_swap_b32 v90, v91
    v_permlane16_swap_b32 v92, v93
    v_permlane16_swap_b32 v94, v95
    v_permlane32_swap_b32 v84, v86
    v_permlane32_swap_b32 v85, v87
    buffer_store_dwordx4 v[84:87], v23, s[52:55], s38 offen offset:0 sc1
    v_permlane32_swap_b32 v88, v90
    v_permlane32_swap_b32 v89, v91
    buffer_store_dwordx4 v[88:91], v24, s[52:55], s38 offen offset:256 sc1
    v_permlane32_swap_b32 v92, v94
    v_permlane32_swap_b32 v93, v95
    buffer_store_dwordx4 v[92:95], v25, s[52:55], s38 offen offset:512 sc1
    v_pk_fma_f32 v[184:185], v[48:49], v[172:173], v[184:185] op_sel_hi:[0,1,1]
    v_pk_fma_f32 v[186:187], v[50:51], v[174:175], v[186:187] op_sel_hi:[0,1,1]
    v_pk_fma_f32 v[188:189], v[52:53], v[176:177], v[188:189] op_sel_hi:[0,1,1]
    v_pk_fma_f32 v[190:191], v[54:55], v[178:179], v[190:191] op_sel_hi:[0,1,1]
    v_pk_fma_f32 v[192:193], v[56:57], v[180:181], v[192:193] op_sel_hi:[0,1,1]
    v_pk_fma_f32 v[194:195], v[58:59], v[182:183], v[194:195] op_sel_hi:[0,1,1]
    s_add_u32 m0, s73, 20480
    v_pk_fma_f32 v[184:185], v[48:49], v[172:173], v[184:185] op_sel:[1,1,0] op_sel_hi:[1,0,1] neg_lo:[1,0,0]
    buffer_load_dwordx4 v47, s[52:55], s85 offen offset:2048 sc1 lds
    v_pk_fma_f32 v[186:187], v[50:51], v[174:175], v[186:187] op_sel:[1,1,0] op_sel_hi:[1,0,1] neg_lo:[1,0,0]
    v_pk_fma_f32 v[188:189], v[52:53], v[176:177], v[188:189] op_sel:[1,1,0] op_sel_hi:[1,0,1] neg_lo:[1,0,0]
    v_pk_fma_f32 v[190:191], v[54:55], v[178:179], v[190:191] op_sel:[1,1,0] op_sel_hi:[1,0,1] neg_lo:[1,0,0]
    v_pk_fma_f32 v[192:193], v[56:57], v[180:181], v[192:193] op_sel:[1,1,0] op_sel_hi:[1,0,1] neg_lo:[1,0,0]
    v_pk_fma_f32 v[194:195], v[58:59], v[182:183], v[194:195] op_sel:[1,1,0] op_sel_hi:[1,0,1] neg_lo:[1,0,0]
    v_pk_fma_f32 v[196:197], v[48:49], v[184:185], v[196:197] op_sel_hi:[0,1,1]
    v_pk_fma_f32 v[198:199], v[50:51], v[186:187], v[198:199] op_sel_hi:[0,1,1]
    v_pk_fma_f32 v[200:201], v[52:53], v[188:189], v[200:201] op_sel_hi:[0,1,1]
    v_pk_fma_f32 v[202:203], v[54:55], v[190:191], v[202:203] op_sel_hi:[0,1,1]
    v_pk_fma_f32 v[204:205], v[56:57], v[192:193], v[204:205] op_sel_hi:[0,1,1]
    v_pk_fma_f32 v[206:207], v[58:59], v[194:195], v[206:207] op_sel_hi:[0,1,1]
    v_pk_fma_f32 v[196:197], v[48:49], v[184:185], v[196:197] op_sel:[1,1,0] op_sel_hi:[1,0,1] neg_lo:[1,0,0]
    v_pk_fma_f32 v[198:199], v[50:51], v[186:187], v[198:199] op_sel:[1,1,0] op_sel_hi:[1,0,1] neg_lo:[1,0,0]
    v_pk_fma_f32 v[200:201], v[52:53], v[188:189], v[200:201] op_sel:[1,1,0] op_sel_hi:[1,0,1] neg_lo:[1,0,0]
    v_pk_fma_f32 v[202:203], v[54:55], v[190:191], v[202:203] op_sel:[1,1,0] op_sel_hi:[1,0,1] neg_lo:[1,0,0]
    v_pk_fma_f32 v[204:205], v[56:57], v[192:193], v[204:205] op_sel:[1,1,0] op_sel_hi:[1,0,1] neg_lo:[1,0,0]
    v_pk_fma_f32 v[206:207], v[58:59], v[194:195], v[206:207] op_sel:[1,1,0] op_sel_hi:[1,0,1] neg_lo:[1,0,0]
    s_mov_b32 s38, 192512
    v_cvt_pk_bf16_f32 v96, v184, v186
    v_cvt_pk_bf16_f32 v97, -v185, -v187
    v_cvt_pk_bf16_f32 v98, v196, v198
    s_add_u32 m0, s73, 20480
    v_cvt_pk_bf16_f32 v99, -v197, -v199
    buffer_load_dwordx4 v47, s[52:55], s85 offen offset:3072 sc1 lds
    v_cvt_pk_bf16_f32 v100, v188, v190
    v_cvt_pk_bf16_f32 v101, -v189, -v191
    v_cvt_pk_bf16_f32 v102, v200, v202
    v_cvt_pk_bf16_f32 v103, -v201, -v203
    v_cvt_pk_bf16_f32 v104, v192, v194
    v_cvt_pk_bf16_f32 v105, -v193, -v195
    v_cvt_pk_bf16_f32 v106, v204, v206
    v_cvt_pk_bf16_f32 v107, -v205, -v207
    v_permlane16_swap_b32 v96, v97
    v_permlane16_swap_b32 v98, v99
    v_permlane16_swap_b32 v100, v101
    v_permlane16_swap_b32 v102, v103
    v_permlane16_swap_b32 v104, v105
    v_permlane16_swap_b32 v106, v107
    v_permlane32_swap_b32 v96, v98
    v_permlane32_swap_b32 v97, v99
    buffer_store_dwordx4 v[96:99], v23, s[52:55], s38 offen offset:0 sc1
    v_permlane32_swap_b32 v100, v102
    v_permlane32_swap_b32 v101, v103
    buffer_store_dwordx4 v[100:103], v24, s[52:55], s38 offen offset:256 sc1
    v_permlane32_swap_b32_e64 v104, v106
    s_add_u32 m0, s73, 24576
    v_permlane32_swap_b32_e64 v105, v107
    buffer_load_dwordx4 v22, s[52:55], s85 offen offset:0 sc1 lds
    buffer_store_dwordx4 v[104:107], v25, s[52:55], s38 offen offset:512 sc1
    v_pk_fma_f32 v[208:209], v[48:49], v[196:197], v[208:209] op_sel_hi:[0,1,1]
    v_pk_fma_f32 v[210:211], v[50:51], v[198:199], v[210:211] op_sel_hi:[0,1,1]
    v_pk_fma_f32 v[212:213], v[52:53], v[200:201], v[212:213] op_sel_hi:[0,1,1]
    v_pk_fma_f32 v[214:215], v[54:55], v[202:203], v[214:215] op_sel_hi:[0,1,1]
    v_pk_fma_f32 v[216:217], v[56:57], v[204:205], v[216:217] op_sel_hi:[0,1,1]
    v_pk_fma_f32 v[218:219], v[58:59], v[206:207], v[218:219] op_sel_hi:[0,1,1]
    v_pk_fma_f32 v[208:209], v[48:49], v[196:197], v[208:209] op_sel:[1,1,0] op_sel_hi:[1,0,1] neg_lo:[1,0,0]
    v_pk_fma_f32 v[210:211], v[50:51], v[198:199], v[210:211] op_sel:[1,1,0] op_sel_hi:[1,0,1] neg_lo:[1,0,0]
    v_pk_fma_f32 v[212:213], v[52:53], v[200:201], v[212:213] op_sel:[1,1,0] op_sel_hi:[1,0,1] neg_lo:[1,0,0]
    v_pk_fma_f32 v[214:215], v[54:55], v[202:203], v[214:215] op_sel:[1,1,0] op_sel_hi:[1,0,1] neg_lo:[1,0,0]
    v_pk_fma_f32 v[216:217], v[56:57], v[204:205], v[216:217] op_sel:[1,1,0] op_sel_hi:[1,0,1] neg_lo:[1,0,0]
    v_pk_fma_f32 v[218:219], v[58:59], v[206:207], v[218:219] op_sel:[1,1,0] op_sel_hi:[1,0,1] neg_lo:[1,0,0]
    v_pk_fma_f32 v[220:221], v[48:49], v[208:209], v[220:221] op_sel_hi:[0,1,1]
    v_pk_fma_f32 v[222:223], v[50:51], v[210:211], v[222:223] op_sel_hi:[0,1,1]
    v_pk_fma_f32 v[224:225], v[52:53], v[212:213], v[224:225] op_sel_hi:[0,1,1]
    v_pk_fma_f32 v[226:227], v[54:55], v[214:215], v[226:227] op_sel_hi:[0,1,1]
    v_pk_fma_f32 v[228:229], v[56:57], v[216:217], v[228:229] op_sel_hi:[0,1,1]
    v_pk_fma_f32 v[230:231], v[58:59], v[218:219], v[230:231] op_sel_hi:[0,1,1]
    v_pk_fma_f32 v[220:221], v[48:49], v[208:209], v[220:221] op_sel:[1,1,0] op_sel_hi:[1,0,1] neg_lo:[1,0,0]
    v_pk_fma_f32 v[222:223], v[50:51], v[210:211], v[222:223] op_sel:[1,1,0] op_sel_hi:[1,0,1] neg_lo:[1,0,0]
    v_pk_fma_f32 v[224:225], v[52:53], v[212:213], v[224:225] op_sel:[1,1,0] op_sel_hi:[1,0,1] neg_lo:[1,0,0]
    s_load_dword s16, s[14:15], 0 glc
    s_load_dword s17, s[14:15], 128 glc
    v_pk_fma_f32 v[226:227], v[54:55], v[214:215], v[226:227] op_sel:[1,1,0] op_sel_hi:[1,0,1] neg_lo:[1,0,0]
    v_pk_fma_f32 v[228:229], v[56:57], v[216:217], v[228:229] op_sel:[1,1,0] op_sel_hi:[1,0,1] neg_lo:[1,0,0]
    v_pk_fma_f32 v[230:231], v[58:59], v[218:219], v[230:231] op_sel:[1,1,0] op_sel_hi:[1,0,1] neg_lo:[1,0,0]
    s_mov_b32 s38, 385024
    v_cvt_pk_bf16_f32 v84, v208, v210
    v_cvt_pk_bf16_f32 v85, -v209, -v211
    v_cvt_pk_bf16_f32 v86, v220, v222
    v_cvt_pk_bf16_f32 v87, -v221, -v223
    v_cvt_pk_bf16_f32 v88, v212, v214
    v_cvt_pk_bf16_f32 v89, -v213, -v215
    v_cvt_pk_bf16_f32 v90, v224, v226
    v_cvt_pk_bf16_f32 v91, -v225, -v227
    v_cvt_pk_bf16_f32 v92, v216, v218
    v_cvt_pk_bf16_f32 v93, -v217, -v219
    v_cvt_pk_bf16_f32 v94, v228, v230
    v_cvt_pk_bf16_f32 v95, -v229, -v231
    v_permlane16_swap_b32 v84, v85
    v_permlane16_swap_b32 v86, v87
    v_permlane16_swap_b32 v88, v89
    v_permlane16_swap_b32 v90, v91
    v_permlane16_swap_b32 v92, v93
    v_permlane16_swap_b32 v94, v95
    v_permlane32_swap_b32 v84, v86
    v_permlane32_swap_b32 v85, v87
    buffer_store_dwordx4 v[84:87], v23, s[52:55], s38 offen offset:0 sc1
    v_permlane32_swap_b32 v88, v90
    v_permlane32_swap_b32 v89, v91
    buffer_store_dwordx4 v[88:91], v24, s[52:55], s38 offen offset:256 sc1
    v_permlane32_swap_b32 v92, v94
    v_permlane32_swap_b32 v93, v95
    buffer_store_dwordx4 v[92:95], v25, s[52:55], s38 offen offset:512 sc1
    v_pk_fma_f32 v[232:233], v[48:49], v[220:221], v[232:233] op_sel_hi:[0,1,1]
    v_pk_fma_f32 v[234:235], v[50:51], v[222:223], v[234:235] op_sel_hi:[0,1,1]
    v_pk_fma_f32 v[236:237], v[52:53], v[224:225], v[236:237] op_sel_hi:[0,1,1]
    v_pk_fma_f32 v[238:239], v[54:55], v[226:227], v[238:239] op_sel_hi:[0,1,1]
    v_pk_fma_f32 v[240:241], v[56:57], v[228:229], v[240:241] op_sel_hi:[0,1,1]
    v_pk_fma_f32 v[242:243], v[58:59], v[230:231], v[242:243] op_sel_hi:[0,1,1]
    v_pk_fma_f32 v[232:233], v[48:49], v[220:221], v[232:233] op_sel:[1,1,0] op_sel_hi:[1,0,1] neg_lo:[1,0,0]
    v_pk_fma_f32 v[234:235], v[50:51], v[222:223], v[234:235] op_sel:[1,1,0] op_sel_hi:[1,0,1] neg_lo:[1,0,0]
    v_pk_fma_f32 v[236:237], v[52:53], v[224:225], v[236:237] op_sel:[1,1,0] op_sel_hi:[1,0,1] neg_lo:[1,0,0]
    v_pk_fma_f32 v[238:239], v[54:55], v[226:227], v[238:239] op_sel:[1,1,0] op_sel_hi:[1,0,1] neg_lo:[1,0,0]
    v_pk_fma_f32 v[240:241], v[56:57], v[228:229], v[240:241] op_sel:[1,1,0] op_sel_hi:[1,0,1] neg_lo:[1,0,0]
    v_pk_fma_f32 v[242:243], v[58:59], v[230:231], v[242:243] op_sel:[1,1,0] op_sel_hi:[1,0,1] neg_lo:[1,0,0]
    v_pk_fma_f32 v[244:245], v[48:49], v[232:233], v[244:245] op_sel_hi:[0,1,1]
    v_pk_fma_f32 v[246:247], v[50:51], v[234:235], v[246:247] op_sel_hi:[0,1,1]
    v_pk_fma_f32 v[248:249], v[52:53], v[236:237], v[248:249] op_sel_hi:[0,1,1]
    v_pk_fma_f32 v[250:251], v[54:55], v[238:239], v[250:251] op_sel_hi:[0,1,1]
    v_pk_fma_f32 v[252:253], v[56:57], v[240:241], v[252:253] op_sel_hi:[0,1,1]
    v_pk_fma_f32 v[254:255], v[58:59], v[242:243], v[254:255] op_sel_hi:[0,1,1]
    v_pk_fma_f32 v[244:245], v[48:49], v[232:233], v[244:245] op_sel:[1,1,0] op_sel_hi:[1,0,1] neg_lo:[1,0,0]
    v_pk_fma_f32 v[246:247], v[50:51], v[234:235], v[246:247] op_sel:[1,1,0] op_sel_hi:[1,0,1] neg_lo:[1,0,0]
    v_pk_fma_f32 v[248:249], v[52:53], v[236:237], v[248:249] op_sel:[1,1,0] op_sel_hi:[1,0,1] neg_lo:[1,0,0]
    v_pk_fma_f32 v[250:251], v[54:55], v[238:239], v[250:251] op_sel:[1,1,0] op_sel_hi:[1,0,1] neg_lo:[1,0,0]
    v_pk_fma_f32 v[252:253], v[56:57], v[240:241], v[252:253] op_sel:[1,1,0] op_sel_hi:[1,0,1] neg_lo:[1,0,0]
    v_pk_fma_f32 v[254:255], v[58:59], v[242:243], v[254:255] op_sel:[1,1,0] op_sel_hi:[1,0,1] neg_lo:[1,0,0]
    s_mov_b32 s38, 577536
    v_cvt_pk_bf16_f32 v96, v232, v234
    v_cvt_pk_bf16_f32 v97, -v233, -v235
    v_cvt_pk_bf16_f32 v98, v244, v246
    v_cvt_pk_bf16_f32 v99, -v245, -v247
    v_cvt_pk_bf16_f32 v100, v236, v238
    v_cvt_pk_bf16_f32 v101, -v237, -v239
    v_cvt_pk_bf16_f32 v102, v248, v250
    v_cvt_pk_bf16_f32 v103, -v249, -v251
    v_cvt_pk_bf16_f32 v104, v240, v242
    v_cvt_pk_bf16_f32 v105, -v241, -v243
    v_cvt_pk_bf16_f32 v106, v252, v254
    v_cvt_pk_bf16_f32 v107, -v253, -v255
    v_permlane16_swap_b32 v96, v97
    v_permlane16_swap_b32 v98, v99
    v_permlane16_swap_b32 v100, v101
    v_permlane16_swap_b32 v102, v103
    v_permlane16_swap_b32 v104, v105
    v_permlane16_swap_b32 v106, v107
    v_permlane32_swap_b32 v96, v98
    v_permlane32_swap_b32 v97, v99
    buffer_store_dwordx4 v[96:99], v23, s[52:55], s38 offen offset:0 sc1
    v_permlane32_swap_b32 v100, v102
    v_permlane32_swap_b32 v101, v103
    buffer_store_dwordx4 v[100:103], v24, s[52:55], s38 offen offset:256 sc1
    v_permlane32_swap_b32 v104, v106
    v_permlane32_swap_b32 v105, v107
    buffer_store_dwordx4 v[104:107], v25, s[52:55], s38 offen offset:512 sc1
    s_waitcnt lgkmcnt(0)
    s_xor_b32 s16, s16, s34
    s_xor_b32 s17, s17, s34
    s_or_b32 s16, s16, s17
    s_cbranch_scc0 L_pfSd
    s_mov_b32 s3, 0
L_pfSl:
    s_load_dword s16, s[14:15], 0 glc
    s_load_dword s17, s[14:15], 128 glc
    s_add_u32 s3, s3, 1
    s_cmp_ge_u32 s3, 400000
    s_cbranch_scc1 L_pfSd
    s_waitcnt lgkmcnt(0)
    s_xor_b32 s16, s16, s34
    s_xor_b32 s17, s17, s34
    s_or_b32 s16, s16, s17
    s_cbranch_scc1 L_pfSl
L_pfSd:
    buffer_load_dwordx4 a[100:103], v3, s[52:55], s10 offen offset:0 sc1
    buffer_load_dwordx4 a[104:107], v3, s[52:55], s10 offen offset:1024 sc1
    buffer_load_dwordx4 a[108:111], v3, s[52:55], s10 offen offset:2048 sc1
    buffer_load_dwordx4 a[112:115], v3, s[52:55], s10 offen offset:3072 sc1
    s_waitcnt vmcnt(21)
    ds_read_b64_tr_b16 a[164:165], v5 offset:30720
    ds_read_b64_tr_b16 a[166:167], v5 offset:32000
    ds_read_b64_tr_b16 a[184:185], v5 offset:35840
    ds_read_b64_tr_b16 a[186:187], v5 offset:37120
    ds_read_b64_tr_b16 a[204:205], v5 offset:0
    ds_read_b64_tr_b16 a[206:207], v5 offset:1280
    ds_read_b64_tr_b16 a[224:225], v5 offset:5120
    ds_read_b64_tr_b16 a[226:227], v5 offset:6400
    ds_read_b64_tr_b16 a[168:169], v5 offset:30752
    ds_read_b64_tr_b16 a[170:171], v5 offset:32032
    ds_read_b64_tr_b16 a[188:189], v5 offset:35872
    ds_read_b64_tr_b16 a[190:191], v5 offset:37152
    ds_read_b64_tr_b16 a[208:209], v5 offset:32
    ds_read_b64_tr_b16 a[210:211], v5 offset:1312
    ds_read_b64_tr_b16 a[228:229], v5 offset:5152
    ds_read_b64_tr_b16 a[230:231], v5 offset:6432
    ds_read_b64_tr_b16 a[172:173], v5 offset:30784
    ds_read_b64_tr_b16 a[174:175], v5 offset:32064
    ds_read_b64_tr_b16 a[192:193], v5 offset:35904
    ds_read_b64_tr_b16 a[194:195], v5 offset:37184
    ds_read_b64_tr_b16 a[212:213], v5 offset:64
    ds_read_b64_tr_b16 a[214:215], v5 offset:1344
    ds_read_b64_tr_b16 a[232:233], v5 offset:5184
    ds_read_b64_tr_b16 a[234:235], v5 offset:6464
    ds_read_b64_tr_b16 a[176:177], v5 offset:30816
    ds_read_b64_tr_b16 a[178:179], v5 offset:32096
    ds_read_b64_tr_b16 a[196:197], v5 offset:35936
    ds_read_b64_tr_b16 a[198:199], v5 offset:37216
    ds_read_b64_tr_b16 a[216:217], v5 offset:96
    ds_read_b64_tr_b16 a[218:219], v5 offset:1376
    ds_read_b64_tr_b16 a[236:237], v5 offset:5216
    ds_read_b64_tr_b16 a[238:239], v5 offset:6496
    ds_read_b64_tr_b16 a[180:181], v5 offset:30848
    ds_read_b64_tr_b16 a[182:183], v5 offset:32128
    ds_read_b64_tr_b16 a[200:201], v5 offset:35968
    ds_read_b64_tr_b16 a[202:203], v5 offset:37248
    ds_read_b64_tr_b16 a[220:221], v5 offset:128
    ds_read_b64_tr_b16 a[222:223], v5 offset:1408
    ds_read_b64_tr_b16 a[240:241], v5 offset:5248
    ds_read_b64_tr_b16 a[242:243], v5 offset:6528
L_join:
    v_and_b32_e64 v34, 3, v0
    v_lshl_add_u32 v37, v34, 3, s73
    v_mul_u32_u24 v32, 160, v6
    v_add_u32_e64 v36, v37, v32
    ds_read_b64 v[128:129], v36 offset:25600
    ds_read_b64 v[138:139], v37 offset:28672
    ds_read_b64 v[148:149], v37 offset:29696
    ds_read_b64 v[130:131], v36 offset:25632
    ds_read_b64 v[140:141], v37 offset:28704
    ds_read_b64 v[150:151], v37 offset:29728
    ds_read_b64 v[132:133], v36 offset:25664
    ds_read_b64 v[142:143], v37 offset:28736
    ds_read_b64 v[152:153], v37 offset:29760
    ds_read_b64 v[134:135], v36 offset:25696
    ds_read_b64 v[144:145], v37 offset:28768
    ds_read_b64 v[154:155], v37 offset:29792
    ds_read_b64 v[136:137], v36 offset:25728
    ds_read_b64 v[146:147], v37 offset:28800
    ds_read_b64 v[156:157], v37 offset:29824
    v_accvgpr_read_b32 v158, a244
    v_accvgpr_read_b32 v159, a245
    buffer_load_dwordx4 a[116:119], v3, s[52:55], s11 offen offset:0 sc1
    buffer_load_dwordx4 a[120:123], v3, s[52:55], s11 offen offset:1024 sc1
    buffer_load_dwordx4 a[124:127], v3, s[52:55], s11 offen offset:2048 sc1
    buffer_load_dwordx4 a[128:131], v3, s[52:55], s11 offen offset:3072 sc1
    s_waitcnt lgkmcnt(0)
    v_lshlrev_b32 v208, 16, v128
    v_lshlrev_b32_e64 v210, 16, v129
    v_and_b32 v209, 0xffff0000, v128
    v_and_b32 v211, 0xffff0000, v129
    v_lshlrev_b32 v160, 16, v138
    v_lshlrev_b32 v166, 16, v139
    v_and_b32 v161, 0xffff0000, v138
    v_and_b32 v167, 0xffff0000, v139
    v_lshlrev_b32 v162, 16, v148
    v_lshlrev_b32 v168, 16, v149
    v_and_b32 v163, 0xffff0000, v148
    v_and_b32 v169, 0xffff0000, v149
    v_pk_add_f32 v[164:165], v[208:209], v[158:159] op_sel_hi:[1,0] neg_lo:[0,1] neg_hi:[0,1]
    v_pk_add_f32 v[170:171], v[210:211], v[158:159] op_sel_hi:[1,0] neg_lo:[0,1] neg_hi:[0,1]
    v_pk_mul_f32 v[160:161], v[160:161], v[158:159] op_sel:[0,1] op_sel_hi:[1,1]
    v_pk_mul_f32 v[166:167], v[166:167], v[158:159] op_sel:[0,1] op_sel_hi:[1,1]
    v_pk_add_f32 v[208:209], v[208:209], v[162:163]
    v_pk_add_f32 v[210:211], v[210:211], v[168:169]
    v_pk_fma_f32 v[208:209], v[164:165], v[160:161], v[208:209]
    v_pk_fma_f32 v[210:211], v[170:171], v[166:167], v[210:211]
    v_lshlrev_b32 v212, 16, v130
    v_lshlrev_b32 v214, 16, v131
    v_and_b32 v213, 0xffff0000, v130
    v_and_b32 v215, 0xffff0000, v131
    v_lshlrev_b32 v160, 16, v140
    v_lshlrev_b32 v166, 16, v141
    v_and_b32 v161, 0xffff0000, v140
    v_and_b32 v167, 0xffff0000, v141
    v_lshlrev_b32 v162, 16, v150
    v_lshlrev_b32 v168, 16, v151
    v_and_b32 v163, 0xffff0000, v150
    buffer_load_dwordx4 a[132:135], v3, s[52:55], s12 offen offset:0 sc1
    v_and_b32 v169, 0xffff0000, v151
    buffer_load_dwordx4 a[136:139], v3, s[52:55], s12 offen offset:1024 sc1
    v_pk_add_f32 v[164:165], v[212:213], v[158:159] op_sel_hi:[1,0] neg_lo:[0,1] neg_hi:[0,1]
    buffer_load_dwordx4 a[140:143], v3, s[52:55], s12 offen offset:2048 sc1
    v_pk_add_f32 v[170:171], v[214:215], v[158:159] op_sel_hi:[1,0] neg_lo:[0,1] neg_hi:[0,1]
    buffer_load_dwordx4 a[144:147], v3, s[52:55], s12 offen offset:3072 sc1
    v_pk_mul_f32 v[160:161], v[160:161], v[158:159] op_sel:[0,1] op_sel_hi:[1,1]
    v_pk_mul_f32 v[166:167], v[166:167], v[158:159] op_sel:[0,1] op_sel_hi:[1,1]
    v_pk_add_f32 v[212:213], v[212:213], v[162:163]
    v_pk_add_f32 v[214:215], v[214:215], v[168:169]
    v_pk_fma_f32 v[212:213], v[164:165], v[160:161], v[212:213]
    v_pk_fma_f32 v[214:215], v[170:171], v[166:167], v[214:215]
    v_lshlrev_b32 v216, 16, v132
    v_lshlrev_b32 v218, 16, v133
    v_and_b32 v217, 0xffff0000, v132
    v_and_b32 v219, 0xffff0000, v133
    v_lshlrev_b32 v160, 16, v142
    v_lshlrev_b32 v166, 16, v143
    v_and_b32 v161, 0xffff0000, v142
    v_and_b32 v167, 0xffff0000, v143
    v_lshlrev_b32 v162, 16, v152
    v_lshlrev_b32 v168, 16, v153
    v_and_b32 v163, 0xffff0000, v152
    v_and_b32 v169, 0xffff0000, v153
    v_pk_add_f32 v[164:165], v[216:217], v[158:159] op_sel_hi:[1,0] neg_lo:[0,1] neg_hi:[0,1]
    v_pk_add_f32 v[170:171], v[218:219], v[158:159] op_sel_hi:[1,0] neg_lo:[0,1] neg_hi:[0,1]
    v_pk_mul_f32 v[160:161], v[160:161], v[158:159] op_sel:[0,1] op_sel_hi:[1,1]
    v_pk_mul_f32 v[166:167], v[166:167], v[158:159] op_sel:[0,1] op_sel_hi:[1,1]
    v_pk_add_f32 v[216:217], v[216:217], v[162:163]
    v_pk_add_f32 v[218:219], v[218:219], v[168:169]
    v_pk_fma_f32 v[216:217], v[164:165], v[160:161], v[216:217]
    v_pk_fma_f32 v[218:219], v[170:171], v[166:167], v[218:219]
    v_lshlrev_b32 v220, 16, v134
    v_lshlrev_b32 v222, 16, v135
    v_and_b32 v221, 0xffff0000, v134
    v_and_b32 v223, 0xffff0000, v135
    v_lshlrev_b32 v160, 16, v144
    v_lshlrev_b32 v166, 16, v145
    v_and_b32 v161, 0xffff0000, v144
    v_and_b32 v167, 0xffff0000, v145
    v_lshlrev_b32 v162, 16, v154
    v_lshlrev_b32 v168, 16, v155
    v_and_b32 v163, 0xffff0000, v154
    v_and_b32 v169, 0xffff0000, v155
    v_pk_add_f32 v[164:165], v[220:221], v[158:159] op_sel_hi:[1,0] neg_lo:[0,1] neg_hi:[0,1]
    v_pk_add_f32 v[170:171], v[222:223], v[158:159] op_sel_hi:[1,0] neg_lo:[0,1] neg_hi:[0,1]
    v_pk_mul_f32 v[160:161], v[160:161], v[158:159] op_sel:[0,1] op_sel_hi:[1,1]
    v_pk_mul_f32 v[166:167], v[166:167], v[158:159] op_sel:[0,1] op_sel_hi:[1,1]
    v_pk_add_f32 v[220:221], v[220:221], v[162:163]
    v_pk_add_f32 v[222:223], v[222:223], v[168:169]
    v_pk_fma_f32 v[220:221], v[164:165], v[160:161], v[220:221]
    v_pk_fma_f32 v[222:223], v[170:171], v[166:167], v[222:223]
    v_lshlrev_b32 v224, 16, v136
    v_lshlrev_b32 v226, 16, v137
    v_and_b32 v225, 0xffff0000, v136
    v_and_b32 v227, 0xffff0000, v137
    v_lshlrev_b32 v160, 16, v146
    v_lshlrev_b32 v166, 16, v147
    v_and_b32 v161, 0xffff0000, v146
    v_and_b32 v167, 0xffff0000, v147
    v_lshlrev_b32 v162, 16, v156
    v_lshlrev_b32 v168, 16, v157
    v_and_b32 v163, 0xffff0000, v156
    v_and_b32 v169, 0xffff0000, v157
    v_pk_add_f32 v[164:165], v[224:225], v[158:159] op_sel_hi:[1,0] neg_lo:[0,1] neg_hi:[0,1]
    v_pk_add_f32 v[170:171], v[226:227], v[158:159] op_sel_hi:[1,0] neg_lo:[0,1] neg_hi:[0,1]
    v_pk_mul_f32 v[160:161], v[160:161], v[158:159] op_sel:[0,1] op_sel_hi:[1,1]
    v_pk_mul_f32 v[166:167], v[166:167], v[158:159] op_sel:[0,1] op_sel_hi:[1,1]
    v_pk_add_f32 v[224:225], v[224:225], v[162:163]
    v_pk_add_f32 v[226:227], v[226:227], v[168:169]
    v_pk_fma_f32 v[224:225], v[164:165], v[160:161], v[224:225]
    v_pk_fma_f32 v[226:227], v[170:171], v[166:167], v[226:227]
    s_waitcnt vmcnt(11) lgkmcnt(0)
    s_cmp_eq_u32 s39, 0
    s_cbranch_scc1 L_nofs
    s_mov_b32 s3, s82
    s_mov_b64 exec, 0xff
    buffer_store_dwordx4 a[252:255], v21, s[52:55], s3 offen sc1
    s_mov_b64 exec, -1
L_nofs:
    v_mfma_f32_16x16x32_bf16 v[128:131], a[100:103], a[164:167], 0
    s_waitcnt vmcnt(10)
    v_mfma_f32_16x16x32_bf16 v[128:131], a[104:107], a[184:187], v[128:131]
    buffer_load_dwordx4 a[148:151], v3, s[52:55], s13 offen offset:0 sc1
    s_waitcnt vmcnt(10)
    v_mfma_f32_16x16x32_bf16 v[128:131], a[108:111], a[204:207], v[128:131]
    s_waitcnt vmcnt(9)
    v_mfma_f32_16x16x32_bf16 v[128:131], a[112:115], a[224:227], v[128:131]
    v_mfma_f32_16x16x32_bf16 v[132:135], a[112:115], a[228:231], 0
    v_mfma_f32_16x16x32_bf16 v[132:135], a[108:111], a[208:211], v[132:135]
    buffer_load_dwordx4 a[152:155], v3, s[52:55], s13 offen offset:1024 sc1
    v_mfma_f32_16x16x32_bf16 v[132:135], a[104:107], a[188:191], v[132:135]
    v_mfma_f32_16x16x32_bf16 v[132:135], a[100:103], a[168:171], v[132:135]
    v_mfma_f32_16x16x32_bf16 v[136:139], a[100:103], a[172:175], 0
    v_mfma_f32_16x16x32_bf16 v[136:139], a[104:107], a[192:195], v[136:139]
    buffer_load_dwordx4 a[156:159], v3, s[52:55], s13 offen offset:2048 sc1
    v_mfma_f32_16x16x32_bf16 v[136:139], a[108:111], a[212:215], v[136:139]
    v_mfma_f32_16x16x32_bf16 v[136:139], a[112:115], a[232:235], v[136:139]
    v_mfma_f32_16x16x32_bf16 v[140:143], a[112:115], a[236:239], 0
    v_mfma_f32_16x16x32_bf16 v[140:143], a[108:111], a[216:219], v[140:143]
    buffer_load_dwordx4 a[160:163], v3, s[52:55], s13 offen offset:3072 sc1
    v_mfma_f32_16x16x32_bf16 v[140:143], a[104:107], a[196:199], v[140:143]
    v_mfma_f32_16x16x32_bf16 v[140:143], a[100:103], a[176:179], v[140:143]
    v_mfma_f32_16x16x32_bf16 v[144:147], a[100:103], a[180:183], 0
    v_mfma_f32_16x16x32_bf16 v[144:147], a[104:107], a[200:203], v[144:147]
    v_mfma_f32_16x16x32_bf16 v[144:147], a[108:111], a[220:223], v[144:147]
    v_mfma_f32_16x16x32_bf16 v[144:147], a[112:115], a[240:243], v[144:147]
    s_waitcnt vmcnt(11)
    v_mfma_f32_16x16x32_bf16 v[148:151], a[116:119], a[164:167], 0
    s_cmp_eq_u32 s64, 1
    s_cselect_b32 s3, 7, 6
    v_min_u32_e64 v29, s3, v0
    s_waitcnt vmcnt(10)
    v_mfma_f32_16x16x32_bf16 v[148:151], a[120:123], a[184:187], v[148:151]
    buffer_load_dwordx4 a[100:103], v3, s[52:55], s24 offen offset:0 sc1
    s_waitcnt vmcnt(10)
    v_mfma_f32_16x16x32_bf16 v[148:151], a[124:127], a[204:207], v[148:151]
    s_waitcnt vmcnt(9)
    v_mfma_f32_16x16x32_bf16 v[148:151], a[128:131], a[224:227], v[148:151]
    v_mfma_f32_16x16x32_bf16 v[152:155], a[128:131], a[228:231], 0
    v_mfma_f32_16x16x32_bf16 v[152:155], a[124:127], a[208:211], v[152:155]
    buffer_load_dwordx4 a[104:107], v3, s[52:55], s24 offen offset:1024 sc1
    v_mfma_f32_16x16x32_bf16 v[152:155], a[120:123], a[188:191], v[152:155]
    s_mul_i32 s3, s64, 107
    s_lshr_b32 s3, s3, 4
    v_add_lshl_u32 v29, v29, s3, 7
    v_mfma_f32_16x16x32_bf16 v[152:155], a[116:119], a[168:171], v[152:155]
    v_mfma_f32_16x16x32_bf16 v[156:159], a[116:119], a[172:175], 0
    v_mfma_f32_16x16x32_bf16 v[156:159], a[120:123], a[192:195], v[156:159]
    buffer_load_dwordx4 a[108:111], v3, s[52:55], s24 offen offset:2048 sc1
    v_mfma_f32_16x16x32_bf16 v[156:159], a[124:127], a[212:215], v[156:159]
    v_mfma_f32_16x16x32_bf16 v[156:159], a[128:131], a[232:235], v[156:159]
    v_mfma_f32_16x16x32_bf16 v[160:163], a[128:131], a[236:239], 0
    v_mfma_f32_16x16x32_bf16 v[160:163], a[124:127], a[216:219], v[160:163]
    buffer_load_dwordx4 a[112:115], v3, s[52:55], s24 offen offset:3072 sc1
    s_lshl_b32 s4, s74, 12
    s_add_u32 s4, s4, 18153472
    v_mfma_f32_16x16x32_bf16 v[160:163], a[120:123], a[196:199], v[160:163]
    v_mfma_f32_16x16x32_bf16 v[160:163], a[116:119], a[176:179], v[160:163]
    v_mfma_f32_16x16x32_bf16 v[164:167], a[116:119], a[180:183], 0
    v_mfma_f32_16x16x32_bf16 v[164:167], a[120:123], a[200:203], v[164:167]
    v_mfma_f32_16x16x32_bf16 v[164:167], a[124:127], a[220:223], v[164:167]
    v_mfma_f32_16x16x32_bf16 v[164:167], a[128:131], a[240:243], v[164:167]
    s_waitcnt vmcnt(11)
    v_mfma_f32_16x16x32_bf16 v[168:171], a[132:135], a[164:167], 0
    v_mul_u32_u24 v32, 10240, v6
    s_waitcnt vmcnt(10)
    v_mfma_f32_16x16x32_bf16 v[168:171], a[136:139], a[184:187], v[168:171]
    buffer_load_dwordx4 a[116:119], v3, s[52:55], s25 offen offset:0 sc1
    s_waitcnt vmcnt(10)
    v_mfma_f32_16x16x32_bf16 v[168:171], a[140:143], a[204:207], v[168:171]
    s_waitcnt vmcnt(9)
    v_mfma_f32_16x16x32_bf16 v[168:171], a[144:147], a[224:227], v[168:171]
    v_mfma_f32_16x16x32_bf16 v[172:175], a[144:147], a[228:231], 0
    v_mfma_f32_16x16x32_bf16 v[172:175], a[140:143], a[208:211], v[172:175]
    buffer_load_dwordx4 a[120:123], v3, s[52:55], s25 offen offset:1024 sc1
    v_lshl_add_u32 v32, v34, 3, v32
    v_mfma_f32_16x16x32_bf16 v[172:175], a[136:139], a[188:191], v[172:175]
    v_mfma_f32_16x16x32_bf16 v[172:175], a[132:135], a[168:171], v[172:175]
    v_mfma_f32_16x16x32_bf16 v[176:179], a[132:135], a[172:175], 0
    v_mfma_f32_16x16x32_bf16 v[176:179], a[136:139], a[192:195], v[176:179]
    buffer_load_dwordx4 a[124:127], v3, s[52:55], s25 offen offset:2048 sc1
    v_mfma_f32_16x16x32_bf16 v[176:179], a[140:143], a[212:215], v[176:179]
    v_add_lshl_u32 v6, v32, s5, 1
    v_mfma_f32_16x16x32_bf16 v[176:179], a[144:147], a[232:235], v[176:179]
    v_mfma_f32_16x16x32_bf16 v[180:183], a[144:147], a[236:239], 0
    v_mfma_f32_16x16x32_bf16 v[180:183], a[140:143], a[216:219], v[180:183]
    buffer_load_dwordx4 a[128:131], v3, s[52:55], s25 offen offset:3072 sc1
    v_mfma_f32_16x16x32_bf16 v[180:183], a[136:139], a[196:199], v[180:183]
    v_mfma_f32_16x16x32_bf16 v[180:183], a[132:135], a[176:179], v[180:183]
    s_mul_i32 s0, s64, 5120
    s_lshr_b32 s3, s64, 1
    s_mul_i32 s3, s3, 20480
    s_add_u32 s3, s3, s0
    v_add_u32_e64 v8, s3, v21
    v_mfma_f32_16x16x32_bf16 v[184:187], a[132:135], a[180:183], 0
    v_mfma_f32_16x16x32_bf16 v[184:187], a[136:139], a[200:203], v[184:187]
    v_mfma_f32_16x16x32_bf16 v[184:187], a[140:143], a[220:223], v[184:187]
    v_mfma_f32_16x16x32_bf16 v[184:187], a[144:147], a[240:243], v[184:187]
    s_waitcnt vmcnt(11)
    v_mfma_f32_16x16x32_bf16 v[188:191], a[148:151], a[164:167], 0
    v_add_u32 v9, 81920, v8
    s_waitcnt vmcnt(10)
    v_mfma_f32_16x16x32_bf16 v[188:191], a[152:155], a[184:187], v[188:191]
    buffer_load_dwordx4 a[132:135], v3, s[52:55], s28 offen offset:0 sc1
    s_waitcnt vmcnt(10)
    v_mfma_f32_16x16x32_bf16 v[188:191], a[156:159], a[204:207], v[188:191]
    s_waitcnt vmcnt(9)
    v_mfma_f32_16x16x32_bf16 v[188:191], a[160:163], a[224:227], v[188:191]
    v_mfma_f32_16x16x32_bf16 v[192:195], a[160:163], a[228:231], 0
    v_mfma_f32_16x16x32_bf16 v[192:195], a[156:159], a[208:211], v[192:195]
    buffer_load_dwordx4 a[136:139], v3, s[52:55], s28 offen offset:1024 sc1
    s_add_u32 s0, s0, 10240
    v_add_u32_e64 v10, s0, v21
    v_mfma_f32_16x16x32_bf16 v[192:195], a[152:155], a[188:191], v[192:195]
    v_mfma_f32_16x16x32_bf16 v[192:195], a[148:151], a[168:171], v[192:195]
    v_mfma_f32_16x16x32_bf16 v[196:199], a[148:151], a[172:175], 0
    v_mfma_f32_16x16x32_bf16 v[196:199], a[152:155], a[192:195], v[196:199]
    buffer_load_dwordx4 a[140:143], v3, s[52:55], s28 offen offset:2048 sc1
    v_mfma_f32_16x16x32_bf16 v[196:199], a[156:159], a[212:215], v[196:199]
    v_add_u32 v11, 81920, v10
    v_mfma_f32_16x16x32_bf16 v[196:199], a[160:163], a[232:235], v[196:199]
    v_mfma_f32_16x16x32_bf16 v[200:203], a[160:163], a[236:239], 0
    v_mfma_f32_16x16x32_bf16 v[200:203], a[156:159], a[216:219], v[200:203]
    buffer_load_dwordx4 a[144:147], v3, s[52:55], s28 offen offset:3072 sc1
    v_mfma_f32_16x16x32_bf16 v[200:203], a[152:155], a[196:199], v[200:203]
    v_mfma_f32_16x16x32_bf16 v[200:203], a[148:151], a[176:179], v[200:203]
    s_mov_b64 s[44:45], s[32:33]
    v_mfma_f32_16x16x32_bf16 v[204:207], a[148:151], a[180:183], 0
    v_mfma_f32_16x16x32_bf16 v[204:207], a[152:155], a[200:203], v[204:207]
    v_mfma_f32_16x16x32_bf16 v[204:207], a[156:159], a[220:223], v[204:207]
    v_mfma_f32_16x16x32_bf16 v[204:207], a[160:163], a[240:243], v[204:207]
    s_waitcnt vmcnt(11)
    v_mfma_f32_16x16x32_bf16 v[48:51], a[100:103], a[164:167], 0
    s_mov_b32 s46, 5242880
    s_waitcnt vmcnt(10)
    v_mfma_f32_16x16x32_bf16 v[48:51], a[104:107], a[184:187], v[48:51]
    buffer_load_dwordx4 a[148:151], v3, s[52:55], s29 offen offset:0 sc1
    s_waitcnt vmcnt(10)
    v_mfma_f32_16x16x32_bf16 v[48:51], a[108:111], a[204:207], v[48:51]
    s_waitcnt vmcnt(9)
    v_mfma_f32_16x16x32_bf16 v[48:51], a[112:115], a[224:227], v[48:51]
    v_mfma_f32_16x16x32_bf16 v[52:55], a[112:115], a[228:231], 0
    v_mfma_f32_16x16x32_bf16 v[52:55], a[108:111], a[208:211], v[52:55]
    buffer_load_dwordx4 a[152:155], v3, s[52:55], s29 offen offset:1024 sc1
    v_mfma_f32_16x16x32_bf16 v[52:55], a[104:107], a[188:191], v[52:55]
    s_lshl3_add_u32 s0, s74, s75
    s_lshl1_add_u32 s0, s0, s35
    s_lshl2_add_u32 s0, s0, s64
    v_mfma_f32_16x16x32_bf16 v[52:55], a[100:103], a[168:171], v[52:55]
    v_mfma_f32_16x16x32_bf16 v[56:59], a[100:103], a[172:175], 0
    v_mfma_f32_16x16x32_bf16 v[56:59], a[104:107], a[192:195], v[56:59]
    buffer_load_dwordx4 a[156:159], v3, s[52:55], s29 offen offset:2048 sc1
    v_mfma_f32_16x16x32_bf16 v[56:59], a[108:111], a[212:215], v[56:59]
    v_mfma_f32_16x16x32_bf16 v[56:59], a[112:115], a[232:235], v[56:59]
    v_mfma_f32_16x16x32_bf16 v[60:63], a[112:115], a[236:239], 0
    v_mfma_f32_16x16x32_bf16 v[60:63], a[108:111], a[216:219], v[60:63]
    buffer_load_dwordx4 a[160:163], v3, s[52:55], s29 offen offset:3072 sc1
    s_mul_i32 s3, s0, 5120
    v_add_u32_e64 v15, s3, v21
    v_mfma_f32_16x16x32_bf16 v[60:63], a[104:107], a[196:199], v[60:63]
    v_mfma_f32_16x16x32_bf16 v[60:63], a[100:103], a[176:179], v[60:63]
    v_mfma_f32_16x16x32_bf16 v[64:67], a[100:103], a[180:183], 0
    v_mfma_f32_16x16x32_bf16 v[64:67], a[104:107], a[200:203], v[64:67]
    v_mfma_f32_16x16x32_bf16 v[64:67], a[108:111], a[220:223], v[64:67]
    v_mfma_f32_16x16x32_bf16 v[64:67], a[112:115], a[240:243], v[64:67]
    s_waitcnt vmcnt(11)
    v_mfma_f32_16x16x32_bf16 v[68:71], a[116:119], a[164:167], 0
    s_xor_b32 s3, s0, 4
    s_mul_i32 s3, s3, 5120
    v_add_u32 v14, s3, v21
    s_waitcnt vmcnt(10)
    v_mfma_f32_16x16x32_bf16 v[68:71], a[120:123], a[184:187], v[68:71]
    buffer_load_dwordx4 a[100:103], v12, s[52:55], s10 offen offset:0 sc1
    s_waitcnt vmcnt(10)
    v_mfma_f32_16x16x32_bf16 v[68:71], a[124:127], a[204:207], v[68:71]
    s_waitcnt vmcnt(9)
    v_mfma_f32_16x16x32_bf16 v[68:71], a[128:131], a[224:227], v[68:71]
    v_mfma_f32_16x16x32_bf16 v[72:75], a[128:131], a[228:231], 0
    v_mfma_f32_16x16x32_bf16 v[72:75], a[124:127], a[208:211], v[72:75]
    buffer_load_dwordx4 a[104:107], v12, s[52:55], s10 offen offset:1024 sc1
    s_lshl_b32 s1, s0, 7
    s_add_u32 s1, s1, 18612224
    s_xor_b32 s80, s1, 512
    v_mfma_f32_16x16x32_bf16 v[72:75], a[120:123], a[188:191], v[72:75]
    v_mfma_f32_16x16x32_bf16 v[72:75], a[116:119], a[168:171], v[72:75]
    v_mfma_f32_16x16x32_bf16 v[76:79], a[116:119], a[172:175], 0
    v_mfma_f32_16x16x32_bf16 v[76:79], a[120:123], a[192:195], v[76:79]
    buffer_load_dwordx4 a[108:111], v7, s[52:55], s10 offen offset:2048 sc1
    v_mfma_f32_16x16x32_bf16 v[76:79], a[124:127], a[212:215], v[76:79]
    s_add_u32 s14, s36, s1
    s_addc_u32 s15, s37, 0
    v_mfma_f32_16x16x32_bf16 v[76:79], a[128:131], a[232:235], v[76:79]
    v_mfma_f32_16x16x32_bf16 v[80:83], a[128:131], a[236:239], 0
    v_mfma_f32_16x16x32_bf16 v[80:83], a[124:127], a[216:219], v[80:83]
    buffer_load_dwordx4 a[112:115], v12, s[52:55], s11 offen offset:0 sc1
    v_mfma_f32_16x16x32_bf16 v[80:83], a[120:123], a[196:199], v[80:83]
    v_mfma_f32_16x16x32_bf16 v[80:83], a[116:119], a[176:179], v[80:83]
    s_mov_b32 s76, 12582912
    v_mfma_f32_16x16x32_bf16 v[84:87], a[116:119], a[180:183], 0
    v_mfma_f32_16x16x32_bf16 v[84:87], a[120:123], a[200:203], v[84:87]
    v_mfma_f32_16x16x32_bf16 v[84:87], a[124:127], a[220:223], v[84:87]
    v_mfma_f32_16x16x32_bf16 v[84:87], a[128:131], a[240:243], v[84:87]
    s_waitcnt vmcnt(11)
    v_mfma_f32_16x16x32_bf16 v[88:91], a[132:135], a[164:167], 0
    s_mov_b32 s77, 12587008
    s_waitcnt vmcnt(10)
    v_mfma_f32_16x16x32_bf16 v[88:91], a[136:139], a[184:187], v[88:91]
    buffer_load_dword v28, v29, s[52:55], s4 offen sc1
    s_waitcnt vmcnt(10)
    v_mfma_f32_16x16x32_bf16 v[88:91], a[140:143], a[204:207], v[88:91]
    s_waitcnt vmcnt(9)
    v_mfma_f32_16x16x32_bf16 v[88:91], a[144:147], a[224:227], v[88:91]
    v_mfma_f32_16x16x32_bf16 v[92:95], a[144:147], a[228:231], 0
    buffer_load_dwordx4 a[116:119], v12, s[52:55], s11 offen offset:1024 sc1
    v_mfma_f32_16x16x32_bf16 v[92:95], a[140:143], a[208:211], v[92:95]
    s_mov_b32 s78, 0xffff0000
    v_mfma_f32_16x16x32_bf16 v[92:95], a[136:139], a[188:191], v[92:95]
    v_mfma_f32_16x16x32_bf16 v[92:95], a[132:135], a[168:171], v[92:95]
    buffer_load_dwordx4 a[120:123], v7, s[52:55], s11 offen offset:2048 sc1
    v_mfma_f32_16x16x32_bf16 v[96:99], a[132:135], a[172:175], 0
    v_mfma_f32_16x16x32_bf16 v[96:99], a[136:139], a[192:195], v[96:99]
    v_mfma_f32_16x16x32_bf16 v[96:99], a[140:143], a[212:215], v[96:99]
    s_mov_b32 s79, 0x0c0c0400
    v_mfma_f32_16x16x32_bf16 v[96:99], a[144:147], a[232:235], v[96:99]
    buffer_load_dwordx4 a[124:127], v12, s[52:55], s12 offen offset:0 sc1
    v_mfma_f32_16x16x32_bf16 v[100:103], a[144:147], a[236:239], 0
    v_mfma_f32_16x16x32_bf16 v[100:103], a[140:143], a[216:219], v[100:103]
    v_mfma_f32_16x16x32_bf16 v[100:103], a[136:139], a[196:199], v[100:103]
    buffer_load_dwordx4 a[128:131], v12, s[52:55], s12 offen offset:1024 sc1
    v_mfma_f32_16x16x32_bf16 v[100:103], a[132:135], a[176:179], v[100:103]
    s_and_b32 s3, s34, 0xffff
    v_mov_b32 v17, s3
    v_mfma_f32_16x16x32_bf16 v[104:107], a[132:135], a[180:183], 0
    v_mfma_f32_16x16x32_bf16 v[104:107], a[136:139], a[200:203], v[104:107]
    v_mfma_f32_16x16x32_bf16 v[104:107], a[140:143], a[220:223], v[104:107]
    v_mfma_f32_16x16x32_bf16 v[104:107], a[144:147], a[240:243], v[104:107]
    s_waitcnt vmcnt(12)
    v_mfma_f32_16x16x32_bf16 v[108:111], a[148:151], a[164:167], 0
    s_waitcnt vmcnt(11)
    v_mfma_f32_16x16x32_bf16 v[108:111], a[152:155], a[184:187], v[108:111]
    buffer_load_dwordx4 a[132:135], v7, s[52:55], s12 offen offset:2048 sc1
    s_waitcnt vmcnt(11)
    v_mfma_f32_16x16x32_bf16 v[108:111], a[156:159], a[204:207], v[108:111]
    s_waitcnt vmcnt(10)
    v_mfma_f32_16x16x32_bf16 v[108:111], a[160:163], a[224:227], v[108:111]
    ds_read_b64_tr_b16 a[164:165], v5 offset:10240
    v_mfma_f32_16x16x32_bf16 v[112:115], a[160:163], a[228:231], 0
    ds_read_b64_tr_b16 a[166:167], v5 offset:11520
    ds_read_b64_tr_b16 a[184:185], v5 offset:15360
    v_mfma_f32_16x16x32_bf16 v[112:115], a[156:159], a[208:211], v[112:115]
    buffer_load_dwordx4 a[136:139], v12, s[52:55], s13 offen offset:0 sc1
    ds_read_b64_tr_b16 a[186:187], v5 offset:16640
    v_mfma_f32_16x16x32_bf16 v[112:115], a[152:155], a[188:191], v[112:115]
    ds_read_b64_tr_b16 a[204:205], v5 offset:20480
    ds_read_b64_tr_b16 a[206:207], v5 offset:21760
    v_mfma_f32_16x16x32_bf16 v[112:115], a[148:151], a[168:171], v[112:115]
    ds_read_b64_tr_b16 a[168:169], v5 offset:10272
    v_mfma_f32_16x16x32_bf16 v[116:119], a[148:151], a[172:175], 0
    ds_read_b64_tr_b16 a[170:171], v5 offset:11552
    ds_read_b64_tr_b16 a[188:189], v5 offset:15392
    v_mfma_f32_16x16x32_bf16 v[116:119], a[152:155], a[192:195], v[116:119]
    buffer_load_dwordx4 a[140:143], v12, s[52:55], s13 offen offset:1024 sc1
    ds_read_b64_tr_b16 a[190:191], v5 offset:16672
    v_mfma_f32_16x16x32_bf16 v[116:119], a[156:159], a[212:215], v[116:119]
    ds_read_b64_tr_b16 a[208:209], v5 offset:20512
    ds_read_b64_tr_b16 a[210:211], v5 offset:21792
    v_mfma_f32_16x16x32_bf16 v[116:119], a[160:163], a[232:235], v[116:119]
    ds_read_b64_tr_b16 a[172:173], v5 offset:10304
    v_mfma_f32_16x16x32_bf16 v[120:123], a[160:163], a[236:239], 0
    ds_read_b64_tr_b16 a[174:175], v5 offset:11584
    ds_read_b64_tr_b16 a[192:193], v5 offset:15424
    v_mfma_f32_16x16x32_bf16 v[120:123], a[156:159], a[216:219], v[120:123]
    buffer_load_dwordx4 a[144:147], v7, s[52:55], s13 offen offset:2048 sc1
    ds_read_b64_tr_b16 a[194:195], v5 offset:16704
    v_mfma_f32_16x16x32_bf16 v[120:123], a[152:155], a[196:199], v[120:123]
    ds_read_b64_tr_b16 a[212:213], v5 offset:20544
    ds_read_b64_tr_b16 a[214:215], v5 offset:21824
    v_mfma_f32_16x16x32_bf16 v[120:123], a[148:151], a[176:179], v[120:123]
    ds_read_b64_tr_b16 a[176:177], v5 offset:10336
    v_mfma_f32_16x16x32_bf16 v[124:127], a[148:151], a[180:183], 0
    ds_read_b64_tr_b16 a[178:179], v5 offset:11616
    ds_read_b64_tr_b16 a[196:197], v5 offset:15456
    v_mfma_f32_16x16x32_bf16 v[124:127], a[152:155], a[200:203], v[124:127]
    ds_read_b64_tr_b16 a[198:199], v5 offset:16736
    v_mfma_f32_16x16x32_bf16 v[124:127], a[156:159], a[220:223], v[124:127]
    ds_read_b64_tr_b16 a[216:217], v5 offset:20576
    ds_read_b64_tr_b16 a[218:219], v5 offset:21856
    v_mfma_f32_16x16x32_bf16 v[124:127], a[160:163], a[240:243], v[124:127]
    ds_read_b64_tr_b16 a[180:181], v5 offset:10368
    ds_read_b64_tr_b16 a[182:183], v5 offset:11648
    ds_read_b64_tr_b16 a[200:201], v5 offset:15488
    ds_read_b64_tr_b16 a[202:203], v5 offset:16768
    ds_read_b64_tr_b16 a[220:221], v5 offset:20608
    ds_read_b64_tr_b16 a[222:223], v5 offset:21888
    s_waitcnt vmcnt(12)
    s_waitcnt lgkmcnt(15)
    v_mfma_f32_16x16x32_bf16 v[128:131], a[100:103], a[164:167], v[128:131]
    buffer_load_dwordx4 a[148:151], v12, s[52:55], s24 offen offset:0 sc1
    s_waitcnt vmcnt(12)
    v_mfma_f32_16x16x32_bf16 v[128:131], a[104:107], a[184:187], v[128:131]
    s_waitcnt vmcnt(11)
    v_mfma_f32_16x16x32_bf16 v[128:131], a[108:111], a[204:207], v[128:131]
    s_waitcnt lgkmcnt(15)
    v_mfma_f32_16x16x32_bf16 v[132:135], a[108:111], a[208:211], v[132:135]
    v_mfma_f32_16x16x32_bf16 v[132:135], a[104:107], a[188:191], v[132:135]
    v_mfma_f32_16x16x32_bf16 v[132:135], a[100:103], a[168:171], v[132:135]
    buffer_load_dwordx4 a[152:155], v12, s[52:55], s24 offen offset:1024 sc1
    s_waitcnt lgkmcnt(12)
    v_mfma_f32_16x16x32_bf16 v[136:139], a[100:103], a[172:175], v[136:139]
    v_mfma_f32_16x16x32_bf16 v[136:139], a[104:107], a[192:195], v[136:139]
    v_mfma_f32_16x16x32_bf16 v[136:139], a[108:111], a[212:215], v[136:139]
    s_waitcnt lgkmcnt(6)
    v_mfma_f32_16x16x32_bf16 v[140:143], a[108:111], a[216:219], v[140:143]
    buffer_load_dwordx4 a[156:159], v7, s[52:55], s24 offen offset:2048 sc1
    v_mfma_f32_16x16x32_bf16 v[140:143], a[104:107], a[196:199], v[140:143]
    s_waitcnt vmcnt(11)
    v_cmp_ne_u32 vcc, s34, v28
    v_mfma_f32_16x16x32_bf16 v[140:143], a[100:103], a[176:179], v[140:143]
    s_waitcnt lgkmcnt(0)
    v_mfma_f32_16x16x32_bf16 v[144:147], a[100:103], a[180:183], v[144:147]
    v_mfma_f32_16x16x32_bf16 v[144:147], a[104:107], a[200:203], v[144:147]
    v_mfma_f32_16x16x32_bf16 v[144:147], a[108:111], a[220:223], v[144:147]
    s_cbranch_vccnz L_ps
L_psd:
    v_mfma_f32_16x16x32_bf16 v[148:151], a[112:115], a[164:167], v[148:151]
    buffer_load_dwordx4 a[160:163], v13, s[52:55], s10 offen offset:0 sc1
    s_waitcnt vmcnt(11)
    v_mfma_f32_16x16x32_bf16 v[148:151], a[116:119], a[184:187], v[148:151]
    s_waitcnt vmcnt(10)
    v_mfma_f32_16x16x32_bf16 v[148:151], a[120:123], a[204:207], v[148:151]
    v_mfma_f32_16x16x32_bf16 v[152:155], a[120:123], a[208:211], v[152:155]
    buffer_load_dwordx4 a[100:103], v4, s[52:55], s10 offen offset:0 sc1
    v_mfma_f32_16x16x32_bf16 v[152:155], a[116:119], a[188:191], v[152:155]
    v_mfma_f32_16x16x32_bf16 v[152:155], a[112:115], a[168:171], v[152:155]
    v_mfma_f32_16x16x32_bf16 v[156:159], a[112:115], a[172:175], v[156:159]
    v_mfma_f32_16x16x32_bf16 v[156:159], a[116:119], a[192:195], v[156:159]
    buffer_load_dwordx4 a[104:107], v4, s[52:55], s10 offen offset:1024 sc1
    v_mfma_f32_16x16x32_bf16 v[156:159], a[120:123], a[212:215], v[156:159]
    v_mfma_f32_16x16x32_bf16 v[160:163], a[120:123], a[216:219], v[160:163]
    v_mfma_f32_16x16x32_bf16 v[160:163], a[116:119], a[196:199], v[160:163]
    buffer_load_dwordx4 a[108:111], v4, s[52:55], s10 offen offset:2048 sc1
    v_mfma_f32_16x16x32_bf16 v[160:163], a[112:115], a[176:179], v[160:163]
    v_mfma_f32_16x16x32_bf16 v[164:167], a[112:115], a[180:183], v[164:167]
    v_mfma_f32_16x16x32_bf16 v[164:167], a[116:119], a[200:203], v[164:167]
    v_mfma_f32_16x16x32_bf16 v[164:167], a[120:123], a[220:223], v[164:167]
    s_waitcnt vmcnt(12)
    v_mfma_f32_16x16x32_bf16 v[168:171], a[124:127], a[164:167], v[168:171]
    buffer_load_dwordx4 a[112:115], v4, s[52:55], s10 offen offset:3072 sc1
    s_waitcnt vmcnt(12)
    v_mfma_f32_16x16x32_bf16 v[168:171], a[128:131], a[184:187], v[168:171]
    s_waitcnt vmcnt(11)
    v_mfma_f32_16x16x32_bf16 v[168:171], a[132:135], a[204:207], v[168:171]
    v_mfma_f32_16x16x32_bf16 v[172:175], a[132:135], a[208:211], v[172:175]
    v_mfma_f32_16x16x32_bf16 v[172:175], a[128:131], a[188:191], v[172:175]
    v_mfma_f32_16x16x32_bf16 v[172:175], a[124:127], a[168:171], v[172:175]
    buffer_load_dwordx4 a[116:119], v13, s[52:55], s11 offen offset:0 sc1
    v_mfma_f32_16x16x32_bf16 v[176:179], a[124:127], a[172:175], v[176:179]
    v_mfma_f32_16x16x32_bf16 v[176:179], a[128:131], a[192:195], v[176:179]
    v_mfma_f32_16x16x32_bf16 v[176:179], a[132:135], a[212:215], v[176:179]
    v_mfma_f32_16x16x32_bf16 v[180:183], a[132:135], a[216:219], v[180:183]
    buffer_load_dwordx4 a[120:123], v4, s[52:55], s11 offen offset:0 sc1
    v_mfma_f32_16x16x32_bf16 v[180:183], a[128:131], a[196:199], v[180:183]
    v_mfma_f32_16x16x32_bf16 v[180:183], a[124:127], a[176:179], v[180:183]
    v_mfma_f32_16x16x32_bf16 v[184:187], a[124:127], a[180:183], v[184:187]
    v_mfma_f32_16x16x32_bf16 v[184:187], a[128:131], a[200:203], v[184:187]
    v_mfma_f32_16x16x32_bf16 v[184:187], a[132:135], a[220:223], v[184:187]
    s_waitcnt vmcnt(12)
    v_mfma_f32_16x16x32_bf16 v[188:191], a[136:139], a[164:167], v[188:191]
    buffer_load_dwordx4 a[124:127], v4, s[52:55], s11 offen offset:1024 sc1
    s_waitcnt vmcnt(12)
    v_mfma_f32_16x16x32_bf16 v[188:191], a[140:143], a[184:187], v[188:191]
    s_waitcnt vmcnt(11)
    v_mfma_f32_16x16x32_bf16 v[188:191], a[144:147], a[204:207], v[188:191]
    v_mfma_f32_16x16x32_bf16 v[192:195], a[144:147], a[208:211], v[192:195]
    v_mfma_f32_16x16x32_bf16 v[192:195], a[140:143], a[188:191], v[192:195]
    v_mfma_f32_16x16x32_bf16 v[192:195], a[136:139], a[168:171], v[192:195]
    buffer_load_dwordx4 a[128:131], v4, s[52:55], s11 offen offset:2048 sc1
    v_mfma_f32_16x16x32_bf16 v[196:199], a[136:139], a[172:175], v[196:199]
    v_mfma_f32_16x16x32_bf16 v[196:199], a[140:143], a[192:195], v[196:199]
    v_mfma_f32_16x16x32_bf16 v[196:199], a[144:147], a[212:215], v[196:199]
    v_mfma_f32_16x16x32_bf16 v[200:203], a[144:147], a[216:219], v[200:203]
    buffer_load_dwordx4 a[132:135], v4, s[52:55], s11 offen offset:3072 sc1
    v_mfma_f32_16x16x32_bf16 v[200:203], a[140:143], a[196:199], v[200:203]
    v_mfma_f32_16x16x32_bf16 v[200:203], a[136:139], a[176:179], v[200:203]
    v_mfma_f32_16x16x32_bf16 v[204:207], a[136:139], a[180:183], v[204:207]
    v_mfma_f32_16x16x32_bf16 v[204:207], a[140:143], a[200:203], v[204:207]
    v_mfma_f32_16x16x32_bf16 v[204:207], a[144:147], a[220:223], v[204:207]
    s_waitcnt vmcnt(12)
    v_mfma_f32_16x16x32_bf16 v[48:51], a[148:151], a[164:167], v[48:51]
    buffer_load_dwordx4 a[136:139], v13, s[52:55], s12 offen offset:0 sc1
    s_waitcnt vmcnt(12)
    v_mfma_f32_16x16x32_bf16 v[48:51], a[152:155], a[184:187], v[48:51]
    s_waitcnt vmcnt(11)
    v_mfma_f32_16x16x32_bf16 v[48:51], a[156:159], a[204:207], v[48:51]
    v_mfma_f32_16x16x32_bf16 v[52:55], a[156:159], a[208:211], v[52:55]
    v_mfma_f32_16x16x32_bf16 v[52:55], a[152:155], a[188:191], v[52:55]
    v_mfma_f32_16x16x32_bf16 v[52:55], a[148:151], a[168:171], v[52:55]
    buffer_load_dwordx4 a[140:143], v4, s[52:55], s12 offen offset:0 sc1
    v_mfma_f32_16x16x32_bf16 v[56:59], a[148:151], a[172:175], v[56:59]
    v_mfma_f32_16x16x32_bf16 v[56:59], a[152:155], a[192:195], v[56:59]
    v_mfma_f32_16x16x32_bf16 v[56:59], a[156:159], a[212:215], v[56:59]
    v_mfma_f32_16x16x32_bf16 v[60:63], a[156:159], a[216:219], v[60:63]
    buffer_load_dwordx4 a[144:147], v4, s[52:55], s12 offen offset:1024 sc1
    v_mfma_f32_16x16x32_bf16 v[60:63], a[152:155], a[196:199], v[60:63]
    v_mfma_f32_16x16x32_bf16 v[60:63], a[148:151], a[176:179], v[60:63]
    v_mfma_f32_16x16x32_bf16 v[64:67], a[148:151], a[180:183], v[64:67]
    v_mfma_f32_16x16x32_bf16 v[64:67], a[152:155], a[200:203], v[64:67]
    v_mfma_f32_16x16x32_bf16 v[64:67], a[156:159], a[220:223], v[64:67]
    s_waitcnt vmcnt(12)
    s_mov_b32 m0, s73
    v_mfma_f32_16x16x32_bf16 v[128:131], a[160:163], a[0:3], v[128:131]
    s_waitcnt vmcnt(11)
    v_mfma_f32_16x16x32_bf16 v[128:131], a[100:103], a[20:23], v[128:131]
    v_lshl_add_u32 v29, s64, 6, v0
    v_lshlrev_b32 v29, 7, v29
    v_add_u32 v29, 18415616, v29
    s_cmp_lg_u32 s2, 0
    s_cbranch_scc1 L_epi
    buffer_load_dword v28, v29, s[52:55], 0 offen sc1
L_epi:
    s_waitcnt vmcnt(10)
    v_mfma_f32_16x16x32_bf16 v[128:131], a[104:107], a[40:43], v[128:131]
    s_waitcnt vmcnt(9)
    v_mfma_f32_16x16x32_bf16 v[128:131], a[108:111], a[60:63], v[128:131]
    s_waitcnt vmcnt(8)
    v_mfma_f32_16x16x32_bf16 v[128:131], a[112:115], a[80:83], v[128:131]
    v_mfma_f32_16x16x32_bf16 v[132:135], a[112:115], a[84:87], v[132:135]
    v_mfma_f32_16x16x32_bf16 v[132:135], a[108:111], a[64:67], v[132:135]
    buffer_load_dwordx4 a[148:151], v4, s[52:55], s12 offen offset:2048 sc1
    v_mfma_f32_16x16x32_bf16 v[132:135], a[104:107], a[44:47], v[132:135]
    v_mfma_f32_16x16x32_bf16 v[132:135], a[100:103], a[24:27], v[132:135]
    v_mfma_f32_16x16x32_bf16 v[132:135], a[160:163], a[4:7], v[132:135]
    v_mfma_f32_16x16x32_bf16 v[136:139], a[160:163], a[8:11], v[136:139]
    v_mfma_f32_16x16x32_bf16 v[136:139], a[100:103], a[28:31], v[136:139]
    buffer_load_dwordx4 a[152:155], v4, s[52:55], s12 offen offset:3072 sc1
    v_mfma_f32_16x16x32_bf16 v[136:139], a[104:107], a[48:51], v[136:139]
    v_mfma_f32_16x16x32_bf16 v[136:139], a[108:111], a[68:71], v[136:139]
    v_mfma_f32_16x16x32_bf16 v[136:139], a[112:115], a[88:91], v[136:139]
    v_mfma_f32_16x16x32_bf16 v[140:143], a[112:115], a[92:95], v[140:143]
    v_mfma_f32_16x16x32_bf16 v[140:143], a[108:111], a[72:75], v[140:143]
    v_mfma_f32_16x16x32_bf16 v[140:143], a[104:107], a[52:55], v[140:143]
    buffer_load_dwordx4 a[156:159], v13, s[52:55], s13 offen offset:0 sc1
    v_mfma_f32_16x16x32_bf16 v[140:143], a[100:103], a[32:35], v[140:143]
    v_mfma_f32_16x16x32_bf16 v[140:143], a[160:163], a[12:15], v[140:143]
    v_mfma_f32_16x16x32_bf16 v[144:147], a[160:163], a[16:19], v[144:147]
    v_mfma_f32_16x16x32_bf16 v[144:147], a[100:103], a[36:39], v[144:147]
    v_mfma_f32_16x16x32_bf16 v[144:147], a[104:107], a[56:59], v[144:147]
    v_mfma_f32_16x16x32_bf16 v[144:147], a[108:111], a[76:79], v[144:147]
    v_mfma_f32_16x16x32_bf16 v[144:147], a[112:115], a[96:99], v[144:147]
    s_waitcnt vmcnt(10)
    v_mfma_f32_16x16x32_bf16 v[148:151], a[116:119], a[0:3], v[148:151]
    s_waitcnt vmcnt(9)
    v_mfma_f32_16x16x32_bf16 v[148:151], a[120:123], a[20:23], v[148:151]
    buffer_load_dwordx4 a[160:163], v4, s[52:55], s13 offen offset:0 sc1
    ds_write_addtid_b32 v128 offset:0
    ds_write_addtid_b32 v129 offset:256
    s_waitcnt vmcnt(9)
    v_mfma_f32_16x16x32_bf16 v[148:151], a[124:127], a[40:43], v[148:151]
    ds_write_addtid_b32 v130 offset:512
    s_waitcnt vmcnt(8)
    v_mfma_f32_16x16x32_bf16 v[148:151], a[128:131], a[60:63], v[148:151]
    ds_write_addtid_b32 v131 offset:768
    s_waitcnt vmcnt(7)
    v_mfma_f32_16x16x32_bf16 v[148:151], a[132:135], a[80:83], v[148:151]
    ds_write_addtid_b32 v132 offset:1024
    v_mfma_f32_16x16x32_bf16 v[152:155], a[132:135], a[84:87], v[152:155]
    buffer_load_dwordx4 a[100:103], v4, s[52:55], s13 offen offset:1024 sc1
    ds_write_addtid_b32 v133 offset:1280
    v_mfma_f32_16x16x32_bf16 v[152:155], a[128:131], a[64:67], v[152:155]
    ds_write_addtid_b32 v134 offset:1536
    v_mfma_f32_16x16x32_bf16 v[152:155], a[124:127], a[44:47], v[152:155]
    ds_write_addtid_b32 v135 offset:1792
    v_mfma_f32_16x16x32_bf16 v[152:155], a[120:123], a[24:27], v[152:155]
    ds_write_addtid_b32 v136 offset:2048
    v_mfma_f32_16x16x32_bf16 v[152:155], a[116:119], a[4:7], v[152:155]
    buffer_load_dwordx4 a[104:107], v4, s[52:55], s13 offen offset:2048 sc1
    ds_write_addtid_b32 v137 offset:2304
    v_mfma_f32_16x16x32_bf16 v[156:159], a[116:119], a[8:11], v[156:159]
    ds_write_addtid_b32 v138 offset:2560
    v_mfma_f32_16x16x32_bf16 v[156:159], a[120:123], a[28:31], v[156:159]
    ds_write_addtid_b32 v139 offset:2816
    v_mfma_f32_16x16x32_bf16 v[156:159], a[124:127], a[48:51], v[156:159]
    ds_write_addtid_b32 v140 offset:3072
    v_mfma_f32_16x16x32_bf16 v[156:159], a[128:131], a[68:71], v[156:159]
    ds_write_addtid_b32 v141 offset:3328
    v_mfma_f32_16x16x32_bf16 v[156:159], a[132:135], a[88:91], v[156:159]
    buffer_load_dwordx4 a[108:111], v4, s[52:55], s13 offen offset:3072 sc1
    ds_write_addtid_b32 v142 offset:3584
    v_mfma_f32_16x16x32_bf16 v[160:163], a[132:135], a[92:95], v[160:163]
    ds_write_addtid_b32 v143 offset:3840
    v_mfma_f32_16x16x32_bf16 v[160:163], a[128:131], a[72:75], v[160:163]
    ds_write_addtid_b32 v144 offset:4096
    v_mfma_f32_16x16x32_bf16 v[160:163], a[124:127], a[52:55], v[160:163]
    ds_write_addtid_b32 v145 offset:4352
    v_mfma_f32_16x16x32_bf16 v[160:163], a[120:123], a[32:35], v[160:163]
    buffer_load_dwordx4 a[112:115], v12, s[52:55], s25 offen offset:0 sc1
    ds_write_addtid_b32 v146 offset:4608
    v_mfma_f32_16x16x32_bf16 v[160:163], a[116:119], a[12:15], v[160:163]
    ds_write_addtid_b32 v147 offset:4864
    v_mfma_f32_16x16x32_bf16 v[164:167], a[116:119], a[16:19], v[164:167]
    v_mfma_f32_16x16x32_bf16 v[164:167], a[120:123], a[36:39], v[164:167]
    v_mfma_f32_16x16x32_bf16 v[164:167], a[124:127], a[56:59], v[164:167]
    v_mfma_f32_16x16x32_bf16 v[164:167], a[128:131], a[76:79], v[164:167]
    v_mfma_f32_16x16x32_bf16 v[164:167], a[132:135], a[96:99], v[164:167]
    s_waitcnt vmcnt(10)
    v_mfma_f32_16x16x32_bf16 v[168:171], a[136:139], a[0:3], v[168:171]
    s_waitcnt vmcnt(9)
    v_mfma_f32_16x16x32_bf16 v[168:171], a[140:143], a[20:23], v[168:171]
    buffer_load_dwordx4 a[116:119], v12, s[52:55], s25 offen offset:1024 sc1
    ds_write_addtid_b32 v148 offset:5120
    ds_write_addtid_b32 v149 offset:5376
    s_waitcnt vmcnt(9)
    v_mfma_f32_16x16x32_bf16 v[168:171], a[144:147], a[40:43], v[168:171]
    ds_write_addtid_b32 v150 offset:5632
    s_waitcnt vmcnt(8)
    v_mfma_f32_16x16x32_bf16 v[168:171], a[148:151], a[60:63], v[168:171]
    ds_write_addtid_b32 v151 offset:5888
    s_waitcnt vmcnt(7)
    v_mfma_f32_16x16x32_bf16 v[168:171], a[152:155], a[80:83], v[168:171]
    ds_write_addtid_b32 v152 offset:6144
    v_mfma_f32_16x16x32_bf16 v[172:175], a[152:155], a[84:87], v[172:175]
    buffer_load_dwordx4 a[120:123], v7, s[52:55], s25 offen offset:2048 sc1
    ds_write_addtid_b32 v153 offset:6400
    v_mfma_f32_16x16x32_bf16 v[172:175], a[148:151], a[64:67], v[172:175]
    ds_write_addtid_b32 v154 offset:6656
    v_mfma_f32_16x16x32_bf16 v[172:175], a[144:147], a[44:47], v[172:175]
    ds_write_addtid_b32 v155 offset:6912
    v_mfma_f32_16x16x32_bf16 v[172:175], a[140:143], a[24:27], v[172:175]
    ds_write_addtid_b32 v156 offset:7168
    v_mfma_f32_16x16x32_bf16 v[172:175], a[136:139], a[4:7], v[172:175]
    buffer_load_dwordx4 a[124:127], v12, s[52:55], s28 offen offset:0 sc1
    ds_write_addtid_b32 v157 offset:7424
    v_mfma_f32_16x16x32_bf16 v[176:179], a[136:139], a[8:11], v[176:179]
    ds_write_addtid_b32 v158 offset:7680
    v_mfma_f32_16x16x32_bf16 v[176:179], a[140:143], a[28:31], v[176:179]
    ds_write_addtid_b32 v159 offset:7936
    v_mfma_f32_16x16x32_bf16 v[176:179], a[144:147], a[48:51], v[176:179]
    ds_write_addtid_b32 v160 offset:8192
    v_mfma_f32_16x16x32_bf16 v[176:179], a[148:151], a[68:71], v[176:179]
    ds_write_addtid_b32 v161 offset:8448
    v_mfma_f32_16x16x32_bf16 v[176:179], a[152:155], a[88:91], v[176:179]
    buffer_load_dwordx4 a[128:131], v12, s[52:55], s28 offen offset:1024 sc1
    ds_write_addtid_b32 v162 offset:8704
    v_mfma_f32_16x16x32_bf16 v[180:183], a[152:155], a[92:95], v[180:183]
    ds_write_addtid_b32 v163 offset:8960
    v_mfma_f32_16x16x32_bf16 v[180:183], a[148:151], a[72:75], v[180:183]
    ds_write_addtid_b32 v164 offset:9216
    v_mfma_f32_16x16x32_bf16 v[180:183], a[144:147], a[52:55], v[180:183]
    ds_write_addtid_b32 v165 offset:9472
    v_mfma_f32_16x16x32_bf16 v[180:183], a[140:143], a[32:35], v[180:183]
    buffer_load_dwordx4 a[132:135], v7, s[52:55], s28 offen offset:2048 sc1
    ds_write_addtid_b32 v166 offset:9728
    v_mfma_f32_16x16x32_bf16 v[180:183], a[136:139], a[12:15], v[180:183]
    ds_write_addtid_b32 v167 offset:9984
    v_mfma_f32_16x16x32_bf16 v[184:187], a[136:139], a[16:19], v[184:187]
    v_mfma_f32_16x16x32_bf16 v[184:187], a[140:143], a[36:39], v[184:187]
    v_mfma_f32_16x16x32_bf16 v[184:187], a[144:147], a[56:59], v[184:187]
    v_mfma_f32_16x16x32_bf16 v[184:187], a[148:151], a[76:79], v[184:187]
    v_mfma_f32_16x16x32_bf16 v[184:187], a[152:155], a[96:99], v[184:187]
    s_waitcnt vmcnt(10)
    v_mfma_f32_16x16x32_bf16 v[188:191], a[156:159], a[0:3], v[188:191]
    s_waitcnt vmcnt(9)
    v_mfma_f32_16x16x32_bf16 v[188:191], a[160:163], a[20:23], v[188:191]
    buffer_load_dwordx4 a[136:139], v12, s[52:55], s29 offen offset:0 sc1
    ds_write_addtid_b32 v168 offset:30720
    ds_write_addtid_b32 v169 offset:30976
    s_waitcnt vmcnt(9)
    v_mfma_f32_16x16x32_bf16 v[188:191], a[100:103], a[40:43], v[188:191]
    ds_write_addtid_b32 v170 offset:31232
    s_waitcnt vmcnt(8)
    v_mfma_f32_16x16x32_bf16 v[188:191], a[104:107], a[60:63], v[188:191]
    ds_write_addtid_b32 v171 offset:31488
    s_waitcnt vmcnt(7)
    v_mfma_f32_16x16x32_bf16 v[188:191], a[108:111], a[80:83], v[188:191]
    ds_write_addtid_b32 v172 offset:31744
    v_mfma_f32_16x16x32_bf16 v[192:195], a[108:111], a[84:87], v[192:195]
    buffer_load_dwordx4 a[140:143], v12, s[52:55], s29 offen offset:1024 sc1
    ds_write_addtid_b32 v173 offset:32000
    v_mfma_f32_16x16x32_bf16 v[192:195], a[104:107], a[64:67], v[192:195]
    ds_write_addtid_b32 v174 offset:32256
    v_mfma_f32_16x16x32_bf16 v[192:195], a[100:103], a[44:47], v[192:195]
    ds_write_addtid_b32 v175 offset:32512
    v_mfma_f32_16x16x32_bf16 v[192:195], a[160:163], a[24:27], v[192:195]
    ds_write_addtid_b32 v176 offset:32768
    v_mfma_f32_16x16x32_bf16 v[192:195], a[156:159], a[4:7], v[192:195]
    buffer_load_dwordx4 a[144:147], v7, s[52:55], s29 offen offset:2048 sc1
    ds_write_addtid_b32 v177 offset:33024
    v_mfma_f32_16x16x32_bf16 v[196:199], a[156:159], a[8:11], v[196:199]
    ds_write_addtid_b32 v178 offset:33280
    v_mfma_f32_16x16x32_bf16 v[196:199], a[160:163], a[28:31], v[196:199]
    ds_write_addtid_b32 v179 offset:33536
    v_mfma_f32_16x16x32_bf16 v[196:199], a[100:103], a[48:51], v[196:199]
    ds_write_addtid_b32 v180 offset:33792
    v_mfma_f32_16x16x32_bf16 v[196:199], a[104:107], a[68:71], v[196:199]
    ds_write_addtid_b32 v181 offset:34048
    v_mfma_f32_16x16x32_bf16 v[196:199], a[108:111], a[88:91], v[196:199]
    buffer_load_dwordx4 a[148:151], v13, s[52:55], s24 offen offset:0 sc1
    ds_write_addtid_b32 v182 offset:34304
    v_mfma_f32_16x16x32_bf16 v[200:203], a[108:111], a[92:95], v[200:203]
    ds_write_addtid_b32 v183 offset:34560
    v_mfma_f32_16x16x32_bf16 v[200:203], a[104:107], a[72:75], v[200:203]
    ds_write_addtid_b32 v184 offset:34816
    v_mfma_f32_16x16x32_bf16 v[200:203], a[100:103], a[52:55], v[200:203]
    ds_write_addtid_b32 v185 offset:35072
    v_mfma_f32_16x16x32_bf16 v[200:203], a[160:163], a[32:35], v[200:203]
    buffer_load_dwordx4 a[152:155], v4, s[52:55], s24 offen offset:0 sc1
    ds_write_addtid_b32 v186 offset:35328
    v_mfma_f32_16x16x32_bf16 v[200:203], a[156:159], a[12:15], v[200:203]
    ds_write_addtid_b32 v187 offset:35584
    v_mfma_f32_16x16x32_bf16 v[204:207], a[156:159], a[16:19], v[204:207]
    v_mfma_f32_16x16x32_bf16 v[204:207], a[160:163], a[36:39], v[204:207]
    v_mfma_f32_16x16x32_bf16 v[204:207], a[100:103], a[56:59], v[204:207]
    v_mfma_f32_16x16x32_bf16 v[204:207], a[104:107], a[76:79], v[204:207]
    v_mfma_f32_16x16x32_bf16 v[204:207], a[108:111], a[96:99], v[204:207]
    s_waitcnt vmcnt(10)
    v_mfma_f32_16x16x32_bf16 v[68:71], a[112:115], a[164:167], v[68:71]
    buffer_load_dwordx4 a[156:159], v4, s[52:55], s24 offen offset:1024 sc1
    ds_write_addtid_b32 v188 offset:35840
    s_waitcnt vmcnt(10)
    v_mfma_f32_16x16x32_bf16 v[68:71], a[116:119], a[184:187], v[68:71]
    ds_write_addtid_b32 v189 offset:36096
    ds_write_addtid_b32 v190 offset:36352
    s_waitcnt vmcnt(9)
    v_mfma_f32_16x16x32_bf16 v[68:71], a[120:123], a[204:207], v[68:71]
    ds_write_addtid_b32 v191 offset:36608
    ds_write_addtid_b32 v192 offset:36864
    v_mfma_f32_16x16x32_bf16 v[72:75], a[120:123], a[208:211], v[72:75]
    buffer_load_dwordx4 a[160:163], v4, s[52:55], s24 offen offset:2048 sc1
    ds_write_addtid_b32 v193 offset:37120
    v_mfma_f32_16x16x32_bf16 v[72:75], a[116:119], a[188:191], v[72:75]
    ds_write_addtid_b32 v194 offset:37376
    ds_write_addtid_b32 v195 offset:37632
    v_mfma_f32_16x16x32_bf16 v[72:75], a[112:115], a[168:171], v[72:75]
    buffer_load_dwordx4 a[100:103], v4, s[52:55], s24 offen offset:3072 sc1
    ds_write_addtid_b32 v196 offset:37888
    ds_write_addtid_b32 v197 offset:38144
    v_mfma_f32_16x16x32_bf16 v[76:79], a[112:115], a[172:175], v[76:79]
    ds_write_addtid_b32 v198 offset:38400
    ds_write_addtid_b32 v199 offset:38656
    v_mfma_f32_16x16x32_bf16 v[76:79], a[116:119], a[192:195], v[76:79]
    ds_write_addtid_b32 v200 offset:38912
    v_mfma_f32_16x16x32_bf16 v[76:79], a[120:123], a[212:215], v[76:79]
    buffer_load_dwordx4 a[104:107], v13, s[52:55], s25 offen offset:0 sc1
    ds_write_addtid_b32 v201 offset:39168
    ds_write_addtid_b32 v202 offset:39424
    v_mfma_f32_16x16x32_bf16 v[80:83], a[120:123], a[216:219], v[80:83]
    ds_write_addtid_b32 v203 offset:39680
    ds_write_addtid_b32 v204 offset:39936
    v_mfma_f32_16x16x32_bf16 v[80:83], a[116:119], a[196:199], v[80:83]
    buffer_load_dwordx4 a[108:111], v4, s[52:55], s25 offen offset:0 sc1
    ds_write_addtid_b32 v205 offset:40192
    ds_write_addtid_b32 v206 offset:40448
    v_mfma_f32_16x16x32_bf16 v[80:83], a[112:115], a[176:179], v[80:83]
    ds_write_addtid_b32 v207 offset:40704
    v_mfma_f32_16x16x32_bf16 v[84:87], a[112:115], a[180:183], v[84:87]
    v_mfma_f32_16x16x32_bf16 v[84:87], a[116:119], a[200:203], v[84:87]
    v_mfma_f32_16x16x32_bf16 v[84:87], a[120:123], a[220:223], v[84:87]
    s_waitcnt vmcnt(12) lgkmcnt(0)
    s_cmp_lg_u32 s2, 0
    s_cbranch_scc1 L_epd
    v_cmp_ne_u32 vcc, s34, v28
    s_cbranch_vccz L_epd
    s_mov_b32 s3, 0
L_epl:
    buffer_load_dword v28, v29, s[52:55], 0 offen sc1
    s_waitcnt vmcnt(0)
    v_cmp_ne_u32 vcc, s34, v28
    s_add_u32 s3, s3, 1
    s_cmp_ge_u32 s3, 400000
    s_cbranch_scc1 L_epd
    s_cbranch_vccnz L_epl
L_epd:
    s_barrier
    s_or_b32 s3, s2, s64
    s_cbranch_scc1 L_eps
    s_mov_b32 s3, 18448384
    s_mov_b64 exec, 0xff
    buffer_store_dwordx4 a[252:255], v21, s[52:55], s3 offen sc1
    s_mov_b64 exec, -1
L_eps:
    v_mfma_f32_16x16x32_bf16 v[88:91], a[124:127], a[164:167], v[88:91]
    buffer_load_dwordx4 a[112:115], v4, s[52:55], s25 offen offset:1024 sc1
    ds_read_b128 v[128:131], v8 offset:0
    ds_read_b128 v[132:135], v8 offset:40960
    ds_read_b128 v[136:139], v9 offset:0
    ds_read_b128 v[140:143], v9 offset:40960
    s_waitcnt vmcnt(12)
    v_mfma_f32_16x16x32_bf16 v[88:91], a[128:131], a[184:187], v[88:91]
    ds_read_b128 v[144:147], v8 offset:1024
    ds_read_b128 v[148:151], v8 offset:41984
    ds_read_b128 v[152:155], v9 offset:1024
    s_waitcnt vmcnt(11)
    v_mfma_f32_16x16x32_bf16 v[88:91], a[132:135], a[204:207], v[88:91]
    ds_read_b128 v[156:159], v9 offset:41984
    ds_read_b128 v[160:163], v8 offset:2048
    ds_read_b128 v[164:167], v8 offset:43008
    ds_read_b128 v[168:171], v9 offset:2048
    v_mfma_f32_16x16x32_bf16 v[92:95], a[132:135], a[208:211], v[92:95]
    ds_read_b128 v[172:175], v9 offset:43008
    s_waitcnt lgkmcnt(8)
    ds_read_b128 v[176:179], v8 offset:3072
    v_mfma_f32_16x16x32_bf16 v[92:95], a[128:131], a[188:191], v[92:95]
    ds_read_b128 v[180:183], v8 offset:44032
    ds_read_b128 v[184:187], v9 offset:3072
    ds_read_b128 v[188:191], v9 offset:44032
    v_add_f32 v128, v128, v132
    v_mfma_f32_16x16x32_bf16 v[92:95], a[124:127], a[168:171], v[92:95]
    buffer_load_dwordx4 a[116:119], v4, s[52:55], s25 offen offset:2048 sc1
    v_add_f32 v136, v136, v140
    v_add_f32 v129, v129, v133
    v_add_f32_e64 v137, v137, v141
    v_mfma_f32_16x16x32_bf16 v[96:99], a[124:127], a[172:175], v[96:99]
    v_add_f32 v130, v130, v134
    v_add_f32 v138, v138, v142
    v_add_f32 v131, v131, v135
    v_add_f32 v139, v139, v143
    v_mfma_f32_16x16x32_bf16 v[96:99], a[128:131], a[192:195], v[96:99]
    v_add_f32 v128, v128, v136
    v_add_f32 v129, v129, v137
    v_add_f32_e64 v130, v130, v138
    v_mfma_f32_16x16x32_bf16 v[96:99], a[132:135], a[212:215], v[96:99]
    v_add_f32 v131, v131, v139
    s_waitcnt lgkmcnt(8)
    ds_read_b128 v[192:195], v8 offset:4096
    ds_read_b128 v[196:199], v8 offset:45056
    v_mfma_f32_16x16x32_bf16 v[100:103], a[132:135], a[216:219], v[100:103]
    buffer_load_dwordx4 a[120:123], v4, s[52:55], s25 offen offset:3072 sc1
    ds_read_b128 v[200:203], v9 offset:4096
    ds_read_b128 v[204:207], v9 offset:45056
    v_add_f32_e64 v144, v144, v148
    v_mfma_f32_16x16x32_bf16 v[100:103], a[128:131], a[196:199], v[100:103]
    v_add_f32 v152, v152, v156
    v_add_f32 v145, v145, v149
    v_add_f32 v153, v153, v157
    v_add_f32 v146, v146, v150
    v_mfma_f32_16x16x32_bf16 v[100:103], a[124:127], a[176:179], v[100:103]
    v_add_f32 v154, v154, v158
    v_add_f32 v147, v147, v151
    v_add_f32_e64 v155, v155, v159
    v_mfma_f32_16x16x32_bf16 v[104:107], a[124:127], a[180:183], v[104:107]
    v_add_f32 v144, v144, v152
    v_add_f32 v145, v145, v153
    v_add_f32 v146, v146, v154
    v_add_f32 v147, v147, v155
    v_mfma_f32_16x16x32_bf16 v[104:107], a[128:131], a[200:203], v[104:107]
    v_cvt_pk_bf16_f32 v148, v128, v128
    v_cvt_pk_bf16_f32 v149, v129, v130
    v_cvt_pk_bf16_f32 v150, v131, v144
    v_mfma_f32_16x16x32_bf16 v[104:107], a[132:135], a[220:223], v[104:107]
    v_cvt_pk_bf16_f32 v151, v145, v146
    v_and_or_b32 v148, v148, s78, v17
    buffer_store_dwordx4 v[148:151], v14, s[52:55], s76 offen offset:0 sc1
    s_waitcnt vmcnt(13)
    v_mfma_f32_16x16x32_bf16 v[108:111], a[136:139], a[164:167], v[108:111]
    buffer_load_dwordx4 a[124:127], v13, s[52:55], s28 offen offset:0 sc1
    s_waitcnt lgkmcnt(8)
    v_add_f32 v160, v160, v164
    v_add_f32 v168, v168, v172
    v_add_f32 v161, v161, v165
    s_waitcnt vmcnt(13)
    v_mfma_f32_16x16x32_bf16 v[108:111], a[140:143], a[184:187], v[108:111]
    v_add_f32 v169, v169, v173
    v_add_f32 v162, v162, v166
    v_add_f32 v170, v170, v174
    s_waitcnt vmcnt(12)
    v_mfma_f32_16x16x32_bf16 v[108:111], a[144:147], a[204:207], v[108:111]
    v_add_f32 v163, v163, v167
    v_add_f32 v171, v171, v175
    v_add_f32 v160, v160, v168
    v_add_f32 v161, v161, v169
    v_mfma_f32_16x16x32_bf16 v[112:115], a[144:147], a[208:211], v[112:115]
    v_add_f32 v162, v162, v170
    v_add_f32_e64 v163, v163, v171
    s_waitcnt lgkmcnt(4)
    v_mfma_f32_16x16x32_bf16 v[112:115], a[140:143], a[188:191], v[112:115]
    v_add_f32 v176, v176, v180
    v_add_f32 v184, v184, v188
    v_add_f32 v177, v177, v181
    v_add_f32 v185, v185, v189
    v_mfma_f32_16x16x32_bf16 v[112:115], a[136:139], a[168:171], v[112:115]
    buffer_load_dwordx4 a[128:131], v4, s[52:55], s28 offen offset:0 sc1
    v_add_f32 v178, v178, v182
    v_add_f32 v186, v186, v190
    v_add_f32_e64 v179, v179, v183
    v_mfma_f32_16x16x32_bf16 v[116:119], a[136:139], a[172:175], v[116:119]
    v_add_f32 v187, v187, v191
    v_add_f32 v176, v176, v184
    v_add_f32 v177, v177, v185
    v_add_f32 v178, v178, v186
    v_mfma_f32_16x16x32_bf16 v[116:119], a[140:143], a[192:195], v[116:119]
    v_add_f32_e64 v179, v179, v187
    v_cvt_pk_bf16_f32 v180, v147, v147
    v_cvt_pk_bf16_f32 v181, v160, v161
    v_mfma_f32_16x16x32_bf16 v[116:119], a[144:147], a[212:215], v[116:119]
    v_cvt_pk_bf16_f32 v182, v162, v163
    v_cvt_pk_bf16_f32 v183, v176, v177
    v_and_or_b32 v180, v180, s78, v17
    buffer_store_dwordx4 v[180:183], v14, s[52:55], s76 offen offset:1024 sc1
    v_mfma_f32_16x16x32_bf16 v[120:123], a[144:147], a[216:219], v[120:123]
    buffer_load_dwordx4 a[132:135], v4, s[52:55], s28 offen offset:1024 sc1
    s_waitcnt lgkmcnt(0)
    v_add_f32 v192, v192, v196
    v_add_f32_e64 v200, v200, v204
    v_mfma_f32_16x16x32_bf16 v[120:123], a[140:143], a[196:199], v[120:123]
    v_add_f32 v193, v193, v197
    v_add_f32 v201, v201, v205
    v_add_f32 v194, v194, v198
    v_add_f32 v202, v202, v206
    v_mfma_f32_16x16x32_bf16 v[120:123], a[136:139], a[176:179], v[120:123]
    v_add_f32 v195, v195, v199
    v_add_f32 v203, v203, v207
    v_add_f32_e64 v192, v192, v200
    v_mfma_f32_16x16x32_bf16 v[124:127], a[136:139], a[180:183], v[124:127]
    v_add_f32 v193, v193, v201
    v_add_f32 v194, v194, v202
    v_add_f32_e64 v195, v195, v203
    v_cvt_pk_bf16_f32 v196, v178, v178
    v_mfma_f32_16x16x32_bf16 v[124:127], a[140:143], a[200:203], v[124:127]
    v_cvt_pk_bf16_f32 v197, v179, v192
    v_cvt_pk_bf16_f32 v198, v193, v194
    v_cvt_pk_bf16_f32 v199, v195, v195
    v_mfma_f32_16x16x32_bf16 v[124:127], a[144:147], a[220:223], v[124:127]
    v_and_or_b32 v196, v196, s78, v17
    buffer_store_dwordx4 v[196:199], v14, s[52:55], s76 offen offset:2048 sc1
    s_mov_b64 exec, 0xff
    buffer_store_dwordx4 a[252:255], v21, s[52:55], s80 offen sc1
    s_mov_b64 exec, -1
    s_waitcnt vmcnt(16)
    v_mfma_f32_16x16x32_bf16 v[48:51], a[148:151], a[0:3], v[48:51]
    s_waitcnt vmcnt(15)
    v_mfma_f32_16x16x32_bf16 v[48:51], a[152:155], a[20:23], v[48:51]
    buffer_load_dwordx4 a[136:139], v4, s[52:55], s28 offen offset:2048 sc1
    s_waitcnt vmcnt(15)
    v_mfma_f32_16x16x32_bf16 v[48:51], a[156:159], a[40:43], v[48:51]
    s_waitcnt vmcnt(14)
    v_mfma_f32_16x16x32_bf16 v[48:51], a[160:163], a[60:63], v[48:51]
    s_waitcnt vmcnt(13)
    v_mfma_f32_16x16x32_bf16 v[48:51], a[100:103], a[80:83], v[48:51]
    v_mfma_f32_16x16x32_bf16 v[52:55], a[100:103], a[84:87], v[52:55]
    v_mfma_f32_16x16x32_bf16 v[52:55], a[160:163], a[64:67], v[52:55]
    v_mfma_f32_16x16x32_bf16 v[52:55], a[156:159], a[44:47], v[52:55]
    v_mfma_f32_16x16x32_bf16 v[52:55], a[152:155], a[24:27], v[52:55]
    buffer_load_dwordx4 a[140:143], v4, s[52:55], s28 offen offset:3072 sc1
    v_mfma_f32_16x16x32_bf16 v[52:55], a[148:151], a[4:7], v[52:55]
    v_mfma_f32_16x16x32_bf16 v[56:59], a[148:151], a[8:11], v[56:59]
    v_mfma_f32_16x16x32_bf16 v[56:59], a[152:155], a[28:31], v[56:59]
    v_mfma_f32_16x16x32_bf16 v[56:59], a[156:159], a[48:51], v[56:59]
    v_mfma_f32_16x16x32_bf16 v[56:59], a[160:163], a[68:71], v[56:59]
    v_mfma_f32_16x16x32_bf16 v[56:59], a[100:103], a[88:91], v[56:59]
    v_mfma_f32_16x16x32_bf16 v[60:63], a[100:103], a[92:95], v[60:63]
    buffer_load_dwordx4 a[144:147], v13, s[52:55], s29 offen offset:0 sc1
    v_mfma_f32_16x16x32_bf16 v[60:63], a[160:163], a[72:75], v[60:63]
    v_mfma_f32_16x16x32_bf16 v[60:63], a[156:159], a[52:55], v[60:63]
    v_mfma_f32_16x16x32_bf16 v[60:63], a[152:155], a[32:35], v[60:63]
    v_mfma_f32_16x16x32_bf16 v[60:63], a[148:151], a[12:15], v[60:63]
    v_mfma_f32_16x16x32_bf16 v[64:67], a[148:151], a[16:19], v[64:67]
    v_mfma_f32_16x16x32_bf16 v[64:67], a[152:155], a[36:39], v[64:67]
    v_mfma_f32_16x16x32_bf16 v[64:67], a[156:159], a[56:59], v[64:67]
    v_mfma_f32_16x16x32_bf16 v[64:67], a[160:163], a[76:79], v[64:67]
    v_mfma_f32_16x16x32_bf16 v[64:67], a[100:103], a[96:99], v[64:67]
    s_waitcnt vmcnt(14)
    v_mfma_f32_16x16x32_bf16 v[68:71], a[104:107], a[0:3], v[68:71]
    s_waitcnt vmcnt(13)
    v_mfma_f32_16x16x32_bf16 v[68:71], a[108:111], a[20:23], v[68:71]
    buffer_load_dwordx4 a[148:151], v4, s[52:55], s29 offen offset:0 sc1
    ds_write_addtid_b32 v48 offset:10240
    ds_write_addtid_b32 v49 offset:10496
    s_waitcnt vmcnt(13)
    v_mfma_f32_16x16x32_bf16 v[68:71], a[112:115], a[40:43], v[68:71]
    ds_write_addtid_b32 v50 offset:10752
    s_waitcnt vmcnt(12)
    v_mfma_f32_16x16x32_bf16 v[68:71], a[116:119], a[60:63], v[68:71]
    ds_write_addtid_b32 v51 offset:11008
    s_waitcnt vmcnt(11)
    v_mfma_f32_16x16x32_bf16 v[68:71], a[120:123], a[80:83], v[68:71]
    ds_write_addtid_b32 v52 offset:11264
    v_mfma_f32_16x16x32_bf16 v[72:75], a[120:123], a[84:87], v[72:75]
    ds_write_addtid_b32 v53 offset:11520
    v_mfma_f32_16x16x32_bf16 v[72:75], a[116:119], a[64:67], v[72:75]
    buffer_load_dwordx4 a[152:155], v4, s[52:55], s29 offen offset:1024 sc1
    ds_write_addtid_b32 v54 offset:11776
    v_mfma_f32_16x16x32_bf16 v[72:75], a[112:115], a[44:47], v[72:75]
    ds_write_addtid_b32 v55 offset:12032
    v_mfma_f32_16x16x32_bf16 v[72:75], a[108:111], a[24:27], v[72:75]
    ds_write_addtid_b32 v56 offset:12288
    v_mfma_f32_16x16x32_bf16 v[72:75], a[104:107], a[4:7], v[72:75]
    ds_write_addtid_b32 v57 offset:12544
    v_mfma_f32_16x16x32_bf16 v[76:79], a[104:107], a[8:11], v[76:79]
    ds_write_addtid_b32 v58 offset:12800
    v_mfma_f32_16x16x32_bf16 v[76:79], a[108:111], a[28:31], v[76:79]
    buffer_load_dwordx4 a[156:159], v4, s[52:55], s29 offen offset:2048 sc1
    ds_write_addtid_b32 v59 offset:13056
    v_mfma_f32_16x16x32_bf16 v[76:79], a[112:115], a[48:51], v[76:79]
    ds_write_addtid_b32 v60 offset:13312
    s_load_dwordx2 s[16:17], s[14:15], 0 glc
    v_mfma_f32_16x16x32_bf16 v[76:79], a[116:119], a[68:71], v[76:79]
    ds_write_addtid_b32 v61 offset:13568
    v_mfma_f32_16x16x32_bf16 v[76:79], a[120:123], a[88:91], v[76:79]
    ds_write_addtid_b32 v62 offset:13824
    v_mfma_f32_16x16x32_bf16 v[80:83], a[120:123], a[92:95], v[80:83]
    ds_write_addtid_b32 v63 offset:14080
    v_mfma_f32_16x16x32_bf16 v[80:83], a[116:119], a[72:75], v[80:83]
    ds_write_addtid_b32 v64 offset:14336
    v_mfma_f32_16x16x32_bf16 v[80:83], a[112:115], a[52:55], v[80:83]
    buffer_load_dwordx4 a[160:163], v4, s[52:55], s29 offen offset:3072 sc1
    ds_write_addtid_b32 v65 offset:14592
    v_mfma_f32_16x16x32_bf16 v[80:83], a[108:111], a[32:35], v[80:83]
    ds_write_addtid_b32 v66 offset:14848
    v_mfma_f32_16x16x32_bf16 v[80:83], a[104:107], a[12:15], v[80:83]
    ds_write_addtid_b32 v67 offset:15104
    v_mfma_f32_16x16x32_bf16 v[84:87], a[104:107], a[16:19], v[84:87]
    v_mfma_f32_16x16x32_bf16 v[84:87], a[108:111], a[36:39], v[84:87]
    v_mfma_f32_16x16x32_bf16 v[84:87], a[112:115], a[56:59], v[84:87]
    v_mfma_f32_16x16x32_bf16 v[84:87], a[116:119], a[76:79], v[84:87]
    v_mfma_f32_16x16x32_bf16 v[84:87], a[120:123], a[96:99], v[84:87]
    s_waitcnt vmcnt(12)
    v_mfma_f32_16x16x32_bf16 v[88:91], a[124:127], a[0:3], v[88:91]
    s_waitcnt vmcnt(11)
    v_mfma_f32_16x16x32_bf16 v[88:91], a[128:131], a[20:23], v[88:91]
    ds_write_addtid_b32 v68 offset:15360
    ds_write_addtid_b32 v69 offset:15616
    s_waitcnt vmcnt(9)
    v_mfma_f32_16x16x32_bf16 v[88:91], a[132:135], a[40:43], v[88:91]
    ds_write_addtid_b32 v70 offset:15872
    s_waitcnt vmcnt(6)
    v_mfma_f32_16x16x32_bf16 v[88:91], a[136:139], a[60:63], v[88:91]
    ds_write_addtid_b32 v71 offset:16128
    s_waitcnt vmcnt(5)
    v_mfma_f32_16x16x32_bf16 v[88:91], a[140:143], a[80:83], v[88:91]
    ds_write_addtid_b32 v72 offset:16384
    v_mfma_f32_16x16x32_bf16 v[92:95], a[140:143], a[84:87], v[92:95]
    ds_write_addtid_b32 v73 offset:16640
    v_mfma_f32_16x16x32_bf16 v[92:95], a[136:139], a[64:67], v[92:95]
    ds_write_addtid_b32 v74 offset:16896
    v_mfma_f32_16x16x32_bf16 v[92:95], a[132:135], a[44:47], v[92:95]
    ds_write_addtid_b32 v75 offset:17152
    v_mfma_f32_16x16x32_bf16 v[92:95], a[128:131], a[24:27], v[92:95]
    ds_write_addtid_b32 v76 offset:17408
    v_mfma_f32_16x16x32_bf16 v[92:95], a[124:127], a[4:7], v[92:95]
    ds_write_addtid_b32 v77 offset:17664
    v_mfma_f32_16x16x32_bf16 v[96:99], a[124:127], a[8:11], v[96:99]
    ds_write_addtid_b32 v78 offset:17920
    v_mfma_f32_16x16x32_bf16 v[96:99], a[128:131], a[28:31], v[96:99]
    ds_write_addtid_b32 v79 offset:18176
    v_mfma_f32_16x16x32_bf16 v[96:99], a[132:135], a[48:51], v[96:99]
    ds_write_addtid_b32 v80 offset:18432
    v_mfma_f32_16x16x32_bf16 v[96:99], a[136:139], a[68:71], v[96:99]
    ds_write_addtid_b32 v81 offset:18688
    v_mfma_f32_16x16x32_bf16 v[96:99], a[140:143], a[88:91], v[96:99]
    ds_write_addtid_b32 v82 offset:18944
    v_mfma_f32_16x16x32_bf16 v[100:103], a[140:143], a[92:95], v[100:103]
    ds_write_addtid_b32 v83 offset:19200
    v_mfma_f32_16x16x32_bf16 v[100:103], a[136:139], a[72:75], v[100:103]
    ds_write_addtid_b32 v84 offset:19456
    v_mfma_f32_16x16x32_bf16 v[100:103], a[132:135], a[52:55], v[100:103]
    ds_write_addtid_b32 v85 offset:19712
    v_mfma_f32_16x16x32_bf16 v[100:103], a[128:131], a[32:35], v[100:103]
    ds_write_addtid_b32 v86 offset:19968
    v_mfma_f32_16x16x32_bf16 v[100:103], a[124:127], a[12:15], v[100:103]
    ds_write_addtid_b32 v87 offset:20224
    v_mfma_f32_16x16x32_bf16 v[104:107], a[124:127], a[16:19], v[104:107]
    v_mfma_f32_16x16x32_bf16 v[104:107], a[128:131], a[36:39], v[104:107]
    v_mfma_f32_16x16x32_bf16 v[104:107], a[132:135], a[56:59], v[104:107]
    s_waitcnt lgkmcnt(0)
    s_xor_b32 s16, s16, s34
    s_xor_b32 s17, s17, s34
    s_or_b32 s16, s16, s17
    s_cbranch_scc0 L_pbd
    s_mov_b32 s3, 0
L_pbl:
    s_load_dwordx2 s[16:17], s[14:15], 0 glc
    s_add_u32 s3, s3, 1
    s_cmp_ge_u32 s3, 400000
    s_cbranch_scc1 L_pbd
    s_waitcnt lgkmcnt(0)
    s_xor_b32 s16, s16, s34
    s_xor_b32 s17, s17, s34
    s_or_b32 s16, s16, s17
    s_cbranch_scc1 L_pbl
L_pbd:
    v_mfma_f32_16x16x32_bf16 v[104:107], a[136:139], a[76:79], v[104:107]
    buffer_load_dwordx4 v[228:231], v15, s[52:55], s76 offen offset:0 sc1
    buffer_load_dwordx4 v[232:235], v15, s[52:55], s76 offen offset:1024 sc1
    v_mfma_f32_16x16x32_bf16 v[104:107], a[140:143], a[96:99], v[104:107]
    buffer_load_dwordx4 v[236:239], v15, s[52:55], s76 offen offset:2048 sc1
    s_waitcnt vmcnt(7)
    v_mfma_f32_16x16x32_bf16 v[108:111], a[144:147], a[0:3], v[108:111]
    s_waitcnt vmcnt(6)
    v_mfma_f32_16x16x32_bf16 v[108:111], a[148:151], a[20:23], v[108:111]
    ds_write_addtid_b32 v88 offset:20480
    ds_write_addtid_b32 v89 offset:20736
    s_waitcnt vmcnt(5)
    v_mfma_f32_16x16x32_bf16 v[108:111], a[152:155], a[40:43], v[108:111]
    ds_write_addtid_b32 v90 offset:20992
    s_waitcnt vmcnt(4)
    v_mfma_f32_16x16x32_bf16 v[108:111], a[156:159], a[60:63], v[108:111]
    ds_write_addtid_b32 v91 offset:21248
    s_waitcnt vmcnt(3)
    v_mfma_f32_16x16x32_bf16 v[108:111], a[160:163], a[80:83], v[108:111]
    ds_write_addtid_b32 v92 offset:21504
    v_mfma_f32_16x16x32_bf16 v[112:115], a[160:163], a[84:87], v[112:115]
    ds_write_addtid_b32 v93 offset:21760
    v_mfma_f32_16x16x32_bf16 v[112:115], a[156:159], a[64:67], v[112:115]
    ds_write_addtid_b32 v94 offset:22016
    v_mfma_f32_16x16x32_bf16 v[112:115], a[152:155], a[44:47], v[112:115]
    ds_write_addtid_b32 v95 offset:22272
    v_mfma_f32_16x16x32_bf16 v[112:115], a[148:151], a[24:27], v[112:115]
    ds_write_addtid_b32 v96 offset:22528
    ds_write_addtid_b32 v108 offset:25600
    ds_write_addtid_b32 v109 offset:25856
    v_mfma_f32_16x16x32_bf16 v[112:115], a[144:147], a[4:7], v[112:115]
    ds_write_addtid_b32 v97 offset:22784
    ds_write_addtid_b32 v110 offset:26112
    ds_write_addtid_b32 v111 offset:26368
    v_mfma_f32_16x16x32_bf16 v[116:119], a[144:147], a[8:11], v[116:119]
    ds_write_addtid_b32 v98 offset:23040
    v_mfma_f32_16x16x32_bf16 v[116:119], a[148:151], a[28:31], v[116:119]
    ds_write_addtid_b32 v99 offset:23296
    v_mfma_f32_16x16x32_bf16 v[116:119], a[152:155], a[48:51], v[116:119]
    ds_write_addtid_b32 v100 offset:23552
    v_mfma_f32_16x16x32_bf16 v[116:119], a[156:159], a[68:71], v[116:119]
    ds_write_addtid_b32 v101 offset:23808
    ds_write_addtid_b32 v112 offset:26624
    ds_write_addtid_b32 v113 offset:26880
    v_mfma_f32_16x16x32_bf16 v[116:119], a[160:163], a[88:91], v[116:119]
    ds_write_addtid_b32 v102 offset:24064
    ds_write_addtid_b32 v114 offset:27136
    ds_write_addtid_b32 v115 offset:27392
    v_mfma_f32_16x16x32_bf16 v[120:123], a[160:163], a[92:95], v[120:123]
    ds_write_addtid_b32 v103 offset:24320
    v_mfma_f32_16x16x32_bf16 v[120:123], a[156:159], a[72:75], v[120:123]
    ds_write_addtid_b32 v104 offset:24576
    v_mfma_f32_16x16x32_bf16 v[120:123], a[152:155], a[52:55], v[120:123]
    ds_write_addtid_b32 v105 offset:24832
    v_mfma_f32_16x16x32_bf16 v[120:123], a[148:151], a[32:35], v[120:123]
    ds_write_addtid_b32 v106 offset:25088
    ds_write_addtid_b32 v116 offset:27648
    ds_write_addtid_b32 v117 offset:27904
    v_mfma_f32_16x16x32_bf16 v[120:123], a[144:147], a[12:15], v[120:123]
    ds_write_addtid_b32 v107 offset:25344
    ds_write_addtid_b32 v118 offset:28160
    ds_write_addtid_b32 v119 offset:28416
    v_mfma_f32_16x16x32_bf16 v[124:127], a[144:147], a[16:19], v[124:127]
    v_mfma_f32_16x16x32_bf16 v[124:127], a[148:151], a[36:39], v[124:127]
    v_mfma_f32_16x16x32_bf16 v[124:127], a[152:155], a[56:59], v[124:127]
    v_mfma_f32_16x16x32_bf16 v[124:127], a[156:159], a[76:79], v[124:127]
    s_nop 0
    ds_write_addtid_b32 v120 offset:28672
    ds_write_addtid_b32 v121 offset:28928
    v_mfma_f32_16x16x32_bf16 v[124:127], a[160:163], a[96:99], v[124:127]
    ds_write_addtid_b32 v122 offset:29184
    ds_write_addtid_b32 v123 offset:29440
    s_nop 5
    ds_write_addtid_b32 v124 offset:29696
    ds_write_addtid_b32 v125 offset:29952
    ds_write_addtid_b32 v126 offset:30208
    ds_write_addtid_b32 v127 offset:30464
    s_waitcnt lgkmcnt(0)
    s_barrier
    ds_read_b128 v[48:51], v10 offset:0
    ds_read_b128 v[52:55], v10 offset:40960
    ds_read_b128 v[56:59], v11 offset:0
    ds_read_b128 v[60:63], v11 offset:40960
    ds_read_b128 v[64:67], v10 offset:1024
    ds_read_b128 v[68:71], v10 offset:41984
    ds_read_b128 v[72:75], v11 offset:1024
    ds_read_b128 v[76:79], v11 offset:41984
    ds_read_b128 v[80:83], v10 offset:2048
    ds_read_b128 v[84:87], v10 offset:43008
    ds_read_b128 v[88:91], v11 offset:2048
    ds_read_b128 v[92:95], v11 offset:43008
    s_waitcnt vmcnt(0)
    v_xor_b32 v32, v17, v228
    v_xor_b32 v33, v17, v232
    v_xor_b32 v34, v17, v236
    v_or3_b32 v32, v32, v33, v34
    v_cmp_ne_u16 vcc, 0, v32
    s_cbranch_vccnz L_px
L_pxd:
    v_and_b32 v128, s78, v228
    v_lshlrev_b32 v129, 16, v229
    v_and_b32 v130, s78, v229
    v_lshlrev_b32 v131, 16, v230
    v_and_b32 v132, s78, v230
    v_lshlrev_b32 v133, 16, v231
    v_and_b32 v134, s78, v231
    v_and_b32 v135, s78, v232
    v_pk_add_f32 v[208:209], v[208:209], v[128:129]
    v_pk_add_f32 v[210:211], v[210:211], v[130:131]
    v_pk_add_f32 v[212:213], v[212:213], v[132:133]
    v_pk_add_f32 v[214:215], v[214:215], v[134:135]
    s_waitcnt lgkmcnt(8)
    ds_read_b128 v[96:99], v10 offset:3072
    ds_read_b128 v[100:103], v10 offset:44032
    ds_read_b128 v[104:107], v11 offset:3072
    ds_read_b128 v[108:111], v11 offset:44032
    s_nop 0
    v_pk_add_f32 v[48:49], v[48:49], v[52:53]
    v_pk_add_f32 v[56:57], v[56:57], v[60:61]
    v_pk_add_f32 v[50:51], v[50:51], v[54:55]
    v_pk_add_f32 v[58:59], v[58:59], v[62:63]
    v_pk_add_f32 v[208:209], v[208:209], v[48:49]
    v_pk_add_f32 v[210:211], v[210:211], v[50:51]
    v_pk_add_f32 v[208:209], v[208:209], v[56:57]
    v_pk_add_f32 v[210:211], v[210:211], v[58:59]
    buffer_store_dwordx4 v[208:211], v6, s[44:47], 0 offen offset:0 nt
    v_lshlrev_b32 v136, 16, v233
    v_and_b32 v137, s78, v233
    v_lshlrev_b32 v138, 16, v234
    v_and_b32 v139, s78, v234
    v_pk_add_f32 v[216:217], v[216:217], v[136:137]
    v_pk_add_f32 v[218:219], v[218:219], v[138:139]
    s_waitcnt lgkmcnt(8)
    ds_read_b128 v[112:115], v10 offset:4096
    ds_read_b128 v[116:119], v10 offset:45056
    ds_read_b128 v[120:123], v11 offset:4096
    ds_read_b128 v[124:127], v11 offset:45056
    s_nop 0
    v_pk_add_f32 v[64:65], v[64:65], v[68:69]
    v_pk_add_f32 v[72:73], v[72:73], v[76:77]
    v_pk_add_f32 v[66:67], v[66:67], v[70:71]
    v_pk_add_f32 v[74:75], v[74:75], v[78:79]
    v_pk_add_f32 v[212:213], v[212:213], v[64:65]
    v_pk_add_f32 v[214:215], v[214:215], v[66:67]
    v_pk_add_f32 v[212:213], v[212:213], v[72:73]
    v_pk_add_f32 v[214:215], v[214:215], v[74:75]
    buffer_store_dwordx4 v[212:215], v6, s[44:47], 0 offen offset:64 nt
    v_lshlrev_b32 v140, 16, v235
    v_and_b32 v141, s78, v235
    v_and_b32 v142, s78, v236
    v_lshlrev_b32 v143, 16, v237
    v_pk_add_f32 v[220:221], v[220:221], v[140:141]
    v_pk_add_f32 v[222:223], v[222:223], v[142:143]
    s_waitcnt lgkmcnt(8)
    s_nop 0
    v_pk_add_f32 v[80:81], v[80:81], v[84:85]
    v_pk_add_f32 v[88:89], v[88:89], v[92:93]
    v_pk_add_f32 v[82:83], v[82:83], v[86:87]
    v_pk_add_f32 v[90:91], v[90:91], v[94:95]
    v_pk_add_f32 v[216:217], v[216:217], v[80:81]
    v_pk_add_f32 v[218:219], v[218:219], v[82:83]
    v_pk_add_f32 v[216:217], v[216:217], v[88:89]
    v_pk_add_f32 v[218:219], v[218:219], v[90:91]
    buffer_store_dwordx4 v[216:219], v6, s[44:47], 0 offen offset:128 nt
    v_and_b32 v144, s78, v237
    v_lshlrev_b32 v145, 16, v238
    v_and_b32 v146, s78, v238
    v_lshlrev_b32 v147, 16, v239
    v_pk_add_f32 v[224:225], v[224:225], v[144:145]
    v_pk_add_f32 v[226:227], v[226:227], v[146:147]
    s_waitcnt lgkmcnt(4)
    s_nop 0
    v_pk_add_f32 v[96:97], v[96:97], v[100:101]
    v_pk_add_f32 v[104:105], v[104:105], v[108:109]
    v_pk_add_f32 v[98:99], v[98:99], v[102:103]
    v_pk_add_f32 v[106:107], v[106:107], v[110:111]
    v_pk_add_f32 v[220:221], v[220:221], v[96:97]
    v_pk_add_f32 v[222:223], v[222:223], v[98:99]
    v_pk_add_f32 v[220:221], v[220:221], v[104:105]
    v_pk_add_f32 v[222:223], v[222:223], v[106:107]
    buffer_store_dwordx4 v[220:223], v6, s[44:47], 0 offen offset:192 nt
    s_waitcnt lgkmcnt(0)
    s_nop 0
    v_pk_add_f32 v[112:113], v[112:113], v[116:117]
    v_pk_add_f32 v[120:121], v[120:121], v[124:125]
    v_pk_add_f32 v[114:115], v[114:115], v[118:119]
    v_pk_add_f32 v[122:123], v[122:123], v[126:127]
    v_pk_add_f32 v[224:225], v[224:225], v[112:113]
    v_pk_add_f32 v[226:227], v[226:227], v[114:115]
    v_pk_add_f32 v[224:225], v[224:225], v[120:121]
    v_pk_add_f32 v[226:227], v[226:227], v[122:123]
    buffer_store_dwordx4 v[224:227], v6, s[44:47], 0 offen offset:256 nt
L_end:
    s_endpgm
L_paF:
    s_mov_b32 s3, 0
L_paFl:
    buffer_load_dword v28, v29, s[52:55], 0 offen sc1
    s_waitcnt vmcnt(0)
    v_cmp_ne_u32 vcc, s34, v28
    s_add_u32 s3, s3, 1
    s_cmp_ge_u32 s3, 400000
    s_cbranch_scc1 L_paFd
    s_cbranch_vccnz L_paFl
    s_branch L_paFd
L_prF:
    s_mov_b32 s3, 0
L_prFl:
    buffer_load_dword v28, v31, s[52:55], 0 offen sc1
    s_waitcnt vmcnt(0)
    v_cmp_ne_u32 vcc, s34, v28
    s_add_u32 s3, s3, 1
    s_cmp_ge_u32 s3, 400000
    s_cbranch_scc1 L_prFd
    s_cbranch_vccnz L_prFl
    s_branch L_prFd
L_paS:
    s_mov_b32 s3, 0
L_paSl:
    buffer_load_dword v28, v29, s[52:55], 0 offen sc1
    s_waitcnt vmcnt(0)
    v_cmp_ne_u32 vcc, s34, v28
    s_add_u32 s3, s3, 1
    s_cmp_ge_u32 s3, 400000
    s_cbranch_scc1 L_paSd
    s_cbranch_vccnz L_paSl
    s_branch L_paSd
L_prS:
    s_mov_b32 s3, 0
L_prSl:
    buffer_load_dword v28, v31, s[52:55], 0 offen sc1
    s_waitcnt vmcnt(0)
    v_cmp_ne_u32 vcc, s34, v28
    s_add_u32 s3, s3, 1
    s_cmp_ge_u32 s3, 400000
    s_cbranch_scc1 L_prSd
    s_cbranch_vccnz L_prSl
    s_branch L_prSd
L_ps:
    s_mov_b32 s3, 0
L_psl:
    buffer_load_dword v28, v29, s[52:55], s4 offen sc1
    s_waitcnt vmcnt(0)
    v_cmp_ne_u32 vcc, s34, v28
    s_add_u32 s3, s3, 1
    s_cmp_ge_u32 s3, 400000
    s_cbranch_scc1 L_psd
    s_cbranch_vccnz L_psl
    s_branch L_psd
L_px:
    s_mov_b32 s3, 0
L_pxl:
    buffer_load_dwordx4 v[228:231], v15, s[52:55], s76 offen offset:0 sc1
    buffer_load_dwordx4 v[232:235], v15, s[52:55], s76 offen offset:1024 sc1
    buffer_load_dwordx4 v[236:239], v15, s[52:55], s76 offen offset:2048 sc1
    s_waitcnt vmcnt(0)
    v_xor_b32 v32, v17, v228
    v_xor_b32 v33, v17, v232
    v_xor_b32_e64 v34, v17, v236
    v_or3_b32 v32, v32, v33, v34
    v_cmp_ne_u16 vcc, 0, v32
    s_add_u32 s3, s3, 1
    s_cmp_ge_u32 s3, 400000
    s_cbranch_scc1 L_pxd
    s_cbranch_vccnz L_pxl
    s_branch L_pxd
L_code_end:
.fill 1056, 4, 0xbf800000
.section .rodata,"a"
.p2align 6
.amdhsa_kernel parallel_sum__ssm_conv_s5__dense_activation_squared_relu__prompt_kernel
  .amdhsa_next_free_vgpr 512
  .amdhsa_next_free_sgpr 102
  .amdhsa_accum_offset 256
  .amdhsa_group_segment_fixed_size 0
  .amdhsa_kernarg_size 136
  .amdhsa_user_sgpr_count 2
  .amdhsa_user_sgpr_kernarg_segment_ptr 1
  .amdhsa_system_sgpr_workgroup_id_x 1
.end_amdhsa_kernel
```
